```python
import torch

def _softmax(x, axis=-1):
    return torch.softmax(x, dim=axis)
def _gelu(x):
    return torch.nn.functional.gelu(x, approximate="tanh")
def _silu(x):
    return torch.nn.functional.silu(x)
def _sigmoid(x):
    return torch.sigmoid(x)
def _layernorm(x, axis=-1, eps=1e-5):
    m = x.mean(dim=axis, keepdim=True)
    v = x.var(dim=axis, keepdim=True, unbiased=False)
    return (x - m) / torch.sqrt(v + eps)
def _scatter_add(tgt, idx, src, axis=0):
    return tgt.clone().index_add_(axis, idx, src)
def _segment_sum(src, seg, n):
    out = torch.zeros((n,) + src.shape[1:], dtype=src.dtype)
    return out.index_add_(0, seg, src)
def _pad(x, pw):
    flat = tuple(v for pair in reversed(pw) for v in pair)
    return torch.nn.functional.pad(x, flat)

kernel_name = 'concat_heads__ssm_conv_s4__linear_kernel_hedgehog__prompt'

def setup_inputs():

    _w = (lambda a: (lambda t: t.to(torch.bfloat16) if t.is_floating_point() else t)(torch.as_tensor(a)))
    def _A_setup():
        B, L, D, N = 1, 2048, 640, 192
        A_re = -(lambda _x: torch.exp(torch.as_tensor(_x)))((lambda *s: torch.randn(*s, dtype=torch.bfloat16) * 3.2)(D, N))
        A_im = torch.pi * (lambda *s: torch.randn(*s, dtype=torch.bfloat16) * 0.2)(D, N)
        B_re = (lambda *s: torch.randn(*s, dtype=torch.bfloat16) * 0.4)(D, N)
        B_im = (lambda *s: torch.randn(*s, dtype=torch.bfloat16) * 0.4)(D, N)
        C_re = (lambda *s: torch.randn(*s, dtype=torch.bfloat16) * 0.4)(D, N)
        C_im = (lambda *s: torch.randn(*s, dtype=torch.bfloat16) * 0.4)(D, N)
        log_dt = (lambda *s: torch.randn(*s, dtype=torch.bfloat16) * 0.2)(D) * 0.5 - 4.0
        Dskip = (lambda *s: torch.randn(*s, dtype=torch.bfloat16) * 0.4)(D)
        return {
            "u": _w((lambda *s: torch.randn(*s, dtype=torch.bfloat16) * 0.05)(B, L, D)),
            "A_re": _w(A_re),
            "A_im": _w(A_im),
            "B_re": _w(B_re),
            "B_im": _w(B_im),
            "C_re": _w(C_re),
            "C_im": _w(C_im),
            "log_dt": _w(log_dt),
            "Dskip": _w(Dskip),
        }
    _A_in = _A_setup()

    def _B_setup():
        B, S, D, H = 1, 2048, 640, 32
        Dh = D // H
        return {
            "x": _w((lambda *s: torch.randn(*s, dtype=torch.bfloat16) * 0.4)(B, S, D)),
            "wqkv": _w((lambda *s: torch.randn(*s, dtype=torch.bfloat16) * 0.4)(D, 3 * D)),
            "w_phi": _w((lambda *s: torch.randn(*s, dtype=torch.bfloat16) * 0.4)(H, Dh, Dh) * (Dh ** -0.5)),
            "wo": _w((lambda *s: torch.randn(*s, dtype=torch.bfloat16) * 0.05)(D, D)),
        }
    _B_in = _B_setup()

    return {
        "A_u": _A_in["u"],
        "A_A_re": _A_in["A_re"],
        "A_A_im": _A_in["A_im"],
        "A_B_re": _A_in["B_re"],
        "A_B_im": _A_in["B_im"],
        "A_C_re": _A_in["C_re"],
        "A_C_im": _A_in["C_im"],
        "A_log_dt": _A_in["log_dt"],
        "A_Dskip": _A_in["Dskip"],
        "B_x": _B_in["x"],
        "B_wqkv": _B_in["wqkv"],
        "B_w_phi": _B_in["w_phi"],
        "B_wo": _B_in["wo"],
    }

def reference(A_u, A_A_re, A_A_im, A_B_re, A_B_im, A_C_re, A_C_im, A_log_dt, A_Dskip, B_x, B_wqkv, B_w_phi, B_wo):
    def _A_ref(u, A_re, A_im, B_re, B_im, C_re, C_im, log_dt, Dskip):
        Bsz, L, D = u.shape
        dt = torch.exp(log_dt)[:, None]
        A = A_re + 1j * A_im
        Bc = B_re + 1j * B_im
        Cc = C_re + 1j * C_im
        logdA = dt * A
        dB = dt * Bc
        l = (lambda x, dt: x.to(dt))(torch.arange(L), A_re.dtype)
        P = torch.exp(logdA[:, :, None] * l[None, None, :])
        K = torch.einsum("dn,dnl,dn->dl", Cc, P, dB).real
        L2 = 2 * L
        Kp = _pad(K, ((0, 0), (0, L)))
        up = (lambda x, *d: x.permute(*d))(u, 0, 2, 1)
        up = _pad(up, ((0, 0), (0, 0), (0, L)))
        Kf = (lambda x, axes=(-2,-1): torch.fft.rfft2(x.float(), dim=axes))(Kp[:, None, :], axes=(-2, -1))
        Uf = (lambda x, axes=(-2,-1): torch.fft.rfft2(x.float(), dim=axes))(up[:, :, None, :], axes=(-2, -1))
        Yf = Uf * Kf[None, :, :, :]
        y = (lambda x, s, axes=(-2,-1): torch.fft.irfft2(x, s=s, dim=axes).to(torch.bfloat16))(Yf, (1, L2), axes=(-2, -1))[:, :, 0, :L]
        y = (lambda x, *d: x.permute(*d))(y, 0, 2, 1) + u * Dskip[None, None, :]
        return y

    def _B_ref(x, wqkv, w_phi, wo):
        B, S, D = x.shape
        H = 32; Dh = D // H
        qkv = (lambda x, *d: x.permute(*d))((x @ wqkv).reshape(B, S, 3, H, Dh), 2, 0, 3, 1, 4)
        q, k, v = qkv[0], qkv[1], qkv[2]
        pq = torch.einsum("bhsd,hdf->bhsf", q, w_phi)
        pk = torch.einsum("bhsd,hdf->bhsf", k, w_phi)
        phi_q = torch.concatenate([_softmax(pq, axis=-1), _softmax(-pq, axis=-1)], axis=-1)
        phi_k = torch.concatenate([_softmax(pk, axis=-1), _softmax(-pk, axis=-1)], axis=-1)
        kv = torch.einsum("bhsf,bhsd->bhfd", phi_k, v)
        z  = torch.einsum("bhsf->bhf", phi_k)
        num = torch.einsum("bhqf,bhfd->bhqd", phi_q, kv)
        den = torch.einsum("bhqf,bhf->bhq", phi_q, z)[..., None] + 1e-6
        o = num / den
        return (lambda x, *d: x.permute(*d))(o, 0, 2, 1, 3).reshape(B, S, D) @ wo

    a = _A_ref(A_u, A_A_re, A_A_im, A_B_re, A_B_im, A_C_re, A_C_im, A_log_dt, A_Dskip)
    b = _B_ref(B_x, B_wqkv, B_w_phi, B_wo)
    return torch.concatenate([a, b], axis=-1)
```

```asm
; @launch grid=(256,1,1) block=(512,1,1) lds=163840
.amdgcn_target "amdgcn-amd-amdhsa--gfx950"
.text
.globl concat_heads__ssm_conv_s4__linear_kernel_hedgehog__prompt_kernel
.p2align 12
.p2align 8
.type concat_heads__ssm_conv_s4__linear_kernel_hedgehog__prompt_kernel,@function
concat_heads__ssm_conv_s4__linear_kernel_hedgehog__prompt_kernel:
    s_cmp_ge_u32 s2, 256
    s_cbranch_scc1 L_EXIT
    s_load_dwordx16 s[20:35], s[0:1], 64
    s_load_dwordx16 s[4:19], s[0:1], 0
    s_getpc_b64 s[60:61]
L_pc:
    s_lshr_b32 s62, s2, 3
    s_lshl_b32 s62, s62, 11
    v_lshrrev_b32_e64 v249, 5, v0
    v_lshl_add_u32 v249, v249, 7, s62
    v_min_u32 v249, L_END-L_pc-4, v249
    global_load_dword v255, v249, s[60:61]
    v_lshrrev_b32 v1, 6, v0
    v_and_b32_e64 v0, 63, v0
    v_readfirstlane_b32 s3, v1
    s_bfe_u32 s100, s2, 0x40003
    s_cmp_ge_u32 s2, 128
    s_cbranch_scc1 L_SIDE
    s_bfe_u32 s36, s2, 0x20001
    s_lshl_b32 s36, s36, 2
    s_lshr_b32 s59, s100, 2
    s_add_u32 s36, s36, s59
    s_and_b32 s37, s2, 1
    s_lshl_b32 s37, s37, 2
    s_and_b32 s59, s100, 3
    s_add_u32 s37, s37, s59
    s_and_b32 s38, s3, 3
    s_lshl_b32 s58, s36, 2
    s_add_u32 s58, s58, s38
    s_mul_i32 s60, s58, 40960
    s_cmp_ge_u32 s3, 4
    s_cbranch_scc1 L_BQ
    s_setprio 3
    v_lshlrev_b32 v12, 4, v0
    s_lshl_b32 s58, s38, 10
    s_add_u32 m0, s58, 157696
    s_mul_i32 s39, s37, 3200
    s_add_u32 s58, s58, s39
    s_waitcnt lgkmcnt(0)
    s_mov_b32 s40, s26
    s_mov_b32 s41, s27
    s_mov_b32 s42, 25600
    s_mov_b32 s43, 0x20000
    s_add_u32 s42, s39, 3200
    buffer_load_dwordx4 v12, s[40:43], s58 offen lds
    s_setprio 1
    s_branch L_BK
L_BQ:
    s_setprio 2
    v_lshrrev_b32 v20, 4, v0
    v_lshrrev_b32_e64 v24, 3, v0
    v_mul_u32_u24 v24, 1280, v24
    v_and_b32 v25, 7, v0
    v_xor_b32 v25, v25, v20
    v_lshl_add_u32 v9, v25, 4, v24
    v_xor_b32_e64 v10, 64, v9
    v_add_u32 v11, 18432, v9
    v_add_u32 v12, 27648, v10
    v_add_u32 v10, 9216, v10
    v_mul_u32_u24 v24, 205, v0
    v_lshlrev_b32 v25, 4, v0
    s_movk_i32 s39, 3680
    s_movk_i32 s58, 15360
    v_lshrrev_b32 v4, 11, v24
    v_bfe_u32 v26, v24, 13, 1
    v_bfe_u32 v27, v24, 14, 1
    v_sub_u32_e64 v26, v26, v27
    v_mad_u32_u24 v4, v4, s39, v25
    v_mad_i32_i24 v4, v26, s58, v4
    v_add_u32 v24, 13120, v24
    v_lshrrev_b32_e64 v5, 11, v24
    v_bfe_u32 v26, v24, 13, 1
    v_bfe_u32 v27, v24, 14, 1
    v_sub_u32_e64 v26, v26, v27
    v_mad_u32_u24 v5, v5, s39, v25
    v_mad_i32_i24 v5, v26, s58, v5
    v_add_u32 v24, 13120, v24
    v_lshrrev_b32_e64 v6, 11, v24
    v_bfe_u32 v26, v24, 13, 1
    v_bfe_u32 v27, v24, 14, 1
    v_sub_u32_e64 v26, v26, v27
    v_mad_u32_u24 v6, v6, s39, v25
    v_mad_i32_i24 v6, v26, s58, v6
    v_add_u32 v24, 13120, v24
    v_lshrrev_b32_e64 v7, 11, v24
    v_bfe_u32 v26, v24, 13, 1
    v_bfe_u32 v27, v24, 14, 1
    v_sub_u32_e64 v26, v26, v27
    v_mad_u32_u24 v7, v7, s39, v25
    v_mad_i32_i24 v7, v26, s58, v7
    v_add_u32 v24, 13120, v24
    v_add_u32 v25, 4096, v25
    v_lshrrev_b32_e64 v8, 11, v24
    v_bfe_u32 v26, v24, 13, 1
    v_bfe_u32 v27, v24, 14, 1
    v_sub_u32_e64 v26, v26, v27
    v_mad_u32_u24 v8, v8, s39, v25
    v_mad_i32_i24 v8, v26, s58, v8
    s_and_b32 s39, s38, 1
    s_lshr_b32 s58, s38, 1
    s_mul_i32 s53, s39, 10240
    s_mul_i32 s59, s58, 5120
    s_add_u32 s53, s53, s59
    s_mul_i32 s52, s39, 1280
    s_mul_i32 s59, s58, 122880
    s_add_u32 s52, s52, s59
    s_mul_i32 s59, s37, 160
    s_add_u32 s52, s52, s59
    s_lshl_b32 s54, s38, 12
    s_waitcnt lgkmcnt(0)
    s_mov_b32 s44, s22
    s_mov_b32 s45, s23
    s_mov_b32 s46, 2621440
    s_mov_b32 s47, 0x20000
    s_mov_b32 s40, s24
    s_mov_b32 s41, s25
    s_mov_b32 s42, 2457600
    s_mov_b32 s43, 0x20000
    s_bitcmp1_b32 s38, 0
    s_cbranch_scc0 L_even
    s_add_u32 m0, s54, 0
    s_add_u32 s39, s60, 0
    s_nop 0
    buffer_load_dwordx4 v9, s[44:47], s39 offen offset:0 lds
    buffer_load_dwordx4 v10, s[44:47], s39 offen offset:1024 lds
    buffer_load_dwordx4 v11, s[44:47], s39 offen offset:2048 lds
    buffer_load_dwordx4 v12, s[44:47], s39 offen offset:3072 lds
    s_add_u32 m0, s54, 4294963200
    s_add_u32 s39, s60, 4294926336
    buffer_load_dwordx4 v9, s[44:47], s39 offen offset:0 lds
    buffer_load_dwordx4 v10, s[44:47], s39 offen offset:1024 lds
    buffer_load_dwordx4 v11, s[44:47], s39 offen offset:2048 lds
    buffer_load_dwordx4 v12, s[44:47], s39 offen offset:3072 lds
    s_add_u32 m0, s54, 110592
    s_add_u32 s39, s60, 128
    buffer_load_dwordx4 v9, s[44:47], s39 offen offset:0 lds
    buffer_load_dwordx4 v10, s[44:47], s39 offen offset:1024 lds
    buffer_load_dwordx4 v11, s[44:47], s39 offen offset:2048 lds
    buffer_load_dwordx4 v12, s[44:47], s39 offen offset:3072 lds
    s_waitcnt vmcnt(4)
    s_barrier
    s_branch L_q1
L_even:
    s_nop 0
    s_add_u32 m0, s53, 16384
    s_add_u32 s39, s52, 1280
    buffer_load_dwordx4 v4, s[40:43], s39 offen offset:0 lds
    buffer_load_dwordx4 v5, s[40:43], s39 offen offset:1024 lds
    buffer_load_dwordx4 v6, s[40:43], s39 offen offset:2048 lds
    buffer_load_dwordx4 v7, s[40:43], s39 offen offset:3072 lds
    s_add_u32 m0, m0, 4096
    s_nop 0
    s_nop 0
    buffer_load_dwordx4 v8, s[40:43], s39 offen offset:0 lds
    s_add_u32 m0, s53, 26624
    s_add_u32 s39, s52, 2560
    buffer_load_dwordx4 v4, s[40:43], s39 offen offset:0 lds
    buffer_load_dwordx4 v5, s[40:43], s39 offen offset:1024 lds
    buffer_load_dwordx4 v6, s[40:43], s39 offen offset:2048 lds
    buffer_load_dwordx4 v7, s[40:43], s39 offen offset:3072 lds
    s_add_u32 m0, m0, 4096
    s_nop 0
    buffer_load_dwordx4 v8, s[40:43], s39 offen offset:0 lds
    s_waitcnt vmcnt(5)
    s_barrier
    s_nop 0
    s_add_u32 m0, s54, 110592
    s_add_u32 s39, s60, 128
    buffer_load_dwordx4 v9, s[44:47], s39 offen offset:0 lds
    buffer_load_dwordx4 v10, s[44:47], s39 offen offset:1024 lds
    buffer_load_dwordx4 v11, s[44:47], s39 offen offset:2048 lds
    buffer_load_dwordx4 v12, s[44:47], s39 offen offset:3072 lds
    s_branch L_q1
L_SIDE:
    s_waitcnt lgkmcnt(0)
    s_and_b32 s37, s2, 1
    s_mul_i32 s37, s37, 640
    v_and_b32 v253, 7, v0
    v_mul_u32_u24 v252, 1280, v253
    s_lshl_b32 s36, s100, 3
    s_add_u32 s36, s36, s3
    s_mul_i32 s36, s36, 80
    s_and_b32 s38, s2, 7
    s_add_u32 s36, s36, s38
    s_lshl_b32 s36, s36, 7
    v_add_u32_e64 v252, s36, v252
    s_lshr_b32 s36, s38, 1
    s_sub_u32 s36, s36, s38
    s_add_u32 s36, s36, 8
    s_cmp_lt_u32 s38, 4
    s_cselect_b32 s36, s36, 0
    s_cselect_b32 s93, 12, 8
    s_lshl_b32 s36, s36, 7
    v_bfe_u32 v253, v0, 3, 1
    v_mad_u32_u24 v252, v253, s36, v252
    s_and_b32 s62, s2, 7
    s_lshl_b32 s39, s62, 2
    s_add_u32 s39, s39, 56
    s_lshl_b32 s62, s62, 3
    s_cmp_lt_u32 s100, 8
    s_cselect_b32 s62, s62, s39
    s_add_u32 s55, s62, s100
    s_lshl_b32 s63, s55, 3
    s_add_u32 s63, s63, s3
    s_nop 0
    s_mul_i32 s62, s63, 384
    v_lshl_add_u32 v1, v0, 2, s62
    v_lshl_add_u32 v35, v0, 1, s62
    s_min_u32 s39, s63, 639
    s_lshl_b32 s39, s39, 1
    v_mov_b32 v34, s39
    v_mov_b32 v14, 0
    v_mov_b32 v15, 0
    v_mov_b32 v16, 0
    v_mov_b32 v17, 0
    v_mov_b32 v18, 0
    v_mov_b32 v19, 0
    v_mov_b32 v20, 0
    v_mov_b32 v21, 0
    s_lshr_b32 s38, s3, 1
    s_bitcmp1_b32 s3, 0
    s_cbranch_scc1 L_ex
    v_lshrrev_b32 v253, 3, v0
    v_mul_u32_u24 v249, 1280, v253
    v_and_b32 v253, 7, v0
    v_min_u32 v253, 4, v253
    v_lshl_add_u32 v249, v253, 7, v249
    v_lshrrev_b32_e64 v253, 4, v0
    v_mul_u32_u24 v253, 1280, v253
    s_lshl_b32 s36, s38, 4
    s_add_u32 s36, s36, s100
    s_mul_i32 s36, s36, 15360
    s_add_u32 s36, s36, s37
    s_add_u32 s36, s36, 1280
    v_add3_u32 v249, v249, v253, s36
    s_mov_b32 s36, 983040
    s_mov_b64 s[96:97], s[24:25]
    s_branch L_e2
L_ex:
    v_and_b32 v253, 31, v0
    v_mul_u32_u24 v249, 1280, v253
    s_bfe_u32 s36, s2, 0x20001
    s_lshl_b32 s36, s36, 4
    s_add_u32 s36, s36, s100
    s_mul_i32 s36, s36, 40960
    s_lshl_b32 s38, s38, 7
    s_add_u32 s36, s36, s38
    v_add_u32_e64 v249, s36, v249
    s_movk_i32 s36, 512
    s_mov_b64 s[96:97], s[22:23]
L_e2:
    s_cmp_ge_u32 s3, 8
    s_cbranch_scc1 L_e3
    global_load_dword v255, v249, s[96:97]
L_e3:
    v_add_u32 v250, s36, v249
    v_add_u32 v251, s36, v250
    s_mov_b64 s[98:99], s[96:97]
    s_cmp_lt_u32 s3, 4
    s_cbranch_scc1 L_e5
    v_min_u32 v253, 49, v0
    v_mul_u32_u24 v251, 52, v253
    v_lshrrev_b32 v251, 8, v251
    v_mul_u32_u24 v251, 3200, v251
    v_lshl_add_u32 v251, v253, 7, v251
    s_lshl_b32 s36, s3, 4
    s_add_u32 s36, s36, s100
    s_sub_u32 s36, s36, 64
    s_mul_i32 s36, s36, 38400
    s_add_u32 s36, s36, s37
    v_add_u32 v251, s36, v251
    s_mov_b64 s[98:99], s[24:25]
L_e5:
    s_cmp_lt_u32 s100, s93
    s_cbranch_scc1 L_A
    s_mov_b32 s40, s34
    s_mov_b32 s41, s35
    s_mov_b32 s42, 16777216
    s_mov_b32 s43, 0x20000
    s_mov_b32 s44, s32
    s_mov_b32 s45, s33
    s_mov_b32 s46, 256
    s_mov_b32 s47, 0x20000
    s_bfe_u32 s36, s2, 0x20003
    s_lshl_b32 s36, s36, 2
    s_and_b32 s38, s2, 3
    s_add_u32 s36, s36, s38
    s_add_u32 s36, s36, 32
    s_sub_u32 s38, s2, 224
    s_cselect_b32 s38, s36, s38
    s_lshl_b32 s38, s38, 3
    s_add_u32 s38, s38, s3
    v_lshlrev_b32 v2, 4, v0
    v_add_u32 v3, 4096, v2
    v_mov_b32 v4, -1
    v_mov_b32 v5, -1
    v_mov_b32 v6, -1
    v_mov_b32 v7, -1
    v_add_u32 v8, s3, v0
    v_lshlrev_b32 v8, 8, v8
    v_mov_b32 v9, 1
    s_waitcnt vmcnt(0)
    global_load_dword v255, v250, s[96:97]
    s_barrier
    global_load_dword v255, v251, s[98:99]
    s_waitcnt vmcnt(0)
    s_mul_i32 s36, s38, 6144
    s_add_u32 s36, s36, 0
    s_nop 0
    buffer_store_dwordx4 v[4:7], v2, s[40:43], s36 offen offset:0 sc1
    buffer_store_dwordx4 v[4:7], v2, s[40:43], s36 offen offset:1024 sc1
    buffer_store_dwordx4 v[4:7], v2, s[40:43], s36 offen offset:2048 sc1
    buffer_store_dwordx4 v[4:7], v2, s[40:43], s36 offen offset:3072 sc1
    buffer_store_dwordx4 v[4:7], v3, s[40:43], s36 offen offset:0 sc1
    buffer_store_dwordx4 v[4:7], v3, s[40:43], s36 offen offset:1024 sc1
    global_load_dword v255, v252, s[4:5] nt
    v_add_u32 v252, 1310720, v252
    global_load_dword v255, v252, s[4:5] nt
    s_waitcnt vmcnt(2)
    s_barrier
    buffer_atomic_add v9, v8, s[44:47], 0 offen offset:0 sc1
    s_mul_i32 s36, s38, 7168
    s_add_u32 s36, s36, 3145728
    buffer_store_dwordx4 v[4:7], v2, s[40:43], s36 offen offset:0 sc1
    buffer_store_dwordx4 v[4:7], v2, s[40:43], s36 offen offset:1024 sc1
    buffer_store_dwordx4 v[4:7], v2, s[40:43], s36 offen offset:2048 sc1
    buffer_store_dwordx4 v[4:7], v2, s[40:43], s36 offen offset:3072 sc1
    buffer_store_dwordx4 v[4:7], v3, s[40:43], s36 offen offset:0 sc1
    buffer_store_dwordx4 v[4:7], v3, s[40:43], s36 offen offset:1024 sc1
    buffer_store_dwordx4 v[4:7], v3, s[40:43], s36 offen offset:2048 sc1
    s_waitcnt vmcnt(0)
    s_barrier
    buffer_atomic_add v9, v8, s[44:47], 0 offen offset:128 sc1
L_EXIT:
    s_endpgm
.p2align 12
L_q1:
    s_add_u32 m0, s53, 126976
    s_add_u32 s39, s52, 247040
    buffer_load_dwordx4 v4, s[40:43], s39 offen offset:0 lds
    buffer_load_dwordx4 v5, s[40:43], s39 offen offset:1024 lds
    buffer_load_dwordx4 v6, s[40:43], s39 offen offset:2048 lds
    buffer_load_dwordx4 v7, s[40:43], s39 offen offset:3072 lds
    s_add_u32 m0, m0, 4096
    s_nop 0
    buffer_load_dwordx4 v8, s[40:43], s39 offen offset:0 lds
    v_lshrrev_b32 v20, 4, v0
    v_bfe_u32 v21, v0, 2, 2
    v_and_b32 v22, 3, v0
    v_and_b32 v23, 15, v0
    v_lshrrev_b32 v24, 1, v20
    v_lshlrev_b32 v24, 2, v24
    v_and_b32 v25, 1, v20
    v_add_u32 v24, v24, v25
    v_lshl_add_u32 v24, v24, 2, v21
    v_lshl_add_u32 v24, v24, 2, v22
    v_mul_u32_u24 v24, 40, v24
    v_add_u32 v1, 0, v24
    v_lshrrev_b32 v24, 1, v23
    v_xor_b32 v24, v24, v20
    v_lshlrev_b32_e64 v24, 4, v24
    v_lshl_add_u32 v24, v23, 7, v24
    s_lshl_b32 s39, s38, 12
    s_add_u32 s39, s39, 0
    v_add_u32 v2, s39, v24
    v_xor_b32 v3, 64, v2
    s_waitcnt vmcnt(9)
    s_barrier
    s_add_u32 m0, s54, 73728
    s_add_u32 s39, s60, 256
    buffer_load_dwordx4 v9, s[44:47], s39 offen offset:0 lds
    buffer_load_dwordx4 v10, s[44:47], s39 offen offset:1024 lds
    buffer_load_dwordx4 v11, s[44:47], s39 offen offset:2048 lds
    buffer_load_dwordx4 v12, s[44:47], s39 offen offset:3072 lds
    s_add_u32 m0, s53, 90112
    s_add_u32 s39, s52, 492800
    buffer_load_dwordx4 v4, s[40:43], s39 offen offset:0 lds
    ds_read_b128 v[96:99], v2 offset:0
    buffer_load_dwordx4 v5, s[40:43], s39 offen offset:1024 lds
    ds_read_b128 v[100:103], v2 offset:2048
    buffer_load_dwordx4 v6, s[40:43], s39 offen offset:2048 lds
    ds_read_b128 v[104:107], v3 offset:0
    buffer_load_dwordx4 v7, s[40:43], s39 offen offset:3072 lds
    s_add_u32 m0, m0, 4096
    ds_read_b128 v[108:111], v3 offset:2048
    buffer_load_dwordx4 v8, s[40:43], s39 offen offset:0 lds
    v_mul_u32_u24 v24, 800, v20
    v_mul_u32_u24 v25, 40, v21
    v_cmp_eq_u32 vcc, v22, v20
    v_add_u32_e64 v24, v24, v25
    v_add_u32 v24, 157696, v24
    v_mov_b32 v25, 160896
    v_cndmask_b32_e64 v15, v25, v24, vcc
    s_mov_b32 s56, 0x3fb8aa3b
    s_mov_b32 s57, 0x3fb8aa3b
    s_add_u32 s69, s60, 3145728
    s_mov_b32 s48, s34
    s_mov_b32 s49, s35
    s_mov_b32 s50, 16777216
    s_mov_b32 s51, 0x20000
    s_bitcmp1_b32 s38, 0
    s_cselect_b64 vcc, -1, 0
    s_cselect_b32 s4, 3, 0
    s_cselect_b32 s5, 4, 1
    s_cselect_b32 s6, 4, 2
    s_lshr_b32 s58, s38, 1
    s_mul_i32 s7, s58, 122880
    s_add_u32 s7, s7, s59
    s_mul_i32 s58, s58, 5
    s_sub_u32 s4, s4, s58
    s_lshl_b32 s4, s4, 10
    s_sub_u32 s5, s5, s58
    s_lshl_b32 s5, s5, 10
    s_sub_u32 s6, s6, s58
    s_lshl_b32 s6, s6, 10
    v_add_u32 v30, 3072, v7
    v_add_u32 v31, 1024, v5
    v_add_u32 v32, 2048, v6
    v_cndmask_b32 v30, v4, v30, vcc
    v_cndmask_b32 v31, v31, v8, vcc
    v_cndmask_b32_e64 v32, v32, v8, vcc
    v_add_u32 v2, 110592, v2
    v_add_u32 v3, 110592, v3
    s_waitcnt vmcnt(9) lgkmcnt(0)
    s_barrier
    s_add_u32 m0, s54, 36864
    s_add_u32 s39, s60, 384
    buffer_load_dwordx4 v9, s[44:47], s39 offen offset:0 lds
    buffer_load_dwordx4 v10, s[44:47], s39 offen offset:1024 lds
    buffer_load_dwordx4 v11, s[44:47], s39 offen offset:2048 lds
    buffer_load_dwordx4 v12, s[44:47], s39 offen offset:3072 lds
    s_add_u32 m0, s53, 53248
    s_add_u32 s39, s52, 738560
    buffer_load_dwordx4 v4, s[40:43], s39 offen offset:0 lds
    ds_read_b128 v[112:115], v2 offset:0
    buffer_load_dwordx4 v5, s[40:43], s39 offen offset:1024 lds
    ds_read_b128 v[116:119], v2 offset:2048
    buffer_load_dwordx4 v6, s[40:43], s39 offen offset:2048 lds
    ds_read_b128 v[120:123], v3 offset:0
    buffer_load_dwordx4 v7, s[40:43], s39 offen offset:3072 lds
    s_add_u32 m0, m0, 4096
    ds_read_b128 v[124:127], v3 offset:2048
    buffer_load_dwordx4 v8, s[40:43], s39 offen offset:0 lds
    v_add_u32 v2, 4294930432, v2
    v_add_u32 v3, 4294930432, v3
    s_waitcnt vmcnt(9) lgkmcnt(0)
    s_barrier
    s_add_u32 m0, s54, 0
    s_nop 0
    s_add_u32 s39, s60, 512
    buffer_load_dwordx4 v9, s[44:47], s39 offen offset:0 lds
    buffer_load_dwordx4 v10, s[44:47], s39 offen offset:1024 lds
    buffer_load_dwordx4 v11, s[44:47], s39 offen offset:2048 lds
    buffer_load_dwordx4 v12, s[44:47], s39 offen offset:3072 lds
    s_add_u32 m0, s53, 16384
    s_add_u32 s39, s52, 984320
    buffer_load_dwordx4 v4, s[40:43], s39 offen offset:0 lds
    ds_read_b128 v[128:131], v2 offset:0
    buffer_load_dwordx4 v5, s[40:43], s39 offen offset:1024 lds
    ds_read_b128 v[132:135], v2 offset:2048
    buffer_load_dwordx4 v6, s[40:43], s39 offen offset:2048 lds
    ds_read_b128 v[136:139], v3 offset:0
    buffer_load_dwordx4 v7, s[40:43], s39 offen offset:3072 lds
    s_add_u32 m0, m0, 4096
    ds_read_b128 v[140:143], v3 offset:2048
    buffer_load_dwordx4 v8, s[40:43], s39 offen offset:0 lds
    v_add_u32 v2, 4294930432, v2
    v_add_u32 v3, 4294930432, v3
    s_waitcnt vmcnt(9) lgkmcnt(0)
    s_barrier
    s_add_u32 m0, s54, 110592
    s_add_u32 s39, s60, 640
    buffer_load_dwordx4 v9, s[44:47], s39 offen offset:0 lds
    buffer_load_dwordx4 v10, s[44:47], s39 offen offset:1024 lds
    buffer_load_dwordx4 v11, s[44:47], s39 offen offset:2048 lds
    buffer_load_dwordx4 v12, s[44:47], s39 offen offset:3072 lds
    s_add_u32 m0, s53, 126976
    s_add_u32 s39, s52, 1230080
    buffer_load_dwordx4 v4, s[40:43], s39 offen offset:0 lds
    ds_read_b128 v[144:147], v2 offset:0
    buffer_load_dwordx4 v5, s[40:43], s39 offen offset:1024 lds
    ds_read_b128 v[148:151], v2 offset:2048
    buffer_load_dwordx4 v6, s[40:43], s39 offen offset:2048 lds
    ds_read_b128 v[152:155], v3 offset:0
    buffer_load_dwordx4 v7, s[40:43], s39 offen offset:3072 lds
    s_add_u32 m0, m0, 4096
    ds_read_b128 v[156:159], v3 offset:2048
    buffer_load_dwordx4 v8, s[40:43], s39 offen offset:0 lds
    v_add_u32 v2, 4294930432, v2
    v_add_u32 v3, 4294930432, v3
    s_waitcnt vmcnt(9) lgkmcnt(0)
    s_barrier
    s_add_u32 m0, s54, 73728
    s_add_u32 s39, s60, 768
    buffer_load_dwordx4 v9, s[44:47], s39 offen offset:0 lds
    buffer_load_dwordx4 v10, s[44:47], s39 offen offset:1024 lds
    buffer_load_dwordx4 v11, s[44:47], s39 offen offset:2048 lds
    buffer_load_dwordx4 v12, s[44:47], s39 offen offset:3072 lds
    s_add_u32 m0, s53, 90112
    s_add_u32 s39, s52, 1475840
    buffer_load_dwordx4 v4, s[40:43], s39 offen offset:0 lds
    ds_read_b128 v[160:163], v2 offset:0
    buffer_load_dwordx4 v5, s[40:43], s39 offen offset:1024 lds
    ds_read_b128 v[164:167], v2 offset:2048
    buffer_load_dwordx4 v6, s[40:43], s39 offen offset:2048 lds
    ds_read_b128 v[168:171], v3 offset:0
    buffer_load_dwordx4 v7, s[40:43], s39 offen offset:3072 lds
    s_add_u32 m0, m0, 4096
    ds_read_b128 v[172:175], v3 offset:2048
    buffer_load_dwordx4 v8, s[40:43], s39 offen offset:0 lds
    v_add_u32 v2, 110592, v2
    v_add_u32 v3, 110592, v3
    s_waitcnt vmcnt(9) lgkmcnt(0)
    s_barrier
    s_add_u32 m0, s54, 36864
    s_add_u32 s39, s60, 896
    buffer_load_dwordx4 v9, s[44:47], s39 offen offset:0 lds
    buffer_load_dwordx4 v10, s[44:47], s39 offen offset:1024 lds
    buffer_load_dwordx4 v11, s[44:47], s39 offen offset:2048 lds
    buffer_load_dwordx4 v12, s[44:47], s39 offen offset:3072 lds
    s_add_u32 m0, s53, 53248
    s_add_u32 s39, s52, 1721600
    buffer_load_dwordx4 v4, s[40:43], s39 offen offset:0 lds
    ds_read_b128 v[176:179], v2 offset:0
    buffer_load_dwordx4 v5, s[40:43], s39 offen offset:1024 lds
    ds_read_b128 v[180:183], v2 offset:2048
    buffer_load_dwordx4 v6, s[40:43], s39 offen offset:2048 lds
    ds_read_b128 v[184:187], v3 offset:0
    buffer_load_dwordx4 v7, s[40:43], s39 offen offset:3072 lds
    s_add_u32 m0, m0, 4096
    ds_read_b128 v[188:191], v3 offset:2048
    buffer_load_dwordx4 v8, s[40:43], s39 offen offset:0 lds
    v_add_u32 v2, 4294930432, v2
    v_add_u32 v3, 4294930432, v3
    s_waitcnt vmcnt(9) lgkmcnt(0)
    s_barrier
    s_add_u32 m0, s54, 0
    s_nop 0
    s_add_u32 s39, s60, 1024
    buffer_load_dwordx4 v9, s[44:47], s39 offen offset:0 lds
    buffer_load_dwordx4 v10, s[44:47], s39 offen offset:1024 lds
    buffer_load_dwordx4 v11, s[44:47], s39 offen offset:2048 lds
    buffer_load_dwordx4 v12, s[44:47], s39 offen offset:3072 lds
    s_add_u32 m0, s53, 16384
    s_add_u32 s39, s52, 1967360
    buffer_load_dwordx4 v4, s[40:43], s39 offen offset:0 lds
    ds_read_b128 v[192:195], v2 offset:0
    buffer_load_dwordx4 v5, s[40:43], s39 offen offset:1024 lds
    ds_read_b128 v[196:199], v2 offset:2048
    buffer_load_dwordx4 v6, s[40:43], s39 offen offset:2048 lds
    ds_read_b128 v[200:203], v3 offset:0
    buffer_load_dwordx4 v7, s[40:43], s39 offen offset:3072 lds
    s_add_u32 m0, m0, 4096
    ds_read_b128 v[204:207], v3 offset:2048
    buffer_load_dwordx4 v8, s[40:43], s39 offen offset:0 lds
    v_add_u32 v2, 4294930432, v2
    v_add_u32 v3, 4294930432, v3
    s_waitcnt vmcnt(9) lgkmcnt(0)
    s_barrier
    s_add_u32 m0, s54, 110592
    s_add_u32 s39, s60, 1152
    buffer_load_dwordx4 v9, s[44:47], s39 offen offset:0 lds
    buffer_load_dwordx4 v10, s[44:47], s39 offen offset:1024 lds
    buffer_load_dwordx4 v11, s[44:47], s39 offen offset:2048 lds
    buffer_load_dwordx4 v12, s[44:47], s39 offen offset:3072 lds
    s_add_u32 m0, s53, 126976
    s_add_u32 s39, s52, 2213120
    buffer_load_dwordx4 v4, s[40:43], s39 offen offset:0 lds
    buffer_load_dwordx4 v5, s[40:43], s39 offen offset:1024 lds
    buffer_load_dwordx4 v6, s[40:43], s39 offen offset:2048 lds
    buffer_load_dwordx4 v7, s[40:43], s39 offen offset:3072 lds
    s_add_u32 m0, m0, 4096
    ds_read_b128 v[208:211], v2 offset:0
    buffer_load_dwordx4 v8, s[40:43], s39 offen offset:0 lds
    s_add_u32 m0, s4, 152576
    s_add_u32 s39, s7, 0
    ds_read_b128 v[212:215], v2 offset:2048
    buffer_load_dwordx4 v30, s[40:43], s39 offen lds
    s_add_u32 m0, s5, 152576
    s_add_u32 s39, s7, 0
    ds_read_b128 v[216:219], v3 offset:0
    buffer_load_dwordx4 v31, s[40:43], s39 offen lds
    s_add_u32 m0, s6, 152576
    s_add_u32 s39, s7, 0
    ds_read_b128 v[220:223], v3 offset:2048
    buffer_load_dwordx4 v32, s[40:43], s39 offen lds
    s_mul_i32 s52, s38, 122880
    s_add_u32 s52, s52, s59
    s_mul_i32 s53, s38, 5120
    v_add_u32 v9, 147456, v1
    v_add_u32 v2, 4294930432, v2
    v_add_u32 v3, 4294930432, v3
    s_waitcnt vmcnt(12) lgkmcnt(0)
    s_barrier
    s_sub_u32 m0, 87040, s53
    s_add_u32 s39, s52, 245760
    buffer_load_dwordx4 v4, s[40:43], s39 offen offset:0 lds
    buffer_load_dwordx4 v5, s[40:43], s39 offen offset:1024 lds
    buffer_load_dwordx4 v6, s[40:43], s39 offen offset:2048 lds
    buffer_load_dwordx4 v7, s[40:43], s39 offen offset:3072 lds
    s_add_u32 m0, m0, 4096
    s_nop 0
    s_nop 0
    buffer_load_dwordx4 v8, s[40:43], s39 offen offset:0 lds
    s_sub_u32 m0, 66560, s53
    s_add_u32 s39, s52, 737280
    buffer_load_dwordx4 v4, s[40:43], s39 offen offset:0 lds
    ds_read_b128 v[224:227], v2 offset:0
    buffer_load_dwordx4 v5, s[40:43], s39 offen offset:1024 lds
    ds_read_b128 v[228:231], v2 offset:2048
    buffer_load_dwordx4 v6, s[40:43], s39 offen offset:2048 lds
    ds_read_b128 v[232:235], v3 offset:0
    buffer_load_dwordx4 v7, s[40:43], s39 offen offset:3072 lds
    s_add_u32 m0, m0, 4096
    ds_read_b128 v[236:239], v3 offset:2048
    buffer_load_dwordx4 v8, s[40:43], s39 offen offset:0 lds
    v_add_u32 v2, 110592, v2
    v_add_u32 v3, 110592, v3
    s_waitcnt vmcnt(10) lgkmcnt(0)
    s_barrier
    ds_read_b64_tr_b16 v[56:57], v9 offset:5120
    ds_read_b64_tr_b16 v[58:59], v9 offset:6400
    ds_read_b64_tr_b16 v[60:61], v9 offset:5128
    s_sub_u32 m0, 46080, s53
    ds_read_b64_tr_b16 v[62:63], v9 offset:6408
    ds_read_b64_tr_b16 v[64:65], v9 offset:5136
    s_add_u32 s39, s52, 1228800
    ds_read_b64_tr_b16 v[66:67], v9 offset:6416
    ds_read_b64_tr_b16 v[68:69], v9 offset:5144
    ds_read_b64_tr_b16 v[70:71], v9 offset:6424
    buffer_load_dwordx4 v4, s[40:43], s39 offen offset:0 lds
    ds_read_b64_tr_b16 v[72:73], v9 offset:5152
    ds_read_b64_tr_b16 v[74:75], v9 offset:6432
    ds_read_b128 v[240:243], v2 offset:0
    buffer_load_dwordx4 v5, s[40:43], s39 offen offset:1024 lds
    ds_read_b64_tr_b16 v[76:77], v9 offset:0
    ds_read_b64_tr_b16 v[78:79], v9 offset:1280
    ds_read_b64_tr_b16 v[80:81], v9 offset:8
    ds_read_b128 v[244:247], v2 offset:2048
    buffer_load_dwordx4 v6, s[40:43], s39 offen offset:2048 lds
    ds_read_b64_tr_b16 v[82:83], v9 offset:1288
    ds_read_b64_tr_b16 v[84:85], v9 offset:16
    ds_read_b128 v[248:251], v3 offset:0
    buffer_load_dwordx4 v7, s[40:43], s39 offen offset:3072 lds
    ds_read_b64_tr_b16 v[86:87], v9 offset:1296
    ds_read_b64_tr_b16 v[88:89], v9 offset:24
    ds_read_b64_tr_b16 v[90:91], v9 offset:1304
    s_add_u32 m0, m0, 4096
    ds_read_b64_tr_b16 v[92:93], v9 offset:32
    ds_read_b64_tr_b16 v[94:95], v9 offset:1312
    ds_read_b128 v[252:255], v3 offset:2048
    buffer_load_dwordx4 v8, s[40:43], s39 offen offset:0 lds
    v_add_u32 v2, 46080, v1
    s_waitcnt vmcnt(10) lgkmcnt(0)
    s_barrier
    s_sub_u32 m0, 25600, s53
    s_add_u32 s39, s52, 1720320
    buffer_load_dwordx4 v4, s[40:43], s39 offen offset:0 lds
    buffer_load_dwordx4 v5, s[40:43], s39 offen offset:1024 lds
    buffer_load_dwordx4 v6, s[40:43], s39 offen offset:2048 lds
    buffer_load_dwordx4 v7, s[40:43], s39 offen offset:3072 lds
    s_add_u32 m0, m0, 4096
    s_nop 0
    s_nop 0
    buffer_load_dwordx4 v8, s[40:43], s39 offen offset:0 lds
    s_add_u32 m0, s4, 5120
    s_add_u32 s39, s7, 2211840
    buffer_load_dwordx4 v30, s[40:43], s39 offen lds
    s_add_u32 m0, s5, 5120
    s_add_u32 s39, s7, 2211840
    buffer_load_dwordx4 v31, s[40:43], s39 offen lds
    s_add_u32 m0, s6, 5120
    s_add_u32 s39, s7, 2211840
    buffer_load_dwordx4 v32, s[40:43], s39 offen lds
    v_min_u32 v9, 49, v0
    v_mul_u32_u24 v10, 52, v9
    v_lshrrev_b32_e64 v10, 8, v10
    v_mul_u32_u24 v10, 640, v10
    v_lshl_add_u32 v9, v9, 7, v10
    s_lshl_b32 s39, s38, 4
    s_add_u32 s39, s39, s100
    s_mul_i32 s39, s39, 20
    s_and_b32 s58, s2, 1
    s_add_u32 s39, s39, s58
    s_mul_i32 s39, s39, 640
    v_add_u32 v9, s39, v9
    global_load_dword v14, v9, s[28:29]
    s_setprio 0
    v_mfma_f32_16x16x32_bf16 v[16:19], v[56:59], v[96:99], 0
    v_mfma_f32_16x16x32_bf16 v[36:39], v[56:59], v[100:103], 0
    v_mfma_f32_16x16x32_bf16 v[20:23], v[60:63], v[96:99], 0
    v_mfma_f32_16x16x32_bf16 v[40:43], v[60:63], v[100:103], 0
    v_mfma_f32_16x16x32_bf16 v[24:27], v[64:67], v[96:99], 0
    v_mfma_f32_16x16x32_bf16 v[44:47], v[64:67], v[100:103], 0
    v_mfma_f32_16x16x32_bf16 v[28:31], v[68:71], v[96:99], 0
    v_mfma_f32_16x16x32_bf16 v[48:51], v[68:71], v[100:103], 0
    v_mfma_f32_16x16x32_bf16 v[32:35], v[72:75], v[96:99], 0
    v_mfma_f32_16x16x32_bf16 v[52:55], v[72:75], v[100:103], 0
    v_mfma_f32_16x16x32_bf16 v[16:19], v[76:79], v[104:107], v[16:19]
    ds_read_b64_tr_b16 v[56:57], v2 offset:40960
    v_mfma_f32_16x16x32_bf16 v[36:39], v[76:79], v[108:111], v[36:39]
    ds_read_b64_tr_b16 v[58:59], v2 offset:42240
    v_mfma_f32_16x16x32_bf16 v[20:23], v[80:83], v[104:107], v[20:23]
    ds_read_b64_tr_b16 v[60:61], v2 offset:40968
    v_mfma_f32_16x16x32_bf16 v[40:43], v[80:83], v[108:111], v[40:43]
    ds_read_b64_tr_b16 v[62:63], v2 offset:42248
    v_mfma_f32_16x16x32_bf16 v[24:27], v[84:87], v[104:107], v[24:27]
    ds_read_b64_tr_b16 v[64:65], v2 offset:40976
    v_mfma_f32_16x16x32_bf16 v[44:47], v[84:87], v[108:111], v[44:47]
    ds_read_b64_tr_b16 v[66:67], v2 offset:42256
    v_mfma_f32_16x16x32_bf16 v[28:31], v[88:91], v[104:107], v[28:31]
    ds_read_b64_tr_b16 v[68:69], v2 offset:40984
    v_mfma_f32_16x16x32_bf16 v[48:51], v[88:91], v[108:111], v[48:51]
    ds_read_b64_tr_b16 v[70:71], v2 offset:42264
    v_mfma_f32_16x16x32_bf16 v[32:35], v[92:95], v[104:107], v[32:35]
    ds_read_b64_tr_b16 v[72:73], v2 offset:40992
    v_mfma_f32_16x16x32_bf16 v[52:55], v[92:95], v[108:111], v[52:55]
    ds_read_b64_tr_b16 v[74:75], v2 offset:42272
    s_waitcnt lgkmcnt(8)
    v_mfma_f32_16x16x32_bf16 v[16:19], v[56:59], v[112:115], v[16:19]
    ds_read_b64_tr_b16 v[76:77], v2 offset:35840
    v_mfma_f32_16x16x32_bf16 v[36:39], v[56:59], v[116:119], v[36:39]
    ds_read_b64_tr_b16 v[78:79], v2 offset:37120
    s_waitcnt lgkmcnt(8)
    v_mfma_f32_16x16x32_bf16 v[20:23], v[60:63], v[112:115], v[20:23]
    ds_read_b64_tr_b16 v[80:81], v2 offset:35848
    v_mfma_f32_16x16x32_bf16 v[40:43], v[60:63], v[116:119], v[40:43]
    ds_read_b64_tr_b16 v[82:83], v2 offset:37128
    s_waitcnt lgkmcnt(8)
    v_mfma_f32_16x16x32_bf16 v[24:27], v[64:67], v[112:115], v[24:27]
    ds_read_b64_tr_b16 v[84:85], v2 offset:35856
    v_mfma_f32_16x16x32_bf16 v[44:47], v[64:67], v[116:119], v[44:47]
    ds_read_b64_tr_b16 v[86:87], v2 offset:37136
    s_waitcnt lgkmcnt(8)
    v_mfma_f32_16x16x32_bf16 v[28:31], v[68:71], v[112:115], v[28:31]
    ds_read_b64_tr_b16 v[88:89], v2 offset:35864
    v_mfma_f32_16x16x32_bf16 v[48:51], v[68:71], v[116:119], v[48:51]
    ds_read_b64_tr_b16 v[90:91], v2 offset:37144
    s_waitcnt lgkmcnt(8)
    v_mfma_f32_16x16x32_bf16 v[32:35], v[72:75], v[112:115], v[32:35]
    ds_read_b64_tr_b16 v[92:93], v2 offset:35872
    v_mfma_f32_16x16x32_bf16 v[52:55], v[72:75], v[116:119], v[52:55]
    ds_read_b64_tr_b16 v[94:95], v2 offset:37152
    s_waitcnt lgkmcnt(8)
    v_mfma_f32_16x16x32_bf16 v[16:19], v[76:79], v[120:123], v[16:19]
    ds_read_b64_tr_b16 v[56:57], v2 offset:30720
    v_mfma_f32_16x16x32_bf16 v[36:39], v[76:79], v[124:127], v[36:39]
    ds_read_b64_tr_b16 v[58:59], v2 offset:32000
    s_waitcnt lgkmcnt(8)
    v_mfma_f32_16x16x32_bf16 v[20:23], v[80:83], v[120:123], v[20:23]
    ds_read_b64_tr_b16 v[60:61], v2 offset:30728
    v_mfma_f32_16x16x32_bf16 v[40:43], v[80:83], v[124:127], v[40:43]
    ds_read_b64_tr_b16 v[62:63], v2 offset:32008
    s_waitcnt lgkmcnt(8)
    v_mfma_f32_16x16x32_bf16 v[24:27], v[84:87], v[120:123], v[24:27]
    ds_read_b64_tr_b16 v[64:65], v2 offset:30736
    v_mfma_f32_16x16x32_bf16 v[44:47], v[84:87], v[124:127], v[44:47]
    ds_read_b64_tr_b16 v[66:67], v2 offset:32016
    s_waitcnt lgkmcnt(8)
    v_mfma_f32_16x16x32_bf16 v[28:31], v[88:91], v[120:123], v[28:31]
    ds_read_b64_tr_b16 v[68:69], v2 offset:30744
    v_mfma_f32_16x16x32_bf16 v[48:51], v[88:91], v[124:127], v[48:51]
    ds_read_b64_tr_b16 v[70:71], v2 offset:32024
    s_waitcnt lgkmcnt(8)
    v_mfma_f32_16x16x32_bf16 v[32:35], v[92:95], v[120:123], v[32:35]
    ds_read_b64_tr_b16 v[72:73], v2 offset:30752
    v_mfma_f32_16x16x32_bf16 v[52:55], v[92:95], v[124:127], v[52:55]
    ds_read_b64_tr_b16 v[74:75], v2 offset:32032
    s_waitcnt lgkmcnt(8)
    v_mfma_f32_16x16x32_bf16 v[16:19], v[56:59], v[128:131], v[16:19]
    ds_read_b64_tr_b16 v[76:77], v2 offset:25600
    v_mfma_f32_16x16x32_bf16 v[36:39], v[56:59], v[132:135], v[36:39]
    ds_read_b64_tr_b16 v[78:79], v2 offset:26880
    s_waitcnt lgkmcnt(8)
    v_mfma_f32_16x16x32_bf16 v[20:23], v[60:63], v[128:131], v[20:23]
    ds_read_b64_tr_b16 v[80:81], v2 offset:25608
    v_mfma_f32_16x16x32_bf16 v[40:43], v[60:63], v[132:135], v[40:43]
    ds_read_b64_tr_b16 v[82:83], v2 offset:26888
    s_waitcnt lgkmcnt(8)
    v_mfma_f32_16x16x32_bf16 v[24:27], v[64:67], v[128:131], v[24:27]
    ds_read_b64_tr_b16 v[84:85], v2 offset:25616
    v_mfma_f32_16x16x32_bf16 v[44:47], v[64:67], v[132:135], v[44:47]
    ds_read_b64_tr_b16 v[86:87], v2 offset:26896
    s_waitcnt lgkmcnt(8)
    v_mfma_f32_16x16x32_bf16 v[28:31], v[68:71], v[128:131], v[28:31]
    ds_read_b64_tr_b16 v[88:89], v2 offset:25624
    v_mfma_f32_16x16x32_bf16 v[48:51], v[68:71], v[132:135], v[48:51]
    ds_read_b64_tr_b16 v[90:91], v2 offset:26904
    s_waitcnt lgkmcnt(8)
    v_mfma_f32_16x16x32_bf16 v[32:35], v[72:75], v[128:131], v[32:35]
    ds_read_b64_tr_b16 v[92:93], v2 offset:25632
    v_mfma_f32_16x16x32_bf16 v[52:55], v[72:75], v[132:135], v[52:55]
    ds_read_b64_tr_b16 v[94:95], v2 offset:26912
    s_waitcnt vmcnt(1)
    s_barrier
    s_waitcnt vmcnt(0)
    v_mul_u32_u24 v14, 40, v0
    v_bfe_u32 v3, v0, 2, 2
    v_mul_u32_u24 v12, 3040, v3
    v_lshrrev_b32_e64 v3, 4, v0
    v_mul_u32_u24 v3, 480, v3
    v_sub_u32_e64 v3, v12, v3
    v_add_u32 v3, 2560, v3
    s_xor_b32 s58, s37, 0
    s_mul_i32 s39, s58, 12800
    s_add_u32 s39, s39, 30720
    v_add_u32 v4, s39, v14
    v_add_u32_e64 v5, v4, v3
    s_mul_i32 s58, s58, 2560
    s_add_u32 s54, s58, s69
    s_xor_b32 s58, s37, 1
    s_mul_i32 s39, s58, 12800
    s_add_u32 s39, s39, 30720
    v_add_u32 v6, s39, v14
    v_add_u32 v7, v6, v3
    s_mul_i32 s58, s58, 2560
    s_add_u32 s61, s58, s69
    s_xor_b32 s58, s37, 2
    s_mul_i32 s39, s58, 12800
    s_add_u32 s39, s39, 30720
    v_add_u32 v8, s39, v14
    v_add_u32 v9, v8, v3
    s_mul_i32 s58, s58, 2560
    s_add_u32 s63, s58, s69
    s_xor_b32 s58, s37, 3
    s_mul_i32 s39, s58, 12800
    s_add_u32 s39, s39, 30720
    v_add_u32 v10, s39, v14
    v_add_u32 v11, v10, v3
    s_mul_i32 s58, s58, 2560
    s_add_u32 s68, s58, s69
    v_lshlrev_b32 v12, 4, v0
    v_lshlrev_b32_e64 v13, 3, v0
    s_mov_b32 s52, 20480
    s_mov_b32 s53, 0
    s_waitcnt lgkmcnt(8)
    v_mfma_f32_16x16x32_bf16 v[16:19], v[76:79], v[136:139], v[16:19]
    ds_read_b64_tr_b16 v[56:57], v2 offset:20480
    v_mfma_f32_16x16x32_bf16 v[36:39], v[76:79], v[140:143], v[36:39]
    ds_read_b64_tr_b16 v[58:59], v2 offset:21760
    s_waitcnt lgkmcnt(8)
    v_mfma_f32_16x16x32_bf16 v[20:23], v[80:83], v[136:139], v[20:23]
    ds_read_b64_tr_b16 v[60:61], v2 offset:20488
    v_mfma_f32_16x16x32_bf16 v[40:43], v[80:83], v[140:143], v[40:43]
    ds_read_b64_tr_b16 v[62:63], v2 offset:21768
    s_waitcnt lgkmcnt(8)
    v_mfma_f32_16x16x32_bf16 v[24:27], v[84:87], v[136:139], v[24:27]
    ds_read_b64_tr_b16 v[64:65], v2 offset:20496
    v_mfma_f32_16x16x32_bf16 v[44:47], v[84:87], v[140:143], v[44:47]
    ds_read_b64_tr_b16 v[66:67], v2 offset:21776
    s_waitcnt lgkmcnt(8)
    v_mfma_f32_16x16x32_bf16 v[28:31], v[88:91], v[136:139], v[28:31]
    ds_read_b64_tr_b16 v[68:69], v2 offset:20504
    v_mfma_f32_16x16x32_bf16 v[48:51], v[88:91], v[140:143], v[48:51]
    ds_read_b64_tr_b16 v[70:71], v2 offset:21784
    s_waitcnt lgkmcnt(8)
    v_mfma_f32_16x16x32_bf16 v[32:35], v[92:95], v[136:139], v[32:35]
    ds_read_b64_tr_b16 v[72:73], v2 offset:20512
    v_mfma_f32_16x16x32_bf16 v[52:55], v[92:95], v[140:143], v[52:55]
    ds_read_b64_tr_b16 v[74:75], v2 offset:21792
    s_waitcnt lgkmcnt(8)
    v_mfma_f32_16x16x32_bf16 v[16:19], v[56:59], v[144:147], v[16:19]
    ds_read_b64_tr_b16 v[76:77], v2 offset:15360
    v_mfma_f32_16x16x32_bf16 v[36:39], v[56:59], v[148:151], v[36:39]
    ds_read_b64_tr_b16 v[78:79], v2 offset:16640
    s_waitcnt lgkmcnt(8)
    v_mfma_f32_16x16x32_bf16 v[20:23], v[60:63], v[144:147], v[20:23]
    ds_read_b64_tr_b16 v[80:81], v2 offset:15368
    v_mfma_f32_16x16x32_bf16 v[40:43], v[60:63], v[148:151], v[40:43]
    ds_read_b64_tr_b16 v[82:83], v2 offset:16648
    s_waitcnt lgkmcnt(8)
    v_mfma_f32_16x16x32_bf16 v[24:27], v[64:67], v[144:147], v[24:27]
    ds_read_b64_tr_b16 v[84:85], v2 offset:15376
    v_mfma_f32_16x16x32_bf16 v[44:47], v[64:67], v[148:151], v[44:47]
    ds_read_b64_tr_b16 v[86:87], v2 offset:16656
    s_waitcnt lgkmcnt(8)
    v_mfma_f32_16x16x32_bf16 v[28:31], v[68:71], v[144:147], v[28:31]
    ds_read_b64_tr_b16 v[88:89], v2 offset:15384
    v_mfma_f32_16x16x32_bf16 v[48:51], v[68:71], v[148:151], v[48:51]
    ds_read_b64_tr_b16 v[90:91], v2 offset:16664
    s_waitcnt lgkmcnt(8)
    v_mfma_f32_16x16x32_bf16 v[32:35], v[72:75], v[144:147], v[32:35]
    ds_read_b64_tr_b16 v[92:93], v2 offset:15392
    v_mfma_f32_16x16x32_bf16 v[52:55], v[72:75], v[148:151], v[52:55]
    ds_read_b64_tr_b16 v[94:95], v2 offset:16672
    s_waitcnt lgkmcnt(8)
    v_mfma_f32_16x16x32_bf16 v[16:19], v[76:79], v[152:155], v[16:19]
    ds_read_b64_tr_b16 v[56:57], v2 offset:10240
    v_mfma_f32_16x16x32_bf16 v[36:39], v[76:79], v[156:159], v[36:39]
    ds_read_b64_tr_b16 v[58:59], v2 offset:11520
    s_waitcnt lgkmcnt(8)
    v_mfma_f32_16x16x32_bf16 v[20:23], v[80:83], v[152:155], v[20:23]
    ds_read_b64_tr_b16 v[60:61], v2 offset:10248
    v_mfma_f32_16x16x32_bf16 v[40:43], v[80:83], v[156:159], v[40:43]
    ds_read_b64_tr_b16 v[62:63], v2 offset:11528
    s_waitcnt lgkmcnt(8)
    v_mfma_f32_16x16x32_bf16 v[24:27], v[84:87], v[152:155], v[24:27]
    ds_read_b64_tr_b16 v[64:65], v2 offset:10256
    v_mfma_f32_16x16x32_bf16 v[44:47], v[84:87], v[156:159], v[44:47]
    ds_read_b64_tr_b16 v[66:67], v2 offset:11536
    s_waitcnt lgkmcnt(8)
    v_mfma_f32_16x16x32_bf16 v[28:31], v[88:91], v[152:155], v[28:31]
    ds_read_b64_tr_b16 v[68:69], v2 offset:10264
    v_mfma_f32_16x16x32_bf16 v[48:51], v[88:91], v[156:159], v[48:51]
    ds_read_b64_tr_b16 v[70:71], v2 offset:11544
    s_waitcnt lgkmcnt(8)
    v_mfma_f32_16x16x32_bf16 v[32:35], v[92:95], v[152:155], v[32:35]
    ds_read_b64_tr_b16 v[72:73], v2 offset:10272
    v_mfma_f32_16x16x32_bf16 v[52:55], v[92:95], v[156:159], v[52:55]
    ds_read_b64_tr_b16 v[74:75], v2 offset:11552
    s_waitcnt lgkmcnt(8)
    v_mfma_f32_16x16x32_bf16 v[16:19], v[56:59], v[160:163], v[16:19]
    ds_read_b64_tr_b16 v[76:77], v2 offset:5120
    v_mfma_f32_16x16x32_bf16 v[36:39], v[56:59], v[164:167], v[36:39]
    ds_read_b64_tr_b16 v[78:79], v2 offset:6400
L_wb_0:
    s_cbranch_execz L_wb_1
    s_waitcnt lgkmcnt(8)
    v_mfma_f32_16x16x32_bf16 v[20:23], v[60:63], v[160:163], v[20:23]
    ds_read_b64_tr_b16 v[80:81], v2 offset:5128
    v_mfma_f32_16x16x32_bf16 v[40:43], v[60:63], v[164:167], v[40:43]
    ds_read_b64_tr_b16 v[82:83], v2 offset:6408
    s_waitcnt lgkmcnt(8)
    v_mfma_f32_16x16x32_bf16 v[24:27], v[64:67], v[160:163], v[24:27]
    ds_read_b64_tr_b16 v[84:85], v2 offset:5136
    v_mfma_f32_16x16x32_bf16 v[44:47], v[64:67], v[164:167], v[44:47]
    ds_read_b64_tr_b16 v[86:87], v2 offset:6416
    s_waitcnt lgkmcnt(8)
    v_mfma_f32_16x16x32_bf16 v[28:31], v[68:71], v[160:163], v[28:31]
    ds_read_b64_tr_b16 v[88:89], v2 offset:5144
    v_mfma_f32_16x16x32_bf16 v[48:51], v[68:71], v[164:167], v[48:51]
    ds_read_b64_tr_b16 v[90:91], v2 offset:6424
    s_waitcnt lgkmcnt(8)
    v_mfma_f32_16x16x32_bf16 v[32:35], v[72:75], v[160:163], v[32:35]
    ds_read_b64_tr_b16 v[92:93], v2 offset:5152
    v_mfma_f32_16x16x32_bf16 v[52:55], v[72:75], v[164:167], v[52:55]
    ds_read_b64_tr_b16 v[94:95], v2 offset:6432
    s_waitcnt lgkmcnt(8)
    v_mfma_f32_16x16x32_bf16 v[16:19], v[76:79], v[168:171], v[16:19]
    ds_read_b64_tr_b16 v[56:57], v2 offset:0
    v_mfma_f32_16x16x32_bf16 v[36:39], v[76:79], v[172:175], v[36:39]
    ds_read_b64_tr_b16 v[58:59], v2 offset:1280
    s_waitcnt lgkmcnt(8)
    v_mfma_f32_16x16x32_bf16 v[20:23], v[80:83], v[168:171], v[20:23]
    ds_read_b64_tr_b16 v[60:61], v2 offset:8
    v_mfma_f32_16x16x32_bf16 v[40:43], v[80:83], v[172:175], v[40:43]
    ds_read_b64_tr_b16 v[62:63], v2 offset:1288
    s_waitcnt lgkmcnt(8)
    v_mfma_f32_16x16x32_bf16 v[24:27], v[84:87], v[168:171], v[24:27]
    ds_read_b64_tr_b16 v[64:65], v2 offset:16
    v_mfma_f32_16x16x32_bf16 v[44:47], v[84:87], v[172:175], v[44:47]
    ds_read_b64_tr_b16 v[66:67], v2 offset:1296
    s_waitcnt lgkmcnt(8)
    v_mfma_f32_16x16x32_bf16 v[28:31], v[88:91], v[168:171], v[28:31]
    ds_read_b64_tr_b16 v[68:69], v2 offset:24
    v_mfma_f32_16x16x32_bf16 v[48:51], v[88:91], v[172:175], v[48:51]
    ds_read_b64_tr_b16 v[70:71], v2 offset:1304
    s_waitcnt lgkmcnt(8)
    v_mfma_f32_16x16x32_bf16 v[32:35], v[92:95], v[168:171], v[32:35]
    ds_read_b64_tr_b16 v[72:73], v2 offset:32
    v_mfma_f32_16x16x32_bf16 v[52:55], v[92:95], v[172:175], v[52:55]
    ds_read_b64_tr_b16 v[74:75], v2 offset:1312
    s_waitcnt lgkmcnt(8)
    v_mfma_f32_16x16x32_bf16 v[16:19], v[56:59], v[176:179], v[16:19]
    ds_read_b64_tr_b16 v[76:77], v1 offset:40960
    v_mfma_f32_16x16x32_bf16 v[36:39], v[56:59], v[180:183], v[36:39]
    ds_read_b64_tr_b16 v[78:79], v1 offset:42240
    s_waitcnt lgkmcnt(8)
    v_mfma_f32_16x16x32_bf16 v[20:23], v[60:63], v[176:179], v[20:23]
    ds_read_b64_tr_b16 v[80:81], v1 offset:40968
    v_mfma_f32_16x16x32_bf16 v[40:43], v[60:63], v[180:183], v[40:43]
    ds_read_b64_tr_b16 v[82:83], v1 offset:42248
    s_waitcnt lgkmcnt(8)
    v_mfma_f32_16x16x32_bf16 v[24:27], v[64:67], v[176:179], v[24:27]
    ds_read_b64_tr_b16 v[84:85], v1 offset:40976
    v_mfma_f32_16x16x32_bf16 v[44:47], v[64:67], v[180:183], v[44:47]
    ds_read_b64_tr_b16 v[86:87], v1 offset:42256
    s_waitcnt lgkmcnt(8)
    v_mfma_f32_16x16x32_bf16 v[28:31], v[68:71], v[176:179], v[28:31]
    ds_read_b64_tr_b16 v[88:89], v1 offset:40984
    v_mfma_f32_16x16x32_bf16 v[48:51], v[68:71], v[180:183], v[48:51]
    ds_read_b64_tr_b16 v[90:91], v1 offset:42264
    s_waitcnt lgkmcnt(8)
    v_mfma_f32_16x16x32_bf16 v[32:35], v[72:75], v[176:179], v[32:35]
    ds_read_b64_tr_b16 v[92:93], v1 offset:40992
    v_mfma_f32_16x16x32_bf16 v[52:55], v[72:75], v[180:183], v[52:55]
    ds_read_b64_tr_b16 v[94:95], v1 offset:42272
    s_waitcnt lgkmcnt(8)
    v_mfma_f32_16x16x32_bf16 v[16:19], v[76:79], v[184:187], v[16:19]
    ds_read_b64_tr_b16 v[56:57], v1 offset:35840
    v_mfma_f32_16x16x32_bf16 v[36:39], v[76:79], v[188:191], v[36:39]
    ds_read_b64_tr_b16 v[58:59], v1 offset:37120
    s_waitcnt lgkmcnt(8)
    v_mfma_f32_16x16x32_bf16 v[20:23], v[80:83], v[184:187], v[20:23]
    ds_read_b64_tr_b16 v[60:61], v1 offset:35848
    v_mfma_f32_16x16x32_bf16 v[40:43], v[80:83], v[188:191], v[40:43]
    ds_read_b64_tr_b16 v[62:63], v1 offset:37128
    s_waitcnt lgkmcnt(8)
    v_mfma_f32_16x16x32_bf16 v[24:27], v[84:87], v[184:187], v[24:27]
    ds_read_b64_tr_b16 v[64:65], v1 offset:35856
    v_mfma_f32_16x16x32_bf16 v[44:47], v[84:87], v[188:191], v[44:47]
    ds_read_b64_tr_b16 v[66:67], v1 offset:37136
    s_waitcnt lgkmcnt(8)
    v_mfma_f32_16x16x32_bf16 v[28:31], v[88:91], v[184:187], v[28:31]
    ds_read_b64_tr_b16 v[68:69], v1 offset:35864
    v_mfma_f32_16x16x32_bf16 v[48:51], v[88:91], v[188:191], v[48:51]
    ds_read_b64_tr_b16 v[70:71], v1 offset:37144
    s_waitcnt lgkmcnt(8)
    v_mfma_f32_16x16x32_bf16 v[32:35], v[92:95], v[184:187], v[32:35]
    ds_read_b64_tr_b16 v[72:73], v1 offset:35872
    v_mfma_f32_16x16x32_bf16 v[52:55], v[92:95], v[188:191], v[52:55]
    ds_read_b64_tr_b16 v[74:75], v1 offset:37152
    s_waitcnt lgkmcnt(8)
    v_mfma_f32_16x16x32_bf16 v[16:19], v[56:59], v[192:195], v[16:19]
    ds_read_b64_tr_b16 v[76:77], v1 offset:30720
    v_mfma_f32_16x16x32_bf16 v[36:39], v[56:59], v[196:199], v[36:39]
    ds_read_b64_tr_b16 v[78:79], v1 offset:32000
    s_waitcnt lgkmcnt(8)
    v_mfma_f32_16x16x32_bf16 v[20:23], v[60:63], v[192:195], v[20:23]
    ds_read_b64_tr_b16 v[80:81], v1 offset:30728
    v_mfma_f32_16x16x32_bf16 v[40:43], v[60:63], v[196:199], v[40:43]
    ds_read_b64_tr_b16 v[82:83], v1 offset:32008
    s_waitcnt lgkmcnt(8)
    v_mfma_f32_16x16x32_bf16 v[24:27], v[64:67], v[192:195], v[24:27]
    ds_read_b64_tr_b16 v[84:85], v1 offset:30736
    v_mfma_f32_16x16x32_bf16 v[44:47], v[64:67], v[196:199], v[44:47]
    ds_read_b64_tr_b16 v[86:87], v1 offset:32016
    s_waitcnt lgkmcnt(8)
    v_mfma_f32_16x16x32_bf16 v[28:31], v[68:71], v[192:195], v[28:31]
    ds_read_b64_tr_b16 v[88:89], v1 offset:30744
    v_mfma_f32_16x16x32_bf16 v[48:51], v[68:71], v[196:199], v[48:51]
    ds_read_b64_tr_b16 v[90:91], v1 offset:32024
    s_waitcnt lgkmcnt(8)
    v_mfma_f32_16x16x32_bf16 v[32:35], v[72:75], v[192:195], v[32:35]
    ds_read_b64_tr_b16 v[92:93], v1 offset:30752
    v_mfma_f32_16x16x32_bf16 v[52:55], v[72:75], v[196:199], v[52:55]
    ds_read_b64_tr_b16 v[94:95], v1 offset:32032
    s_waitcnt lgkmcnt(8)
    v_mfma_f32_16x16x32_bf16 v[16:19], v[76:79], v[200:203], v[16:19]
    s_lshl_b32 s39, s38, 2
    v_mfma_f32_16x16x32_bf16 v[36:39], v[76:79], v[204:207], v[36:39]
    s_add_u32 s39, s39, 161664
    s_waitcnt lgkmcnt(6)
    v_mfma_f32_16x16x32_bf16 v[20:23], v[80:83], v[200:203], v[20:23]
    v_mov_b32 v14, s39
    ds_write_b32 v14, v14
    v_mfma_f32_16x16x32_bf16 v[40:43], v[80:83], v[204:207], v[40:43]
    ds_read_b64_tr_b16 v[56:57], v1 offset:25600
    s_waitcnt lgkmcnt(6)
    v_mfma_f32_16x16x32_bf16 v[24:27], v[84:87], v[200:203], v[24:27]
    ds_read_b64_tr_b16 v[58:59], v1 offset:26880
    ds_read_b64_tr_b16 v[60:61], v1 offset:25608
    v_mfma_f32_16x16x32_bf16 v[44:47], v[84:87], v[204:207], v[44:47]
    ds_read_b64_tr_b16 v[62:63], v1 offset:26888
    s_waitcnt lgkmcnt(7)
    v_mfma_f32_16x16x32_bf16 v[28:31], v[88:91], v[200:203], v[28:31]
    ds_read_b64_tr_b16 v[64:65], v1 offset:25616
    v_mfma_f32_16x16x32_bf16 v[48:51], v[88:91], v[204:207], v[48:51]
    ds_read_b64_tr_b16 v[66:67], v1 offset:26896
    ds_read_b64_tr_b16 v[68:69], v1 offset:25624
    s_waitcnt lgkmcnt(8)
    v_mfma_f32_16x16x32_bf16 v[32:35], v[92:95], v[200:203], v[32:35]
    ds_read_b64_tr_b16 v[70:71], v1 offset:26904
    v_mfma_f32_16x16x32_bf16 v[52:55], v[92:95], v[204:207], v[52:55]
    ds_read_b64_tr_b16 v[72:73], v1 offset:25632
    ds_read_b64_tr_b16 v[74:75], v1 offset:26912
    s_waitcnt lgkmcnt(8)
    v_mfma_f32_16x16x32_bf16 v[16:19], v[56:59], v[208:211], v[16:19]
    ds_read_b64_tr_b16 v[76:77], v1 offset:20480
    v_mfma_f32_16x16x32_bf16 v[36:39], v[56:59], v[212:215], v[36:39]
    ds_read_b64_tr_b16 v[78:79], v1 offset:21760
    ds_read_b64_tr_b16 v[80:81], v1 offset:20488
    s_waitcnt lgkmcnt(9)
    v_mfma_f32_16x16x32_bf16 v[20:23], v[60:63], v[208:211], v[20:23]
    ds_read_b64_tr_b16 v[82:83], v1 offset:21768
    v_mfma_f32_16x16x32_bf16 v[40:43], v[60:63], v[212:215], v[40:43]
    ds_read_b64_tr_b16 v[84:85], v1 offset:20496
    ds_read_b64_tr_b16 v[86:87], v1 offset:21776
    s_waitcnt lgkmcnt(10)
    v_mfma_f32_16x16x32_bf16 v[24:27], v[64:67], v[208:211], v[24:27]
    ds_read_b64_tr_b16 v[88:89], v1 offset:20504
    v_mfma_f32_16x16x32_bf16 v[44:47], v[64:67], v[212:215], v[44:47]
    ds_read_b64_tr_b16 v[90:91], v1 offset:21784
    ds_read_b64_tr_b16 v[92:93], v1 offset:20512
    s_waitcnt lgkmcnt(11)
    v_mfma_f32_16x16x32_bf16 v[28:31], v[68:71], v[208:211], v[28:31]
    ds_read_b64_tr_b16 v[94:95], v1 offset:21792
    v_mfma_f32_16x16x32_bf16 v[48:51], v[68:71], v[212:215], v[48:51]
    ds_read_b64_tr_b16 v[96:97], v15 offset:0
    ds_read_b64_tr_b16 v[98:99], v15 offset:160
    s_waitcnt lgkmcnt(12)
    v_mfma_f32_16x16x32_bf16 v[32:35], v[72:75], v[208:211], v[32:35]
    ds_read_b64_tr_b16 v[100:101], v15 offset:320
    v_mfma_f32_16x16x32_bf16 v[52:55], v[72:75], v[212:215], v[52:55]
    ds_read_b64_tr_b16 v[102:103], v15 offset:480
    ds_read_b64_tr_b16 v[104:105], v15 offset:640
    s_waitcnt lgkmcnt(13)
    v_mfma_f32_16x16x32_bf16 v[16:19], v[76:79], v[216:219], v[16:19]
    ds_read_b64_tr_b16 v[56:57], v1 offset:15360
    v_mfma_f32_16x16x32_bf16 v[36:39], v[76:79], v[220:223], v[36:39]
    ds_read_b64_tr_b16 v[58:59], v1 offset:16640
    ds_read_b64_tr_b16 v[60:61], v1 offset:15368
    s_waitcnt lgkmcnt(14)
    v_mfma_f32_16x16x32_bf16 v[20:23], v[80:83], v[216:219], v[20:23]
    ds_read_b64_tr_b16 v[62:63], v1 offset:16648
    v_mfma_f32_16x16x32_bf16 v[40:43], v[80:83], v[220:223], v[40:43]
    ds_read_b64_tr_b16 v[64:65], v1 offset:15376
    ds_read_b64_tr_b16 v[66:67], v1 offset:16656
    s_waitcnt lgkmcnt(15)
    v_mfma_f32_16x16x32_bf16 v[24:27], v[84:87], v[216:219], v[24:27]
    ds_read_b64_tr_b16 v[68:69], v1 offset:15384
    v_mfma_f32_16x16x32_bf16 v[44:47], v[84:87], v[220:223], v[44:47]
    ds_read_b64_tr_b16 v[70:71], v1 offset:16664
    ds_read_b64_tr_b16 v[72:73], v1 offset:15392
    s_waitcnt lgkmcnt(15)
    v_mfma_f32_16x16x32_bf16 v[28:31], v[88:91], v[216:219], v[28:31]
    ds_read_b64_tr_b16 v[74:75], v1 offset:16672
    v_mfma_f32_16x16x32_bf16 v[48:51], v[88:91], v[220:223], v[48:51]
    ds_read_b64_tr_b16 v[106:107], v15 offset:8
    ds_read_b64_tr_b16 v[108:109], v15 offset:168
    s_waitcnt lgkmcnt(15)
    v_mfma_f32_16x16x32_bf16 v[32:35], v[92:95], v[216:219], v[32:35]
    ds_read_b64_tr_b16 v[110:111], v15 offset:328
    v_mfma_f32_16x16x32_bf16 v[52:55], v[92:95], v[220:223], v[52:55]
    ds_read_b64_tr_b16 v[112:113], v15 offset:488
    ds_read_b64_tr_b16 v[114:115], v15 offset:648
    s_waitcnt lgkmcnt(13)
    v_mfma_f32_16x16x32_bf16 v[16:19], v[56:59], v[224:227], v[16:19]
    ds_read_b64_tr_b16 v[76:77], v1 offset:10240
    v_mfma_f32_16x16x32_bf16 v[36:39], v[56:59], v[228:231], v[36:39]
    ds_read_b64_tr_b16 v[78:79], v1 offset:11520
    ds_read_b64_tr_b16 v[80:81], v1 offset:10248
    s_waitcnt lgkmcnt(14)
    v_mfma_f32_16x16x32_bf16 v[20:23], v[60:63], v[224:227], v[20:23]
    ds_read_b64_tr_b16 v[82:83], v1 offset:11528
    v_mfma_f32_16x16x32_bf16 v[40:43], v[60:63], v[228:231], v[40:43]
    ds_read_b64_tr_b16 v[84:85], v1 offset:10256
    ds_read_b64_tr_b16 v[86:87], v1 offset:11536
    s_waitcnt lgkmcnt(15)
    v_mfma_f32_16x16x32_bf16 v[24:27], v[64:67], v[224:227], v[24:27]
    ds_read_b64_tr_b16 v[88:89], v1 offset:10264
    v_mfma_f32_16x16x32_bf16 v[44:47], v[64:67], v[228:231], v[44:47]
    ds_read_b64_tr_b16 v[90:91], v1 offset:11544
    ds_read_b64_tr_b16 v[92:93], v1 offset:10272
    s_waitcnt lgkmcnt(15)
    v_mfma_f32_16x16x32_bf16 v[28:31], v[68:71], v[224:227], v[28:31]
    ds_read_b64_tr_b16 v[94:95], v1 offset:11552
    v_mfma_f32_16x16x32_bf16 v[48:51], v[68:71], v[228:231], v[48:51]
    ds_read_b64_tr_b16 v[116:117], v15 offset:16
    ds_read_b64_tr_b16 v[118:119], v15 offset:176
    s_waitcnt lgkmcnt(15)
    v_mfma_f32_16x16x32_bf16 v[32:35], v[72:75], v[224:227], v[32:35]
    ds_read_b64_tr_b16 v[120:121], v15 offset:336
    v_mfma_f32_16x16x32_bf16 v[52:55], v[72:75], v[228:231], v[52:55]
    ds_read_b64_tr_b16 v[122:123], v15 offset:496
    ds_read_b64_tr_b16 v[124:125], v15 offset:656
    s_waitcnt lgkmcnt(13)
    v_mfma_f32_16x16x32_bf16 v[16:19], v[76:79], v[232:235], v[16:19]
    ds_read_b64_tr_b16 v[56:57], v1 offset:5120
    v_mfma_f32_16x16x32_bf16 v[36:39], v[76:79], v[236:239], v[36:39]
    ds_read_b64_tr_b16 v[58:59], v1 offset:6400
    ds_read_b64_tr_b16 v[60:61], v1 offset:5128
    s_waitcnt lgkmcnt(14)
    v_mfma_f32_16x16x32_bf16 v[20:23], v[80:83], v[232:235], v[20:23]
    ds_read_b64_tr_b16 v[62:63], v1 offset:6408
    v_mfma_f32_16x16x32_bf16 v[40:43], v[80:83], v[236:239], v[40:43]
    ds_read_b64_tr_b16 v[64:65], v1 offset:5136
    ds_read_b64_tr_b16 v[66:67], v1 offset:6416
    s_waitcnt lgkmcnt(15)
    v_mfma_f32_16x16x32_bf16 v[24:27], v[84:87], v[232:235], v[24:27]
    ds_read_b64_tr_b16 v[68:69], v1 offset:5144
    v_mfma_f32_16x16x32_bf16 v[44:47], v[84:87], v[236:239], v[44:47]
    ds_read_b64_tr_b16 v[70:71], v1 offset:6424
    ds_read_b64_tr_b16 v[72:73], v1 offset:5152
    s_waitcnt lgkmcnt(15)
    v_mfma_f32_16x16x32_bf16 v[28:31], v[88:91], v[232:235], v[28:31]
    ds_read_b64_tr_b16 v[74:75], v1 offset:6432
    v_mfma_f32_16x16x32_bf16 v[48:51], v[88:91], v[236:239], v[48:51]
    ds_read_b64_tr_b16 v[126:127], v15 offset:24
    ds_read_b64_tr_b16 v[128:129], v15 offset:184
    s_waitcnt lgkmcnt(15)
    v_mfma_f32_16x16x32_bf16 v[32:35], v[92:95], v[232:235], v[32:35]
    ds_read_b64_tr_b16 v[130:131], v15 offset:344
    v_mfma_f32_16x16x32_bf16 v[52:55], v[92:95], v[236:239], v[52:55]
    ds_read_b64_tr_b16 v[132:133], v15 offset:504
    ds_read_b64_tr_b16 v[134:135], v15 offset:664
    s_waitcnt lgkmcnt(13)
    v_mfma_f32_16x16x32_bf16 v[16:19], v[56:59], v[240:243], v[16:19]
    ds_read_b64_tr_b16 v[76:77], v1 offset:0
    v_mfma_f32_16x16x32_bf16 v[36:39], v[56:59], v[244:247], v[36:39]
    ds_read_b64_tr_b16 v[78:79], v1 offset:1280
    ds_read_b64_tr_b16 v[80:81], v1 offset:8
    s_waitcnt lgkmcnt(14)
    v_mfma_f32_16x16x32_bf16 v[20:23], v[60:63], v[240:243], v[20:23]
    ds_read_b64_tr_b16 v[82:83], v1 offset:1288
    v_mfma_f32_16x16x32_bf16 v[40:43], v[60:63], v[244:247], v[40:43]
    ds_read_b64_tr_b16 v[84:85], v1 offset:16
    ds_read_b64_tr_b16 v[86:87], v1 offset:1296
    s_waitcnt lgkmcnt(15)
    v_mfma_f32_16x16x32_bf16 v[24:27], v[64:67], v[240:243], v[24:27]
    ds_read_b64_tr_b16 v[88:89], v1 offset:24
    v_mfma_f32_16x16x32_bf16 v[44:47], v[64:67], v[244:247], v[44:47]
    ds_read_b64_tr_b16 v[90:91], v1 offset:1304
    ds_read_b64_tr_b16 v[92:93], v1 offset:32
    s_waitcnt lgkmcnt(15)
    v_mfma_f32_16x16x32_bf16 v[28:31], v[68:71], v[240:243], v[28:31]
    ds_read_b64_tr_b16 v[94:95], v1 offset:1312
    v_mfma_f32_16x16x32_bf16 v[48:51], v[68:71], v[244:247], v[48:51]
    ds_read_b64_tr_b16 v[136:137], v15 offset:32
    ds_read_b64_tr_b16 v[138:139], v15 offset:192
    s_waitcnt lgkmcnt(15)
    v_mfma_f32_16x16x32_bf16 v[32:35], v[72:75], v[240:243], v[32:35]
    ds_read_b64_tr_b16 v[140:141], v15 offset:352
    v_mfma_f32_16x16x32_bf16 v[52:55], v[72:75], v[244:247], v[52:55]
    ds_read_b64_tr_b16 v[142:143], v15 offset:512
    ds_read_b64_tr_b16 v[144:145], v15 offset:672
    s_waitcnt lgkmcnt(13)
    v_mfma_f32_16x16x32_bf16 v[16:19], v[76:79], v[248:251], v[16:19]
    s_waitcnt lgkmcnt(11)
    v_mfma_f32_16x16x32_bf16 v[20:23], v[80:83], v[248:251], v[20:23]
    s_waitcnt lgkmcnt(9)
    v_mfma_f32_16x16x32_bf16 v[24:27], v[84:87], v[248:251], v[24:27]
    s_waitcnt lgkmcnt(7)
    v_mfma_f32_16x16x32_bf16 v[28:31], v[88:91], v[248:251], v[28:31]
    s_waitcnt lgkmcnt(5)
    v_mfma_f32_16x16x32_bf16 v[32:35], v[92:95], v[248:251], v[32:35]
    v_mfma_f32_16x16x32_bf16 v[36:39], v[76:79], v[252:255], v[36:39]
    v_mfma_f32_16x16x32_bf16 v[40:43], v[80:83], v[252:255], v[40:43]
    v_mfma_f32_16x16x32_bf16 v[44:47], v[84:87], v[252:255], v[44:47]
    v_mfma_f32_16x16x32_bf16 v[48:51], v[88:91], v[252:255], v[48:51]
    v_mfma_f32_16x16x32_bf16 v[52:55], v[92:95], v[252:255], v[52:55]
    v_and_b32 v200, 15, v0
    v_lshrrev_b32 v201, 4, v0
    v_lshrrev_b32 v202, 2, v200
    v_and_b32 v203, 3, v0
    v_cmp_eq_u32 vcc, 0, v203
    v_mul_u32_u24 v200, 80, v200
    v_add_u32 v200, 133120, v200
    v_cndmask_b32_e64 v202, 4, v202, vcc
    v_cvt_pk_bf16_f32 v16, v16, v17
    v_cvt_pk_bf16_f32 v17, v18, v19
    v_cvt_pk_bf16_f32 v18, v20, v21
    v_cvt_pk_bf16_f32 v19, v22, v23
    v_cvt_pk_bf16_f32 v20, v24, v25
    v_cvt_pk_bf16_f32 v21, v26, v27
    v_cvt_pk_bf16_f32 v22, v28, v29
    v_cvt_pk_bf16_f32 v23, v30, v31
    v_cvt_pk_bf16_f32 v24, v32, v33
    v_cvt_pk_bf16_f32 v25, v34, v35
    v_mfma_f32_16x16x32_bf16 v[148:151], v[96:99], v[16:19], 0
    v_cvt_pk_bf16_f32 v36, v36, v37
    v_mfma_f32_16x16x32_bf16 v[152:155], v[106:109], v[16:19], 0
    v_cvt_pk_bf16_f32 v37, v38, v39
    v_mfma_f32_16x16x32_bf16 v[156:159], v[116:119], v[16:19], 0
    v_cvt_pk_bf16_f32 v38, v40, v41
    v_mfma_f32_16x16x32_bf16 v[160:163], v[126:129], v[16:19], 0
    v_cvt_pk_bf16_f32 v39, v42, v43
    s_waitcnt lgkmcnt(3)
    v_mfma_f32_16x16x32_bf16 v[164:167], v[136:139], v[16:19], 0
    v_cvt_pk_bf16_f32 v40, v44, v45
    v_mfma_f32_16x16x32_bf16 v[148:151], v[100:103], v[20:23], v[148:151]
    v_cvt_pk_bf16_f32 v41, v46, v47
    v_mfma_f32_16x16x32_bf16 v[152:155], v[110:113], v[20:23], v[152:155]
    v_cvt_pk_bf16_f32 v42, v48, v49
    v_mfma_f32_16x16x32_bf16 v[156:159], v[120:123], v[20:23], v[156:159]
    v_cvt_pk_bf16_f32 v43, v50, v51
    v_mfma_f32_16x16x32_bf16 v[160:163], v[130:133], v[20:23], v[160:163]
    v_cvt_pk_bf16_f32 v44, v52, v53
    s_waitcnt lgkmcnt(1)
    v_mfma_f32_16x16x32_bf16 v[164:167], v[140:143], v[20:23], v[164:167]
    v_cvt_pk_bf16_f32 v45, v54, v55
    v_mfma_f32_16x16x16_bf16 v[148:151], v[104:105], v[24:25], v[148:151]
    v_mul_u32_u24 v202, 80, v202
    v_mfma_f32_16x16x16_bf16 v[152:155], v[114:115], v[24:25], v[152:155]
    v_add_u32 v202, 134400, v202
    v_mfma_f32_16x16x16_bf16 v[156:159], v[124:125], v[24:25], v[156:159]
    v_lshl_add_u32 v196, v201, 4, v200
    v_mfma_f32_16x16x16_bf16 v[160:163], v[134:135], v[24:25], v[160:163]
    v_lshl_add_u32 v197, v201, 4, v202
    s_waitcnt lgkmcnt(0)
    v_mfma_f32_16x16x16_bf16 v[164:167], v[144:145], v[24:25], v[164:167]
    v_lshl_add_u32 v198, v201, 2, v200
    v_lshl_add_u32 v199, v201, 2, v202
    v_mov_b32 v213, 0
    v_mov_b32 v219, 0
    v_mov_b32 v225, 0
    v_mov_b32 v231, 0
    v_mov_b32 v237, 0
    v_mov_b32 v243, 0
    v_mov_b32 v249, 0
    v_mov_b32_e64 v255, 0
    v_max3_f32 v188, v148, v149, v150
    v_max3_f32 v188, v151, v152, v188
    v_max3_f32 v188, v153, v154, v188
    v_max3_f32 v188, v155, v156, v188
    v_max3_f32 v188, v157, v158, v188
    v_max3_f32 v188, v159, v160, v188
    v_max3_f32 v188, v161, v162, v188
    v_max3_f32 v188, v163, v164, v188
    v_max3_f32 v188, v165, v166, v188
    v_max_f32 v188, v167, v188
    v_mul_f32 v188, s56, v188
    v_pk_fma_f32 v[56:57], v[148:149], s[56:57], v[188:189] op_sel_hi:[1,1,0] neg_lo:[0,0,1] neg_hi:[0,0,1]
    v_pk_fma_f32 v[58:59], v[150:151], s[56:57], v[188:189] op_sel_hi:[1,1,0] neg_lo:[0,0,1] neg_hi:[0,0,1]
    v_pk_fma_f32 v[60:61], v[152:153], s[56:57], v[188:189] op_sel_hi:[1,1,0] neg_lo:[0,0,1] neg_hi:[0,0,1]
    v_pk_fma_f32 v[62:63], v[154:155], s[56:57], v[188:189] op_sel_hi:[1,1,0] neg_lo:[0,0,1] neg_hi:[0,0,1]
    v_pk_fma_f32 v[64:65], v[156:157], s[56:57], v[188:189] op_sel_hi:[1,1,0] neg_lo:[0,0,1] neg_hi:[0,0,1]
    v_pk_fma_f32 v[66:67], v[158:159], s[56:57], v[188:189] op_sel_hi:[1,1,0] neg_lo:[0,0,1] neg_hi:[0,0,1]
    v_pk_fma_f32 v[68:69], v[160:161], s[56:57], v[188:189] op_sel_hi:[1,1,0] neg_lo:[0,0,1] neg_hi:[0,0,1]
    v_pk_fma_f32 v[70:71], v[162:163], s[56:57], v[188:189] op_sel_hi:[1,1,0] neg_lo:[0,0,1] neg_hi:[0,0,1]
    v_pk_fma_f32 v[72:73], v[164:165], s[56:57], v[188:189] op_sel_hi:[1,1,0] neg_lo:[0,0,1] neg_hi:[0,0,1]
    v_pk_fma_f32 v[74:75], v[166:167], s[56:57], v[188:189] op_sel_hi:[1,1,0] neg_lo:[0,0,1] neg_hi:[0,0,1]
    v_exp_f32 v56, v56
    v_exp_f32 v57, v57
    v_exp_f32 v58, v58
    v_exp_f32 v59, v59
    v_exp_f32 v60, v60
    v_exp_f32 v61, v61
    v_pk_add_f32 v[192:193], v[56:57], v[58:59]
    v_exp_f32 v62, v62
    v_exp_f32 v63, v63
    v_pk_add_f32 v[192:193], v[192:193], v[60:61]
    v_exp_f32 v64, v64
    v_exp_f32 v65, v65
    v_pk_add_f32 v[192:193], v[192:193], v[62:63]
    v_exp_f32 v66, v66
    v_exp_f32 v67, v67
    v_pk_add_f32 v[192:193], v[192:193], v[64:65]
    v_exp_f32 v68, v68
    v_exp_f32 v69, v69
    v_pk_add_f32 v[192:193], v[192:193], v[66:67]
    v_exp_f32 v70, v70
    v_exp_f32 v71, v71
    v_pk_add_f32 v[192:193], v[192:193], v[68:69]
    v_exp_f32 v72, v72
    v_exp_f32 v73, v73
    v_pk_add_f32 v[192:193], v[192:193], v[70:71]
    v_exp_f32 v74, v74
    v_exp_f32 v75, v75
    v_pk_add_f32 v[192:193], v[192:193], v[72:73]
    v_rcp_f32 v76, v56
    v_rcp_f32 v77, v57
    v_pk_add_f32 v[192:193], v[192:193], v[74:75]
    v_add_f32 v192, v192, v193
    v_rcp_f32 v78, v58
    v_rcp_f32 v79, v59
    v_rcp_f32 v80, v60
    v_rcp_f32_e64 v81, v61
    v_pk_add_f32 v[194:195], v[76:77], v[78:79]
    v_rcp_f32 v82, v62
    v_rcp_f32 v83, v63
    v_pk_add_f32 v[194:195], v[194:195], v[80:81]
    v_cvt_pk_bf16_f32 v208, v56, v57
    v_rcp_f32 v84, v64
    v_rcp_f32 v85, v65
    v_pk_add_f32 v[194:195], v[194:195], v[82:83]
    v_cvt_pk_bf16_f32 v209, v58, v59
    v_rcp_f32 v86, v66
    v_rcp_f32 v87, v67
    v_pk_add_f32 v[194:195], v[194:195], v[84:85]
    v_cvt_pk_bf16_f32 v210, v60, v61
    v_rcp_f32 v88, v68
    v_rcp_f32 v89, v69
    v_pk_add_f32 v[194:195], v[194:195], v[86:87]
    v_cvt_pk_bf16_f32 v211, v62, v63
    v_rcp_f32 v90, v70
    v_rcp_f32 v91, v71
    v_pk_add_f32 v[194:195], v[194:195], v[88:89]
    v_cvt_pk_bf16_f32 v214, v64, v65
    v_rcp_f32 v92, v72
    v_rcp_f32 v93, v73
    v_pk_add_f32 v[194:195], v[194:195], v[90:91]
    v_cvt_pk_bf16_f32 v215, v66, v67
    v_rcp_f32 v94, v74
    v_rcp_f32 v95, v75
    v_pk_add_f32 v[194:195], v[194:195], v[92:93]
    v_cvt_pk_bf16_f32 v216, v68, v69
    v_cvt_pk_bf16_f32 v217, v70, v71
    v_pk_add_f32 v[194:195], v[194:195], v[94:95]
    v_add_f32_e64 v194, v194, v195
    v_cmp_ngt_f32 vcc, 0x71800000, v194
    v_cvt_pk_bf16_f32 v220, v72, v73
    v_cvt_pk_bf16_f32 v221, v74, v75
    s_nop 2
    s_cbranch_vccnz L_q0_fix
L_q0_ok:
    v_rcp_f32 v190, v194
    s_nop 0
    v_mul_f32_e64 v190, v190, v192
    v_pk_mul_f32 v[76:77], v[76:77], v[190:191] op_sel_hi:[1,0]
    v_cvt_pk_bf16_f32 v222, v76, v77
    v_pk_mul_f32 v[78:79], v[78:79], v[190:191] op_sel_hi:[1,0]
    v_cvt_pk_bf16_f32 v223, v78, v79
    v_pk_mul_f32 v[80:81], v[80:81], v[190:191] op_sel_hi:[1,0]
    v_cvt_pk_bf16_f32 v226, v80, v81
    v_pk_mul_f32 v[82:83], v[82:83], v[190:191] op_sel_hi:[1,0]
    v_cvt_pk_bf16_f32 v227, v82, v83
    v_pk_mul_f32 v[84:85], v[84:85], v[190:191] op_sel_hi:[1,0]
    v_cvt_pk_bf16_f32 v228, v84, v85
    v_pk_mul_f32 v[86:87], v[86:87], v[190:191] op_sel_hi:[1,0]
    v_cvt_pk_bf16_f32 v229, v86, v87
    v_pk_mul_f32 v[88:89], v[88:89], v[190:191] op_sel_hi:[1,0]
    v_cvt_pk_bf16_f32 v212, v88, v89
    v_pk_mul_f32 v[90:91], v[90:91], v[190:191] op_sel_hi:[1,0]
    v_cvt_pk_bf16_f32 v218, v90, v91
    v_pk_mul_f32 v[92:93], v[92:93], v[190:191] op_sel_hi:[1,0]
    v_cvt_pk_bf16_f32 v224, v92, v93
    v_pk_mul_f32 v[94:95], v[94:95], v[190:191] op_sel_hi:[1,0]
    v_cvt_pk_bf16_f32 v230, v94, v95
    v_mfma_f32_16x16x32_bf16 v[168:171], v[96:99], v[36:39], 0
    v_mfma_f32_16x16x32_bf16 v[172:175], v[106:109], v[36:39], 0
    v_permlane32_swap_b32 v208, v220
    v_mfma_f32_16x16x32_bf16 v[176:179], v[116:119], v[36:39], 0
    v_permlane32_swap_b32 v214, v226
    v_mfma_f32_16x16x32_bf16 v[180:183], v[126:129], v[36:39], 0
    v_permlane32_swap_b32 v209, v221
    v_mfma_f32_16x16x32_bf16 v[184:187], v[136:139], v[36:39], 0
    v_permlane32_swap_b32 v215, v227
    v_mfma_f32_16x16x32_bf16 v[168:171], v[100:103], v[40:43], v[168:171]
    v_permlane32_swap_b32 v210, v222
    v_mfma_f32_16x16x32_bf16 v[172:175], v[110:113], v[40:43], v[172:175]
    v_permlane32_swap_b32 v216, v228
    v_mfma_f32_16x16x32_bf16 v[176:179], v[120:123], v[40:43], v[176:179]
    v_permlane32_swap_b32 v211, v223
    v_mfma_f32_16x16x32_bf16 v[180:183], v[130:133], v[40:43], v[180:183]
    v_permlane32_swap_b32 v217, v229
    v_mfma_f32_16x16x32_bf16 v[184:187], v[140:143], v[40:43], v[184:187]
    v_permlane32_swap_b32 v212, v224
    v_mfma_f32_16x16x16_bf16 v[168:171], v[104:105], v[44:45], v[168:171]
    v_permlane32_swap_b32 v218, v230
    v_mfma_f32_16x16x16_bf16 v[172:175], v[114:115], v[44:45], v[172:175]
    v_permlane16_swap_b32 v208, v214
    v_mfma_f32_16x16x16_bf16 v[176:179], v[124:125], v[44:45], v[176:179]
    v_permlane16_swap_b32 v220, v226
    v_mfma_f32_16x16x16_bf16 v[180:183], v[134:135], v[44:45], v[180:183]
    v_permlane16_swap_b32 v209, v215
    v_mfma_f32_16x16x16_bf16 v[184:187], v[144:145], v[44:45], v[184:187]
    v_permlane16_swap_b32 v221, v227
    v_permlane16_swap_b32 v210, v216
    v_permlane16_swap_b32 v222, v228
    v_permlane16_swap_b32 v211, v217
    v_permlane16_swap_b32 v223, v229
    v_permlane16_swap_b32 v212, v218
    v_permlane16_swap_b32 v224, v230
    v_max3_f32 v188, v168, v169, v170
    v_max3_f32 v188, v171, v172, v188
    v_max3_f32 v188, v173, v174, v188
    v_max3_f32 v188, v175, v176, v188
    v_max3_f32 v188, v177, v178, v188
    v_max3_f32 v188, v179, v180, v188
    v_max3_f32 v188, v181, v182, v188
    v_max3_f32 v188, v183, v184, v188
    v_max3_f32 v188, v185, v186, v188
    v_max_f32 v188, v187, v188
    v_mul_f32 v188, s56, v188
    v_pk_fma_f32 v[56:57], v[168:169], s[56:57], v[188:189] op_sel_hi:[1,1,0] neg_lo:[0,0,1] neg_hi:[0,0,1]
    v_pk_fma_f32 v[58:59], v[170:171], s[56:57], v[188:189] op_sel_hi:[1,1,0] neg_lo:[0,0,1] neg_hi:[0,0,1]
    v_pk_fma_f32 v[60:61], v[172:173], s[56:57], v[188:189] op_sel_hi:[1,1,0] neg_lo:[0,0,1] neg_hi:[0,0,1]
    v_pk_fma_f32 v[62:63], v[174:175], s[56:57], v[188:189] op_sel_hi:[1,1,0] neg_lo:[0,0,1] neg_hi:[0,0,1]
    v_pk_fma_f32 v[64:65], v[176:177], s[56:57], v[188:189] op_sel_hi:[1,1,0] neg_lo:[0,0,1] neg_hi:[0,0,1]
    v_pk_fma_f32 v[66:67], v[178:179], s[56:57], v[188:189] op_sel_hi:[1,1,0] neg_lo:[0,0,1] neg_hi:[0,0,1]
    v_pk_fma_f32 v[68:69], v[180:181], s[56:57], v[188:189] op_sel_hi:[1,1,0] neg_lo:[0,0,1] neg_hi:[0,0,1]
    v_pk_fma_f32 v[70:71], v[182:183], s[56:57], v[188:189] op_sel_hi:[1,1,0] neg_lo:[0,0,1] neg_hi:[0,0,1]
    v_pk_fma_f32 v[72:73], v[184:185], s[56:57], v[188:189] op_sel_hi:[1,1,0] neg_lo:[0,0,1] neg_hi:[0,0,1]
    v_pk_fma_f32 v[74:75], v[186:187], s[56:57], v[188:189] op_sel_hi:[1,1,0] neg_lo:[0,0,1] neg_hi:[0,0,1]
    v_exp_f32 v56, v56
    v_exp_f32 v57, v57
    v_exp_f32 v58, v58
    v_exp_f32 v59, v59
    v_exp_f32 v60, v60
    v_exp_f32 v61, v61
    v_pk_add_f32 v[192:193], v[56:57], v[58:59]
    v_exp_f32 v62, v62
    v_exp_f32 v63, v63
    v_pk_add_f32 v[192:193], v[192:193], v[60:61]
    v_exp_f32 v64, v64
    v_exp_f32 v65, v65
    v_pk_add_f32 v[192:193], v[192:193], v[62:63]
    v_exp_f32 v66, v66
    v_exp_f32 v67, v67
    v_pk_add_f32 v[192:193], v[192:193], v[64:65]
    v_exp_f32 v68, v68
    v_exp_f32 v69, v69
    v_pk_add_f32 v[192:193], v[192:193], v[66:67]
    v_exp_f32 v70, v70
    v_exp_f32 v71, v71
    v_pk_add_f32 v[192:193], v[192:193], v[68:69]
    v_exp_f32 v72, v72
    v_exp_f32 v73, v73
    v_pk_add_f32 v[192:193], v[192:193], v[70:71]
    v_exp_f32 v74, v74
    v_exp_f32 v75, v75
    v_pk_add_f32 v[192:193], v[192:193], v[72:73]
    v_rcp_f32 v76, v56
    v_rcp_f32 v77, v57
    v_pk_add_f32 v[192:193], v[192:193], v[74:75]
    v_add_f32 v192, v192, v193
    v_rcp_f32 v78, v58
    v_rcp_f32 v79, v59
    v_rcp_f32 v80, v60
    v_rcp_f32_e64 v81, v61
    v_pk_add_f32 v[194:195], v[76:77], v[78:79]
    v_rcp_f32 v82, v62
    v_rcp_f32 v83, v63
    v_pk_add_f32 v[194:195], v[194:195], v[80:81]
    v_cvt_pk_bf16_f32 v232, v56, v57
    v_rcp_f32 v84, v64
    v_rcp_f32 v85, v65
    v_pk_add_f32 v[194:195], v[194:195], v[82:83]
    v_cvt_pk_bf16_f32 v233, v58, v59
    v_rcp_f32 v86, v66
    v_rcp_f32 v87, v67
    v_pk_add_f32 v[194:195], v[194:195], v[84:85]
    v_cvt_pk_bf16_f32 v234, v60, v61
    v_rcp_f32 v88, v68
    v_rcp_f32 v89, v69
    v_pk_add_f32 v[194:195], v[194:195], v[86:87]
    v_cvt_pk_bf16_f32 v235, v62, v63
L_wb_1:
    s_cbranch_execz L_wb_2
    v_rcp_f32 v90, v70
    v_rcp_f32_e64 v91, v71
    v_pk_add_f32 v[194:195], v[194:195], v[88:89]
    v_cvt_pk_bf16_f32 v238, v64, v65
    v_rcp_f32 v92, v72
    v_rcp_f32 v93, v73
    v_pk_add_f32 v[194:195], v[194:195], v[90:91]
    v_cvt_pk_bf16_f32 v239, v66, v67
    v_rcp_f32 v94, v74
    v_rcp_f32 v95, v75
    v_pk_add_f32 v[194:195], v[194:195], v[92:93]
    v_cvt_pk_bf16_f32 v240, v68, v69
    v_cvt_pk_bf16_f32 v241, v70, v71
    v_pk_add_f32 v[194:195], v[194:195], v[94:95]
    v_add_f32_e64 v194, v194, v195
    v_cmp_ngt_f32 vcc, 0x71800000, v194
    v_cvt_pk_bf16_f32 v244, v72, v73
    v_cvt_pk_bf16_f32 v245, v74, v75
    s_nop 2
    s_cbranch_vccnz L_q1_fix
L_q1_ok:
    v_rcp_f32 v190, v194
    s_nop 0
    v_mul_f32_e64 v190, v190, v192
    v_pk_mul_f32 v[76:77], v[76:77], v[190:191] op_sel_hi:[1,0]
    v_cvt_pk_bf16_f32 v246, v76, v77
    v_pk_mul_f32 v[78:79], v[78:79], v[190:191] op_sel_hi:[1,0]
    v_cvt_pk_bf16_f32 v247, v78, v79
    v_pk_mul_f32 v[80:81], v[80:81], v[190:191] op_sel_hi:[1,0]
    v_cvt_pk_bf16_f32 v250, v80, v81
    v_pk_mul_f32 v[82:83], v[82:83], v[190:191] op_sel_hi:[1,0]
    v_cvt_pk_bf16_f32 v251, v82, v83
    v_pk_mul_f32 v[84:85], v[84:85], v[190:191] op_sel_hi:[1,0]
    v_cvt_pk_bf16_f32 v252, v84, v85
    v_pk_mul_f32 v[86:87], v[86:87], v[190:191] op_sel_hi:[1,0]
    v_cvt_pk_bf16_f32 v253, v86, v87
    v_pk_mul_f32 v[88:89], v[88:89], v[190:191] op_sel_hi:[1,0]
    v_cvt_pk_bf16_f32 v236, v88, v89
    v_pk_mul_f32 v[90:91], v[90:91], v[190:191] op_sel_hi:[1,0]
    v_cvt_pk_bf16_f32 v242, v90, v91
    v_pk_mul_f32 v[92:93], v[92:93], v[190:191] op_sel_hi:[1,0]
    v_cvt_pk_bf16_f32 v248, v92, v93
    v_pk_mul_f32 v[94:95], v[94:95], v[190:191] op_sel_hi:[1,0]
    v_cvt_pk_bf16_f32 v254, v94, v95
    v_permlane32_swap_b32 v232, v244
    v_permlane32_swap_b32 v238, v250
    v_permlane32_swap_b32 v233, v245
    v_permlane32_swap_b32 v239, v251
    v_permlane32_swap_b32 v234, v246
    v_permlane32_swap_b32 v240, v252
    v_permlane32_swap_b32 v235, v247
    v_permlane32_swap_b32 v241, v253
    v_permlane32_swap_b32 v236, v248
    v_permlane32_swap_b32 v242, v254
    v_permlane16_swap_b32 v232, v238
    v_permlane16_swap_b32 v244, v250
    v_permlane16_swap_b32 v233, v239
    v_permlane16_swap_b32 v245, v251
    v_permlane16_swap_b32 v234, v240
    v_permlane16_swap_b32 v246, v252
    v_permlane16_swap_b32 v235, v241
    v_permlane16_swap_b32 v247, v253
    v_permlane16_swap_b32 v236, v242
    v_permlane16_swap_b32 v248, v254
    v_mov_b32 v181, 0
    v_mov_b32 v183, 0
    v_mov_b32 v185, 0
    v_mov_b32 v187, 0
    v_mov_b32 v189, 0
    v_mov_b32 v191, 0
    v_mov_b32 v193, 0
    v_mov_b32 v195, 0
    s_add_u32 s58, s54, 20480
    s_barrier
    s_setprio 1
    ds_read_b128 v[152:155], v197 offset:0
    ds_read_b32 v182, v199 offset:64
    ds_read_b128 v[148:151], v196 offset:0
    ds_read_b32 v180, v198 offset:64
    ds_read_b128 v[160:163], v197 offset:6144
    ds_read_b32 v186, v199 offset:6208
    ds_read_b128 v[156:159], v196 offset:6144
    ds_read_b32 v184, v198 offset:6208
    s_waitcnt lgkmcnt(7)
    v_mfma_f32_16x16x32_bf16 v[20:23], v[152:155], v[208:211], 0
    ds_read_b128 v[168:171], v197 offset:12288
    s_waitcnt lgkmcnt(6)
    v_mfma_f32_16x16x32_bf16 v[16:19], v[148:151], v[208:211], 0
    ds_read_b32 v190, v199 offset:12352
    s_waitcnt lgkmcnt(5)
    v_mfma_f32_16x16x32_bf16 v[28:31], v[160:163], v[214:217], 0
    ds_read_b128 v[164:167], v196 offset:12288
    s_waitcnt lgkmcnt(4)
    v_mfma_f32_16x16x32_bf16 v[24:27], v[156:159], v[214:217], 0
    ds_read_b32 v188, v198 offset:12352
    v_mfma_f32_16x16x16_bf16 v[20:23], v[182:183], v[212:213], v[20:23]
    ds_read_b128 v[176:179], v197 offset:18432
    v_mfma_f32_16x16x16_bf16 v[16:19], v[180:181], v[212:213], v[16:19]
    ds_read_b32 v194, v199 offset:18496
    v_mfma_f32_16x16x16_bf16 v[28:31], v[186:187], v[218:219], v[28:31]
    ds_read_b128 v[172:175], v196 offset:18432
    s_waitcnt lgkmcnt(7)
    v_mfma_f32_16x16x16_bf16 v[24:27], v[184:185], v[218:219], v[24:27]
    ds_read_b32 v192, v198 offset:18496
    s_waitcnt lgkmcnt(7)
    v_mfma_f32_16x16x32_bf16 v[36:39], v[168:171], v[220:223], 0
    s_waitcnt lgkmcnt(5)
    v_mfma_f32_16x16x32_bf16 v[32:35], v[164:167], v[220:223], 0
    s_waitcnt lgkmcnt(3)
    v_mfma_f32_16x16x32_bf16 v[44:47], v[176:179], v[226:229], 0
    s_waitcnt lgkmcnt(1)
    v_mfma_f32_16x16x32_bf16 v[40:43], v[172:175], v[226:229], 0
    v_rcp_f32 v21, v21
    v_rcp_f32 v29, v29
    v_mul_f32 v20, v20, v21
    v_mfma_f32_16x16x16_bf16 v[36:39], v[190:191], v[224:225], v[36:39]
    v_mul_f32 v16, v16, v21
    v_mul_f32 v17, v17, v21
    v_mul_f32 v18, v18, v21
    v_mul_f32 v19, v19, v21
    v_mfma_f32_16x16x16_bf16 v[32:35], v[188:189], v[224:225], v[32:35]
    v_cvt_pk_bf16_f32 v136, v16, v17
    v_cvt_pk_bf16_f32 v137, v18, v19
    v_mul_f32_e64 v28, v28, v29
    v_mfma_f32_16x16x16_bf16 v[44:47], v[194:195], v[230:231], v[44:47]
    v_mul_f32 v24, v24, v29
    v_mul_f32 v25, v25, v29
    v_mul_f32 v26, v26, v29
    v_mul_f32_e64 v27, v27, v29
    s_waitcnt lgkmcnt(0)
    v_mfma_f32_16x16x16_bf16 v[40:43], v[192:193], v[230:231], v[40:43]
    v_cvt_pk_bf16_f32 v138, v24, v25
    v_cvt_pk_bf16_f32 v139, v26, v27
    v_cvt_pk_bf16_f32 v144, v20, v28
    buffer_store_dwordx4 v[136:139], v12, s[48:51], s54 offen offset:0 sc1
    v_mfma_f32_16x16x32_bf16 v[52:55], v[152:155], v[232:235], 0
    v_mfma_f32_16x16x32_bf16 v[48:51], v[148:151], v[232:235], 0
    v_mfma_f32_16x16x32_bf16 v[60:63], v[160:163], v[238:241], 0
    v_mfma_f32_16x16x32_bf16 v[56:59], v[156:159], v[238:241], 0
    v_rcp_f32 v37, v37
    v_rcp_f32 v45, v45
    v_mul_f32_e64 v36, v36, v37
    v_mfma_f32_16x16x16_bf16 v[52:55], v[182:183], v[236:237], v[52:55]
    v_mul_f32 v32, v32, v37
    v_mul_f32 v33, v33, v37
    v_mul_f32 v34, v34, v37
    v_mul_f32 v35, v35, v37
    v_mfma_f32_16x16x16_bf16 v[48:51], v[180:181], v[236:237], v[48:51]
    v_cvt_pk_bf16_f32 v140, v32, v33
    v_cvt_pk_bf16_f32 v141, v34, v35
    v_mul_f32 v44, v44, v45
    v_mul_f32 v40, v40, v45
    v_mfma_f32_16x16x16_bf16 v[60:63], v[186:187], v[242:243], v[60:63]
    v_mul_f32 v41, v41, v45
    v_mul_f32 v42, v42, v45
    v_mul_f32_e64 v43, v43, v45
    v_cvt_pk_bf16_f32 v142, v40, v41
    v_mfma_f32_16x16x16_bf16 v[56:59], v[184:185], v[242:243], v[56:59]
    v_cvt_pk_bf16_f32 v143, v42, v43
    v_cvt_pk_bf16_f32 v145, v36, v44
    buffer_store_dwordx4 v[140:143], v12, s[48:51], s54 offen offset:1024 sc1
    buffer_store_dwordx2 v[144:145], v13, s[48:51], s54 offen offset:2048 sc1
    v_mfma_f32_16x16x32_bf16 v[68:71], v[168:171], v[244:247], 0
    v_mfma_f32_16x16x32_bf16 v[64:67], v[164:167], v[244:247], 0
    v_mfma_f32_16x16x32_bf16 v[76:79], v[176:179], v[250:253], 0
    v_mfma_f32_16x16x32_bf16 v[72:75], v[172:175], v[250:253], 0
    v_rcp_f32 v53, v53
    v_rcp_f32 v61, v61
    v_mul_f32_e64 v52, v52, v53
    v_mfma_f32_16x16x16_bf16 v[68:71], v[190:191], v[248:249], v[68:71]
    v_mul_f32 v48, v48, v53
    v_mul_f32 v49, v49, v53
    v_mul_f32 v50, v50, v53
    v_mul_f32 v51, v51, v53
    v_mfma_f32_16x16x16_bf16 v[64:67], v[188:189], v[248:249], v[64:67]
    v_cvt_pk_bf16_f32 v96, v48, v49
    v_cvt_pk_bf16_f32 v97, v50, v51
    v_mul_f32_e64 v60, v60, v61
    v_mfma_f32_16x16x16_bf16 v[76:79], v[194:195], v[254:255], v[76:79]
    v_mul_f32 v56, v56, v61
    v_mul_f32 v57, v57, v61
    v_mul_f32 v58, v58, v61
    v_mul_f32 v59, v59, v61
    v_mfma_f32_16x16x16_bf16 v[72:75], v[192:193], v[254:255], v[72:75]
    v_cvt_pk_bf16_f32 v98, v56, v57
    v_cvt_pk_bf16_f32 v99, v58, v59
    v_cvt_pk_bf16_f32 v104, v52, v60
    buffer_store_dwordx4 v[96:99], v12, s[48:51], s58 offen offset:0 sc1
    v_rcp_f32 v69, v69
    v_rcp_f32 v77, v77
    v_mul_f32 v68, v68, v69
    v_mul_f32 v64, v64, v69
    v_mul_f32 v65, v65, v69
    v_mul_f32 v66, v66, v69
    v_mul_f32_e64 v67, v67, v69
    v_cvt_pk_bf16_f32 v100, v64, v65
    v_cvt_pk_bf16_f32 v101, v66, v67
    v_mul_f32 v76, v76, v77
    v_mul_f32 v72, v72, v77
    v_mul_f32 v73, v73, v77
    v_mul_f32 v74, v74, v77
    v_mul_f32_e64 v75, v75, v77
    v_cvt_pk_bf16_f32 v102, v72, v73
    v_cvt_pk_bf16_f32 v103, v74, v75
    v_cvt_pk_bf16_f32 v105, v68, v76
    buffer_store_dwordx4 v[100:103], v12, s[48:51], s58 offen offset:1024 sc1
    buffer_store_dwordx2 v[104:105], v13, s[48:51], s58 offen offset:2048 sc1
    s_setprio 0
    s_barrier
    ds_read_b64_tr_b16 v[56:57], v4 offset:0
    ds_read_b64_tr_b16 v[58:59], v4 offset:3200
    ds_read_b64_tr_b16 v[60:61], v4 offset:8
    ds_read_b64_tr_b16 v[62:63], v4 offset:3208
    ds_read_b64_tr_b16 v[64:65], v4 offset:16
    ds_read_b64_tr_b16 v[66:67], v4 offset:3216
    ds_read_b64_tr_b16 v[68:69], v4 offset:24
    ds_read_b64_tr_b16 v[70:71], v4 offset:3224
    ds_read_b64_tr_b16 v[72:73], v4 offset:32
    ds_read_b64_tr_b16 v[74:75], v4 offset:3232
    s_waitcnt lgkmcnt(8)
    v_mfma_f32_16x16x32_bf16 v[16:19], v[56:59], v[96:99], 0
    ds_read_b64_tr_b16 v[76:77], v4 offset:6400
    v_mfma_f32_16x16x32_bf16 v[36:39], v[56:59], v[136:139], 0
    ds_read_b64_tr_b16 v[78:79], v4 offset:9600
    s_waitcnt lgkmcnt(8)
    v_mfma_f32_16x16x32_bf16 v[20:23], v[60:63], v[96:99], 0
    ds_read_b64_tr_b16 v[80:81], v4 offset:6408
    v_mfma_f32_16x16x32_bf16 v[40:43], v[60:63], v[136:139], 0
    ds_read_b64_tr_b16 v[82:83], v4 offset:9608
    s_waitcnt lgkmcnt(8)
    v_mfma_f32_16x16x32_bf16 v[24:27], v[64:67], v[96:99], 0
    ds_read_b64_tr_b16 v[84:85], v4 offset:6416
    v_mfma_f32_16x16x32_bf16 v[44:47], v[64:67], v[136:139], 0
    ds_read_b64_tr_b16 v[86:87], v4 offset:9616
    s_waitcnt lgkmcnt(8)
    v_mfma_f32_16x16x32_bf16 v[28:31], v[68:71], v[96:99], 0
    ds_read_b64_tr_b16 v[88:89], v4 offset:6424
    v_mfma_f32_16x16x32_bf16 v[48:51], v[68:71], v[136:139], 0
    ds_read_b64_tr_b16 v[90:91], v4 offset:9624
    s_waitcnt lgkmcnt(8)
    v_mfma_f32_16x16x32_bf16 v[32:35], v[72:75], v[96:99], 0
    ds_read_b64_tr_b16 v[92:93], v4 offset:6432
    v_mfma_f32_16x16x32_bf16 v[52:55], v[72:75], v[136:139], 0
    ds_read_b64_tr_b16 v[94:95], v4 offset:9632
    s_waitcnt lgkmcnt(8)
    v_mfma_f32_16x16x32_bf16 v[16:19], v[76:79], v[100:103], v[16:19]
    ds_read_b64_tr_b16 v[56:57], v5 offset:0
    v_mfma_f32_16x16x32_bf16 v[36:39], v[76:79], v[140:143], v[36:39]
    ds_read_b64_tr_b16 v[58:59], v6 offset:0
    s_waitcnt lgkmcnt(8)
    v_mfma_f32_16x16x32_bf16 v[20:23], v[80:83], v[100:103], v[20:23]
    ds_read_b64_tr_b16 v[60:61], v5 offset:8
    v_mfma_f32_16x16x32_bf16 v[40:43], v[80:83], v[140:143], v[40:43]
    ds_read_b64_tr_b16 v[62:63], v6 offset:8
    s_waitcnt lgkmcnt(8)
    v_mfma_f32_16x16x32_bf16 v[24:27], v[84:87], v[100:103], v[24:27]
    ds_read_b64_tr_b16 v[64:65], v5 offset:16
    v_mfma_f32_16x16x32_bf16 v[44:47], v[84:87], v[140:143], v[44:47]
    ds_read_b64_tr_b16 v[66:67], v6 offset:16
    s_waitcnt lgkmcnt(8)
    v_mfma_f32_16x16x32_bf16 v[28:31], v[88:91], v[100:103], v[28:31]
    ds_read_b64_tr_b16 v[68:69], v5 offset:24
    v_mfma_f32_16x16x32_bf16 v[48:51], v[88:91], v[140:143], v[48:51]
    ds_read_b64_tr_b16 v[70:71], v6 offset:24
    s_waitcnt lgkmcnt(8)
    v_mfma_f32_16x16x32_bf16 v[32:35], v[92:95], v[100:103], v[32:35]
    ds_read_b64_tr_b16 v[72:73], v5 offset:32
    v_mfma_f32_16x16x32_bf16 v[52:55], v[92:95], v[140:143], v[52:55]
    ds_read_b64_tr_b16 v[74:75], v6 offset:32
    s_waitcnt vmcnt(2)
    s_barrier
    s_add_u32 s39, s61, s52
    buffer_load_dwordx4 v[106:109], v12, s[48:51], s39 offen sc1
    buffer_load_dwordx4 v[110:113], v12, s[48:51], s39 offen offset:1024 sc1
    buffer_load_dwordx2 v[114:115], v13, s[48:51], s39 offen offset:2048 sc1
    s_add_u32 s39, s61, s53
    buffer_load_dwordx4 v[146:149], v12, s[48:51], s39 offen sc1
    buffer_load_dwordx4 v[150:153], v12, s[48:51], s39 offen offset:1024 sc1
    buffer_load_dwordx2 v[154:155], v13, s[48:51], s39 offen offset:2048 sc1
    v_mul_u32_u24 v190, 205, v0
    v_lshlrev_b32 v191, 4, v0
    s_movk_i32 s39, 2400
    s_movk_i32 s58, 10240
    v_lshrrev_b32 v180, 11, v190
    v_mad_u32_u24 v180, v180, s39, v191
    v_add_u32 v190, 13120, v190
    v_add_u32 v191, 1024, v191
    v_lshrrev_b32_e64 v181, 11, v190
    v_mad_u32_u24 v181, v181, s39, v191
    v_add_u32 v190, 13120, v190
    v_add_u32 v191, 1024, v191
    v_lshrrev_b32_e64 v182, 11, v190
    v_mad_u32_u24 v182, v182, s39, v191
    v_cmp_gt_u32 vcc, 32, v0
    v_mov_b32 v190, 1073741824
    v_mul_u32_u24 v192, 205, v0
    v_lshlrev_b32 v193, 4, v0
    s_movk_i32 s39, 16
    s_movk_i32 s58, 704
    v_lshrrev_b32 v184, 11, v192
    v_mad_u32_u24 v184, v184, s39, v193
    v_add_u32 v192, 13120, v192
    v_add_u32 v193, 1024, v193
    v_lshrrev_b32_e64 v185, 11, v192
    v_mad_u32_u24 v185, v185, s39, v193
    v_add_u32 v192, 13120, v192
    v_add_u32 v193, 1024, v193
    v_lshrrev_b32_e64 v186, 11, v192
    v_mad_u32_u24 v186, v186, s39, v193
    v_cndmask_b32_e64 v182, v190, v182, vcc
    s_mul_i32 s58, s38, 5120
    v_add_u32 v191, s58, v12
    v_add_u32 v177, 0, v191
    v_add_u32 v178, 133120, v191
    s_mul_i32 s58, s3, 2816
    s_add_u32 s58, s58, 30720
    v_add_u32 v184, s58, v184
    v_add_u32 v185, s58, v185
    v_add_u32 v186, s58, v186
    v_and_b32 v190, 15, v0
    v_mul_u32_u24 v190, 176, v190
    v_lshrrev_b32 v191, 4, v0
    v_mul_u32_u24 v191, 40, v191
    v_add3_u32 v176, v190, v191, s58
    s_mov_b32 s44, s30
    s_mov_b32 s45, s31
    s_mov_b32 s46, 5242880
    s_mov_b32 s47, 0x20000
    s_lshl_b32 s60, s60, 1
    s_mul_i32 s58, s37, 160
    s_add_u32 s60, s60, s58
    s_add_u32 s60, s60, 42240
    s_branch L_P3
.p2align 6
L_BK:
    v_lshrrev_b32_e64 v100, 4, v0
    v_bfe_u32 v101, v0, 2, 2
    v_and_b32 v102, 3, v0
    v_and_b32 v103, 15, v0
    v_lshrrev_b32 v104, 1, v100
    v_lshlrev_b32 v104, 2, v104
    v_and_b32 v105, 1, v100
    v_add_u32 v104, v104, v105
    v_lshl_add_u32 v104, v104, 2, v101
    v_lshl_add_u32 v104, v104, 2, v102
    v_mul_u32_u24 v104, 40, v104
    v_add_u32 v1, 0, v104
    v_lshrrev_b32 v104, 1, v103
    v_xor_b32 v104, v104, v100
    v_lshlrev_b32_e64 v104, 4, v104
    v_lshl_add_u32 v104, v103, 7, v104
    s_lshl_b32 s39, s38, 12
    s_add_u32 s39, s39, 0
    v_add_u32 v2, s39, v104
    v_xor_b32 v3, 64, v2
    s_mov_b32 s56, 0x3fb8aa3b
    s_mov_b32 s57, 0x3fb8aa3b
    s_add_u32 s69, s60, 3145728
    s_mov_b32 s48, s34
    s_mov_b32 s49, s35
    s_mov_b32 s50, 16777216
    s_mov_b32 s51, 0x20000
    s_lshl_b32 s58, s37, 2
    s_add_u32 s58, s58, s38
    s_mul_i32 s63, s58, 69632
    s_lshl_b32 s68, s58, 12
    s_add_u32 s68, s68, 2228224
    s_lshl_b32 s58, s36, 8
    v_lshl_add_u32 v10, v0, 2, s58
    v_mul_u32_u24 v104, 4096, v100
    v_add3_u32 v11, v104, v12, s58
    v_mov_b32_e64 v251, 0
    v_mul_u32_u24 v104, 800, v100
    v_mul_u32_u24 v105, 40, v101
    v_cmp_eq_u32 vcc, v102, v100
    v_add_u32_e64 v104, v104, v105
    v_add_u32 v104, 157696, v104
    v_mov_b32 v105, 160896
    v_cndmask_b32 v9, v105, v104, vcc
    s_lshl_b32 s58, s38, 5
    v_lshlrev_b32_e64 v104, 7, v100
    v_add3_u32 v104, v104, v103, s58
    v_mul_u32_u24 v105, 80, v104
    v_add_u32 v13, 92160, v105
    v_mul_u32_u24_e64 v105, 48, v104
    v_add_u32 v248, 133120, v105
    s_lshl_b32 s58, s38, 6
    v_lshlrev_b32 v104, 2, v100
    v_add3_u32 v104, v104, v101, s58
    v_mul_u32_u24 v14, 160, v104
    v_lshl_add_u32 v14, v102, 3, v14
    v_add_u32 v14, 92160, v14
    v_mul_u32_u24 v15, 96, v104
    v_lshl_add_u32 v15, v102, 3, v15
    v_add_u32 v15, 133120, v15
    s_mul_i32 s58, s38, 6144
    s_add_u32 s58, s58, 133120
    v_bfrev_b32 v104, v101
    v_lshrrev_b32 v104, 30, v104
    v_lshl_add_u32 v104, v100, 2, v104
    v_mul_u32_u24 v104, 80, v104
    v_lshlrev_b32_e64 v105, 3, v102
    v_add3_u32 v244, v104, v105, s58
    v_lshrrev_b32_e64 v104, 1, v100
    v_mul_u32_u24 v104, 608, v104
    v_sub_u32 v245, v244, v104
    v_lshrrev_b32 v104, 1, v102
    v_mul_u32_u24 v104, 1264, v104
    v_add_u32 v246, v244, v104
    v_and_b32 v104, 60, v0
    v_cmp_eq_u32_e64 vcc, 16, v104
    v_mov_b32 v105, 0x358637bd
    s_nop 2
    s_or_b32 vcc_hi, vcc_hi, 0x10000
    v_cndmask_b32 v252, 0, v105, vcc
    v_mul_u32_u24 v104, 205, v0
    v_lshlrev_b32 v105, 4, v0
    s_movk_i32 s39, 1120
    s_movk_i32 s58, 5120
    v_lshrrev_b32 v4, 11, v104
    v_mad_u32_u24 v4, v4, s39, v105
    v_add_u32 v104, 13120, v104
    v_lshrrev_b32_e64 v5, 11, v104
    v_mad_u32_u24 v5, v5, s39, v105
    v_add_u32 v104, 13120, v104
    v_lshrrev_b32_e64 v6, 11, v104
    v_mad_u32_u24 v6, v6, s39, v105
    v_add_u32 v104, 13120, v104
    v_lshrrev_b32_e64 v7, 11, v104
    v_mad_u32_u24 v7, v7, s39, v105
    v_add_u32 v104, 13120, v104
    v_add_u32 v105, 4096, v105
    v_lshrrev_b32_e64 v8, 11, v104
    v_mad_u32_u24 v8, v8, s39, v105
    s_mov_b32 s40, s28
    s_mov_b32 s41, s29
    s_mov_b32 s42, 819200
    s_mov_b32 s43, 0x20000
    s_mul_i32 s52, s37, 160
    s_mov_b64 exec, 0
    s_branch L_wb_0
L_wb_x:
    s_mov_b64 exec, -1
    s_waitcnt vmcnt(0)
    s_barrier
    s_nop 0
    ds_read_b128 v[136:139], v2 offset:0
    ds_read_b128 v[140:143], v2 offset:2048
    ds_read_b64_tr_b16 v[96:97], v1 offset:16384
    ds_read_b64_tr_b16 v[98:99], v1 offset:17664
    ds_read_b64_tr_b16 v[100:101], v1 offset:16392
    ds_read_b64_tr_b16 v[102:103], v1 offset:17672
    ds_read_b64_tr_b16 v[104:105], v1 offset:16400
    ds_read_b64_tr_b16 v[106:107], v1 offset:17680
    ds_read_b64_tr_b16 v[108:109], v1 offset:16408
    ds_read_b64_tr_b16 v[110:111], v1 offset:17688
    ds_read_b64_tr_b16 v[112:113], v1 offset:16416
    ds_read_b64_tr_b16 v[114:115], v1 offset:17696
    s_waitcnt lgkmcnt(8)
    v_mfma_f32_16x16x32_bf16 v[16:19], v[96:99], v[136:139], 0
    ds_read_b128 v[144:147], v3 offset:0
    v_mfma_f32_16x16x32_bf16 v[36:39], v[96:99], v[140:143], 0
    ds_read_b128 v[148:151], v3 offset:2048
    s_waitcnt lgkmcnt(8)
    v_mfma_f32_16x16x32_bf16 v[20:23], v[100:103], v[136:139], 0
    ds_read_b64_tr_b16 v[116:117], v1 offset:21504
    v_mfma_f32_16x16x32_bf16 v[40:43], v[100:103], v[140:143], 0
    ds_read_b64_tr_b16 v[118:119], v1 offset:22784
    s_waitcnt lgkmcnt(8)
    v_mfma_f32_16x16x32_bf16 v[24:27], v[104:107], v[136:139], 0
    ds_read_b64_tr_b16 v[120:121], v1 offset:21512
    ds_read_b64_tr_b16 v[122:123], v1 offset:22792
    v_mfma_f32_16x16x32_bf16 v[44:47], v[104:107], v[140:143], 0
    ds_read_b64_tr_b16 v[124:125], v1 offset:21520
    s_waitcnt lgkmcnt(9)
    v_mfma_f32_16x16x32_bf16 v[28:31], v[108:111], v[136:139], 0
    ds_read_b64_tr_b16 v[126:127], v1 offset:22800
    v_mfma_f32_16x16x32_bf16 v[48:51], v[108:111], v[140:143], 0
    ds_read_b64_tr_b16 v[128:129], v1 offset:21528
    s_waitcnt lgkmcnt(9)
    v_mfma_f32_16x16x32_bf16 v[32:35], v[112:115], v[136:139], 0
    ds_read_b64_tr_b16 v[130:131], v1 offset:22808
    v_mfma_f32_16x16x32_bf16 v[52:55], v[112:115], v[140:143], 0
    ds_read_b64_tr_b16 v[132:133], v1 offset:21536
    ds_read_b64_tr_b16 v[134:135], v1 offset:22816
    s_waitcnt lgkmcnt(8)
    v_mfma_f32_16x16x32_bf16 v[16:19], v[116:119], v[144:147], v[16:19]
    s_barrier
    v_mfma_f32_16x16x32_bf16 v[36:39], v[116:119], v[148:151], v[36:39]
    ds_read_b64_tr_b16 v[96:97], v1 offset:26624
    s_waitcnt lgkmcnt(7)
    v_mfma_f32_16x16x32_bf16 v[20:23], v[120:123], v[144:147], v[20:23]
    ds_read_b64_tr_b16 v[98:99], v1 offset:27904
    v_mfma_f32_16x16x32_bf16 v[40:43], v[120:123], v[148:151], v[40:43]
    ds_read_b64_tr_b16 v[100:101], v1 offset:26632
    s_waitcnt lgkmcnt(7)
    v_mfma_f32_16x16x32_bf16 v[24:27], v[124:127], v[144:147], v[24:27]
    ds_read_b64_tr_b16 v[102:103], v1 offset:27912
    v_mfma_f32_16x16x32_bf16 v[44:47], v[124:127], v[148:151], v[44:47]
    ds_read_b64_tr_b16 v[104:105], v1 offset:26640
    s_waitcnt lgkmcnt(7)
    v_mfma_f32_16x16x32_bf16 v[28:31], v[128:131], v[144:147], v[28:31]
    ds_read_b64_tr_b16 v[106:107], v1 offset:27920
    v_mfma_f32_16x16x32_bf16 v[48:51], v[128:131], v[148:151], v[48:51]
    ds_read_b64_tr_b16 v[108:109], v1 offset:26648
    s_waitcnt lgkmcnt(7)
    v_mfma_f32_16x16x32_bf16 v[32:35], v[132:135], v[144:147], v[32:35]
    ds_read_b64_tr_b16 v[110:111], v1 offset:27928
    v_mfma_f32_16x16x32_bf16 v[52:55], v[132:135], v[148:151], v[52:55]
    ds_read_b64_tr_b16 v[112:113], v1 offset:26656
    ds_read_b64_tr_b16 v[114:115], v1 offset:27936
    s_waitcnt lgkmcnt(8)
    v_mfma_f32_16x16x32_bf16 v[56:59], v[96:99], v[136:139], 0
    ds_read_b64_tr_b16 v[116:117], v1 offset:31744
    v_mfma_f32_16x16x32_bf16 v[76:79], v[96:99], v[140:143], 0
    ds_read_b64_tr_b16 v[118:119], v1 offset:33024
    s_waitcnt lgkmcnt(8)
    v_mfma_f32_16x16x32_bf16 v[60:63], v[100:103], v[136:139], 0
    ds_read_b64_tr_b16 v[120:121], v1 offset:31752
    v_mfma_f32_16x16x32_bf16 v[80:83], v[100:103], v[140:143], 0
    ds_read_b64_tr_b16 v[122:123], v1 offset:33032
    s_waitcnt lgkmcnt(8)
    v_mfma_f32_16x16x32_bf16 v[64:67], v[104:107], v[136:139], 0
    ds_read_b64_tr_b16 v[124:125], v1 offset:31760
    v_mfma_f32_16x16x32_bf16 v[84:87], v[104:107], v[140:143], 0
    ds_read_b64_tr_b16 v[126:127], v1 offset:33040
    s_waitcnt lgkmcnt(8)
    v_mfma_f32_16x16x32_bf16 v[68:71], v[108:111], v[136:139], 0
    ds_read_b64_tr_b16 v[128:129], v1 offset:31768
    v_mfma_f32_16x16x32_bf16 v[88:91], v[108:111], v[140:143], 0
    ds_read_b64_tr_b16 v[130:131], v1 offset:33048
    s_waitcnt lgkmcnt(8)
    v_mfma_f32_16x16x32_bf16 v[72:75], v[112:115], v[136:139], 0
    ds_read_b64_tr_b16 v[132:133], v1 offset:31776
    v_mfma_f32_16x16x32_bf16 v[92:95], v[112:115], v[140:143], 0
    ds_read_b64_tr_b16 v[134:135], v1 offset:33056
    ds_read_b64_tr_b16 v[152:153], v9 offset:0
    ds_read_b64_tr_b16 v[154:155], v9 offset:160
    ds_read_b64_tr_b16 v[156:157], v9 offset:320
    ds_read_b64_tr_b16 v[158:159], v9 offset:480
    ds_read_b64_tr_b16 v[160:161], v9 offset:640
    ds_read_b64_tr_b16 v[162:163], v9 offset:8
    ds_read_b64_tr_b16 v[164:165], v9 offset:168
    ds_read_b64_tr_b16 v[166:167], v9 offset:328
    ds_read_b64_tr_b16 v[168:169], v9 offset:488
    ds_read_b64_tr_b16 v[170:171], v9 offset:648
    ds_read_b64_tr_b16 v[172:173], v9 offset:16
    ds_read_b64_tr_b16 v[174:175], v9 offset:176
    ds_read_b64_tr_b16 v[176:177], v9 offset:336
    ds_read_b64_tr_b16 v[178:179], v9 offset:496
    ds_read_b64_tr_b16 v[180:181], v9 offset:656
    ds_read_b64_tr_b16 v[182:183], v9 offset:24
    ds_read_b64_tr_b16 v[184:185], v9 offset:184
    ds_read_b64_tr_b16 v[186:187], v9 offset:344
    ds_read_b64_tr_b16 v[188:189], v9 offset:504
    ds_read_b64_tr_b16 v[190:191], v9 offset:664
    ds_read_b64_tr_b16 v[192:193], v9 offset:32
    ds_read_b64_tr_b16 v[194:195], v9 offset:192
    ds_read_b64_tr_b16 v[196:197], v9 offset:352
    ds_read_b64_tr_b16 v[198:199], v9 offset:512
    ds_read_b64_tr_b16 v[200:201], v9 offset:672
    s_waitcnt lgkmcnt(15)
    v_mfma_f32_16x16x32_bf16 v[56:59], v[116:119], v[144:147], v[56:59]
    v_add_u32 v1, 110592, v1
    v_mfma_f32_16x16x32_bf16 v[76:79], v[116:119], v[148:151], v[76:79]
    v_add_u32 v2, 110592, v2
    v_add_u32 v3, 110592, v3
    v_mfma_f32_16x16x32_bf16 v[60:63], v[120:123], v[144:147], v[60:63]
    s_barrier
    v_mfma_f32_16x16x32_bf16 v[80:83], v[120:123], v[148:151], v[80:83]
    ds_read_b128 v[136:139], v2 offset:0
    ds_read_b128 v[140:143], v2 offset:2048
    v_mfma_f32_16x16x32_bf16 v[64:67], v[124:127], v[144:147], v[64:67]
    ds_read_b64_tr_b16 v[96:97], v1 offset:16384
    ds_read_b64_tr_b16 v[98:99], v1 offset:17664
    v_mfma_f32_16x16x32_bf16 v[84:87], v[124:127], v[148:151], v[84:87]
    ds_read_b64_tr_b16 v[100:101], v1 offset:16392
    v_mfma_f32_16x16x32_bf16 v[68:71], v[128:131], v[144:147], v[68:71]
    ds_read_b64_tr_b16 v[102:103], v1 offset:17672
    ds_read_b64_tr_b16 v[104:105], v1 offset:16400
    v_mfma_f32_16x16x32_bf16 v[88:91], v[128:131], v[148:151], v[88:91]
    ds_read_b64_tr_b16 v[106:107], v1 offset:17680
    v_mfma_f32_16x16x32_bf16 v[72:75], v[132:135], v[144:147], v[72:75]
    ds_read_b64_tr_b16 v[108:109], v1 offset:16408
    ds_read_b64_tr_b16 v[110:111], v1 offset:17688
    v_mfma_f32_16x16x32_bf16 v[92:95], v[132:135], v[148:151], v[92:95]
    ds_read_b64_tr_b16 v[112:113], v1 offset:16416
    ds_read_b64_tr_b16 v[114:115], v1 offset:17696
    s_waitcnt lgkmcnt(8)
    v_mfma_f32_16x16x32_bf16 v[16:19], v[96:99], v[136:139], v[16:19]
    ds_read_b64_tr_b16 v[116:117], v1 offset:26624
    v_mfma_f32_16x16x32_bf16 v[36:39], v[96:99], v[140:143], v[36:39]
    ds_read_b64_tr_b16 v[118:119], v1 offset:27904
    s_waitcnt lgkmcnt(8)
    v_mfma_f32_16x16x32_bf16 v[20:23], v[100:103], v[136:139], v[20:23]
    ds_read_b64_tr_b16 v[120:121], v1 offset:26632
    v_mfma_f32_16x16x32_bf16 v[40:43], v[100:103], v[140:143], v[40:43]
    ds_read_b64_tr_b16 v[122:123], v1 offset:27912
    s_waitcnt lgkmcnt(8)
    v_mfma_f32_16x16x32_bf16 v[24:27], v[104:107], v[136:139], v[24:27]
    ds_read_b64_tr_b16 v[124:125], v1 offset:26640
    v_mfma_f32_16x16x32_bf16 v[44:47], v[104:107], v[140:143], v[44:47]
    ds_read_b64_tr_b16 v[126:127], v1 offset:27920
    s_waitcnt lgkmcnt(8)
    v_mfma_f32_16x16x32_bf16 v[28:31], v[108:111], v[136:139], v[28:31]
    ds_read_b64_tr_b16 v[128:129], v1 offset:26648
    v_mfma_f32_16x16x32_bf16 v[48:51], v[108:111], v[140:143], v[48:51]
    ds_read_b64_tr_b16 v[130:131], v1 offset:27928
    s_waitcnt lgkmcnt(8)
    v_mfma_f32_16x16x32_bf16 v[32:35], v[112:115], v[136:139], v[32:35]
    ds_read_b64_tr_b16 v[132:133], v1 offset:26656
L_wb_2:
    s_cbranch_execz L_wb_3
    v_mfma_f32_16x16x32_bf16 v[52:55], v[112:115], v[140:143], v[52:55]
    ds_read_b64_tr_b16 v[134:135], v1 offset:27936
    s_waitcnt lgkmcnt(8)
    v_mfma_f32_16x16x32_bf16 v[56:59], v[116:119], v[136:139], v[56:59]
    ds_read_b128 v[144:147], v3 offset:0
    v_mfma_f32_16x16x32_bf16 v[76:79], v[116:119], v[140:143], v[76:79]
    ds_read_b128 v[148:151], v3 offset:2048
    s_waitcnt lgkmcnt(8)
    v_mfma_f32_16x16x32_bf16 v[60:63], v[120:123], v[136:139], v[60:63]
    ds_read_b64_tr_b16 v[96:97], v1 offset:21504
    v_mfma_f32_16x16x32_bf16 v[80:83], v[120:123], v[140:143], v[80:83]
    ds_read_b64_tr_b16 v[98:99], v1 offset:22784
    s_waitcnt lgkmcnt(8)
    v_mfma_f32_16x16x32_bf16 v[64:67], v[124:127], v[136:139], v[64:67]
    ds_read_b64_tr_b16 v[100:101], v1 offset:21512
    ds_read_b64_tr_b16 v[102:103], v1 offset:22792
    v_mfma_f32_16x16x32_bf16 v[84:87], v[124:127], v[140:143], v[84:87]
    ds_read_b64_tr_b16 v[104:105], v1 offset:21520
    s_waitcnt lgkmcnt(9)
    v_mfma_f32_16x16x32_bf16 v[68:71], v[128:131], v[136:139], v[68:71]
    ds_read_b64_tr_b16 v[106:107], v1 offset:22800
    v_mfma_f32_16x16x32_bf16 v[88:91], v[128:131], v[140:143], v[88:91]
    ds_read_b64_tr_b16 v[108:109], v1 offset:21528
    s_waitcnt lgkmcnt(9)
    v_mfma_f32_16x16x32_bf16 v[72:75], v[132:135], v[136:139], v[72:75]
    ds_read_b64_tr_b16 v[110:111], v1 offset:22808
    v_mfma_f32_16x16x32_bf16 v[92:95], v[132:135], v[140:143], v[92:95]
    ds_read_b64_tr_b16 v[112:113], v1 offset:21536
    ds_read_b64_tr_b16 v[114:115], v1 offset:22816
    s_waitcnt lgkmcnt(8)
    v_mfma_f32_16x16x32_bf16 v[16:19], v[96:99], v[144:147], v[16:19]
    ds_read_b64_tr_b16 v[116:117], v1 offset:31744
    v_mfma_f32_16x16x32_bf16 v[36:39], v[96:99], v[148:151], v[36:39]
    ds_read_b64_tr_b16 v[118:119], v1 offset:33024
    s_waitcnt lgkmcnt(8)
    v_mfma_f32_16x16x32_bf16 v[20:23], v[100:103], v[144:147], v[20:23]
    ds_read_b64_tr_b16 v[120:121], v1 offset:31752
    v_mfma_f32_16x16x32_bf16 v[40:43], v[100:103], v[148:151], v[40:43]
    ds_read_b64_tr_b16 v[122:123], v1 offset:33032
    s_waitcnt lgkmcnt(8)
    v_mfma_f32_16x16x32_bf16 v[24:27], v[104:107], v[144:147], v[24:27]
    ds_read_b64_tr_b16 v[124:125], v1 offset:31760
    v_mfma_f32_16x16x32_bf16 v[44:47], v[104:107], v[148:151], v[44:47]
    ds_read_b64_tr_b16 v[126:127], v1 offset:33040
    s_waitcnt lgkmcnt(8)
    v_mfma_f32_16x16x32_bf16 v[28:31], v[108:111], v[144:147], v[28:31]
    ds_read_b64_tr_b16 v[128:129], v1 offset:31768
    v_mfma_f32_16x16x32_bf16 v[48:51], v[108:111], v[148:151], v[48:51]
    ds_read_b64_tr_b16 v[130:131], v1 offset:33048
    s_waitcnt lgkmcnt(8)
    v_mfma_f32_16x16x32_bf16 v[32:35], v[112:115], v[144:147], v[32:35]
    ds_read_b64_tr_b16 v[132:133], v1 offset:31776
    v_mfma_f32_16x16x32_bf16 v[52:55], v[112:115], v[148:151], v[52:55]
    ds_read_b64_tr_b16 v[134:135], v1 offset:33056
    s_waitcnt lgkmcnt(8)
    v_mfma_f32_16x16x32_bf16 v[56:59], v[116:119], v[144:147], v[56:59]
    v_add_u32 v1, 4294930432, v1
    v_mfma_f32_16x16x32_bf16 v[76:79], v[116:119], v[148:151], v[76:79]
    v_add_u32 v2, 4294930432, v2
    v_add_u32 v3, 4294930432, v3
    s_waitcnt lgkmcnt(6)
    v_mfma_f32_16x16x32_bf16 v[60:63], v[120:123], v[144:147], v[60:63]
    s_barrier
    v_mfma_f32_16x16x32_bf16 v[80:83], v[120:123], v[148:151], v[80:83]
    ds_read_b128 v[136:139], v2 offset:0
    ds_read_b128 v[140:143], v2 offset:2048
    s_waitcnt lgkmcnt(6)
    v_mfma_f32_16x16x32_bf16 v[64:67], v[124:127], v[144:147], v[64:67]
    ds_read_b64_tr_b16 v[96:97], v1 offset:16384
    ds_read_b64_tr_b16 v[98:99], v1 offset:17664
    v_mfma_f32_16x16x32_bf16 v[84:87], v[124:127], v[148:151], v[84:87]
    ds_read_b64_tr_b16 v[100:101], v1 offset:16392
    s_waitcnt lgkmcnt(7)
    v_mfma_f32_16x16x32_bf16 v[68:71], v[128:131], v[144:147], v[68:71]
    ds_read_b64_tr_b16 v[102:103], v1 offset:17672
    ds_read_b64_tr_b16 v[104:105], v1 offset:16400
    v_mfma_f32_16x16x32_bf16 v[88:91], v[128:131], v[148:151], v[88:91]
    ds_read_b64_tr_b16 v[106:107], v1 offset:17680
    s_waitcnt lgkmcnt(8)
    v_mfma_f32_16x16x32_bf16 v[72:75], v[132:135], v[144:147], v[72:75]
    ds_read_b64_tr_b16 v[108:109], v1 offset:16408
    ds_read_b64_tr_b16 v[110:111], v1 offset:17688
    v_mfma_f32_16x16x32_bf16 v[92:95], v[132:135], v[148:151], v[92:95]
    ds_read_b64_tr_b16 v[112:113], v1 offset:16416
    ds_read_b64_tr_b16 v[114:115], v1 offset:17696
    s_waitcnt lgkmcnt(8)
    v_mfma_f32_16x16x32_bf16 v[16:19], v[96:99], v[136:139], v[16:19]
    ds_read_b64_tr_b16 v[116:117], v1 offset:26624
    v_mfma_f32_16x16x32_bf16 v[36:39], v[96:99], v[140:143], v[36:39]
    ds_read_b64_tr_b16 v[118:119], v1 offset:27904
    s_waitcnt lgkmcnt(8)
    v_mfma_f32_16x16x32_bf16 v[20:23], v[100:103], v[136:139], v[20:23]
    ds_read_b64_tr_b16 v[120:121], v1 offset:26632
    v_mfma_f32_16x16x32_bf16 v[40:43], v[100:103], v[140:143], v[40:43]
    ds_read_b64_tr_b16 v[122:123], v1 offset:27912
    s_waitcnt lgkmcnt(8)
    v_mfma_f32_16x16x32_bf16 v[24:27], v[104:107], v[136:139], v[24:27]
    ds_read_b64_tr_b16 v[124:125], v1 offset:26640
    v_mfma_f32_16x16x32_bf16 v[44:47], v[104:107], v[140:143], v[44:47]
    ds_read_b64_tr_b16 v[126:127], v1 offset:27920
    s_waitcnt lgkmcnt(8)
    v_mfma_f32_16x16x32_bf16 v[28:31], v[108:111], v[136:139], v[28:31]
    ds_read_b64_tr_b16 v[128:129], v1 offset:26648
    v_mfma_f32_16x16x32_bf16 v[48:51], v[108:111], v[140:143], v[48:51]
    ds_read_b64_tr_b16 v[130:131], v1 offset:27928
    s_waitcnt lgkmcnt(8)
    v_mfma_f32_16x16x32_bf16 v[32:35], v[112:115], v[136:139], v[32:35]
    ds_read_b64_tr_b16 v[132:133], v1 offset:26656
    v_mfma_f32_16x16x32_bf16 v[52:55], v[112:115], v[140:143], v[52:55]
    ds_read_b64_tr_b16 v[134:135], v1 offset:27936
    s_waitcnt lgkmcnt(8)
    v_mfma_f32_16x16x32_bf16 v[56:59], v[116:119], v[136:139], v[56:59]
    ds_read_b128 v[144:147], v3 offset:0
    v_mfma_f32_16x16x32_bf16 v[76:79], v[116:119], v[140:143], v[76:79]
    ds_read_b128 v[148:151], v3 offset:2048
    s_waitcnt lgkmcnt(8)
    v_mfma_f32_16x16x32_bf16 v[60:63], v[120:123], v[136:139], v[60:63]
    ds_read_b64_tr_b16 v[96:97], v1 offset:21504
    v_mfma_f32_16x16x32_bf16 v[80:83], v[120:123], v[140:143], v[80:83]
    ds_read_b64_tr_b16 v[98:99], v1 offset:22784
    s_waitcnt lgkmcnt(8)
    v_mfma_f32_16x16x32_bf16 v[64:67], v[124:127], v[136:139], v[64:67]
    ds_read_b64_tr_b16 v[100:101], v1 offset:21512
    ds_read_b64_tr_b16 v[102:103], v1 offset:22792
    v_mfma_f32_16x16x32_bf16 v[84:87], v[124:127], v[140:143], v[84:87]
    ds_read_b64_tr_b16 v[104:105], v1 offset:21520
    s_waitcnt lgkmcnt(9)
    v_mfma_f32_16x16x32_bf16 v[68:71], v[128:131], v[136:139], v[68:71]
    ds_read_b64_tr_b16 v[106:107], v1 offset:22800
    v_mfma_f32_16x16x32_bf16 v[88:91], v[128:131], v[140:143], v[88:91]
    ds_read_b64_tr_b16 v[108:109], v1 offset:21528
    s_waitcnt lgkmcnt(9)
    v_mfma_f32_16x16x32_bf16 v[72:75], v[132:135], v[136:139], v[72:75]
    ds_read_b64_tr_b16 v[110:111], v1 offset:22808
    v_mfma_f32_16x16x32_bf16 v[92:95], v[132:135], v[140:143], v[92:95]
    ds_read_b64_tr_b16 v[112:113], v1 offset:21536
    ds_read_b64_tr_b16 v[114:115], v1 offset:22816
    s_waitcnt lgkmcnt(8)
    v_mfma_f32_16x16x32_bf16 v[16:19], v[96:99], v[144:147], v[16:19]
    ds_read_b64_tr_b16 v[116:117], v1 offset:31744
    v_mfma_f32_16x16x32_bf16 v[36:39], v[96:99], v[148:151], v[36:39]
    ds_read_b64_tr_b16 v[118:119], v1 offset:33024
    s_waitcnt lgkmcnt(8)
    v_mfma_f32_16x16x32_bf16 v[20:23], v[100:103], v[144:147], v[20:23]
    ds_read_b64_tr_b16 v[120:121], v1 offset:31752
    v_mfma_f32_16x16x32_bf16 v[40:43], v[100:103], v[148:151], v[40:43]
    ds_read_b64_tr_b16 v[122:123], v1 offset:33032
    s_waitcnt lgkmcnt(8)
    v_mfma_f32_16x16x32_bf16 v[24:27], v[104:107], v[144:147], v[24:27]
    ds_read_b64_tr_b16 v[124:125], v1 offset:31760
    v_mfma_f32_16x16x32_bf16 v[44:47], v[104:107], v[148:151], v[44:47]
    ds_read_b64_tr_b16 v[126:127], v1 offset:33040
    s_waitcnt lgkmcnt(8)
    v_mfma_f32_16x16x32_bf16 v[28:31], v[108:111], v[144:147], v[28:31]
    ds_read_b64_tr_b16 v[128:129], v1 offset:31768
    v_mfma_f32_16x16x32_bf16 v[48:51], v[108:111], v[148:151], v[48:51]
    ds_read_b64_tr_b16 v[130:131], v1 offset:33048
    s_waitcnt lgkmcnt(8)
    v_mfma_f32_16x16x32_bf16 v[32:35], v[112:115], v[144:147], v[32:35]
    ds_read_b64_tr_b16 v[132:133], v1 offset:31776
    v_mfma_f32_16x16x32_bf16 v[52:55], v[112:115], v[148:151], v[52:55]
    ds_read_b64_tr_b16 v[134:135], v1 offset:33056
    s_waitcnt lgkmcnt(8)
    v_mfma_f32_16x16x32_bf16 v[56:59], v[116:119], v[144:147], v[56:59]
    v_add_u32 v1, 4294930432, v1
    v_mfma_f32_16x16x32_bf16 v[76:79], v[116:119], v[148:151], v[76:79]
    v_add_u32 v2, 4294930432, v2
    v_add_u32 v3, 4294930432, v3
    s_waitcnt lgkmcnt(6)
    v_mfma_f32_16x16x32_bf16 v[60:63], v[120:123], v[144:147], v[60:63]
    s_barrier
    v_mfma_f32_16x16x32_bf16 v[80:83], v[120:123], v[148:151], v[80:83]
    ds_read_b128 v[136:139], v2 offset:0
    ds_read_b128 v[140:143], v2 offset:2048
    s_waitcnt lgkmcnt(6)
    v_mfma_f32_16x16x32_bf16 v[64:67], v[124:127], v[144:147], v[64:67]
    ds_read_b64_tr_b16 v[96:97], v1 offset:16384
    ds_read_b64_tr_b16 v[98:99], v1 offset:17664
    v_mfma_f32_16x16x32_bf16 v[84:87], v[124:127], v[148:151], v[84:87]
    ds_read_b64_tr_b16 v[100:101], v1 offset:16392
    s_waitcnt lgkmcnt(7)
    v_mfma_f32_16x16x32_bf16 v[68:71], v[128:131], v[144:147], v[68:71]
    ds_read_b64_tr_b16 v[102:103], v1 offset:17672
    ds_read_b64_tr_b16 v[104:105], v1 offset:16400
    v_mfma_f32_16x16x32_bf16 v[88:91], v[128:131], v[148:151], v[88:91]
    ds_read_b64_tr_b16 v[106:107], v1 offset:17680
    s_waitcnt lgkmcnt(8)
    v_mfma_f32_16x16x32_bf16 v[72:75], v[132:135], v[144:147], v[72:75]
    ds_read_b64_tr_b16 v[108:109], v1 offset:16408
    ds_read_b64_tr_b16 v[110:111], v1 offset:17688
    v_mfma_f32_16x16x32_bf16 v[92:95], v[132:135], v[148:151], v[92:95]
    ds_read_b64_tr_b16 v[112:113], v1 offset:16416
    ds_read_b64_tr_b16 v[114:115], v1 offset:17696
    s_waitcnt lgkmcnt(8)
    v_mfma_f32_16x16x32_bf16 v[16:19], v[96:99], v[136:139], v[16:19]
    ds_read_b64_tr_b16 v[116:117], v1 offset:26624
    v_mfma_f32_16x16x32_bf16 v[36:39], v[96:99], v[140:143], v[36:39]
    ds_read_b64_tr_b16 v[118:119], v1 offset:27904
    s_waitcnt lgkmcnt(8)
    v_mfma_f32_16x16x32_bf16 v[20:23], v[100:103], v[136:139], v[20:23]
    ds_read_b64_tr_b16 v[120:121], v1 offset:26632
    v_mfma_f32_16x16x32_bf16 v[40:43], v[100:103], v[140:143], v[40:43]
    ds_read_b64_tr_b16 v[122:123], v1 offset:27912
    s_waitcnt lgkmcnt(8)
    v_mfma_f32_16x16x32_bf16 v[24:27], v[104:107], v[136:139], v[24:27]
    ds_read_b64_tr_b16 v[124:125], v1 offset:26640
    v_mfma_f32_16x16x32_bf16 v[44:47], v[104:107], v[140:143], v[44:47]
    ds_read_b64_tr_b16 v[126:127], v1 offset:27920
    s_waitcnt lgkmcnt(8)
    v_mfma_f32_16x16x32_bf16 v[28:31], v[108:111], v[136:139], v[28:31]
    ds_read_b64_tr_b16 v[128:129], v1 offset:26648
    v_mfma_f32_16x16x32_bf16 v[48:51], v[108:111], v[140:143], v[48:51]
    ds_read_b64_tr_b16 v[130:131], v1 offset:27928
    s_waitcnt lgkmcnt(8)
    v_mfma_f32_16x16x32_bf16 v[32:35], v[112:115], v[136:139], v[32:35]
    ds_read_b64_tr_b16 v[132:133], v1 offset:26656
    v_mfma_f32_16x16x32_bf16 v[52:55], v[112:115], v[140:143], v[52:55]
    ds_read_b64_tr_b16 v[134:135], v1 offset:27936
    s_waitcnt lgkmcnt(8)
    v_mfma_f32_16x16x32_bf16 v[56:59], v[116:119], v[136:139], v[56:59]
    ds_read_b128 v[144:147], v3 offset:0
    v_mfma_f32_16x16x32_bf16 v[76:79], v[116:119], v[140:143], v[76:79]
    ds_read_b128 v[148:151], v3 offset:2048
    s_waitcnt lgkmcnt(8)
    v_mfma_f32_16x16x32_bf16 v[60:63], v[120:123], v[136:139], v[60:63]
    ds_read_b64_tr_b16 v[96:97], v1 offset:21504
    v_mfma_f32_16x16x32_bf16 v[80:83], v[120:123], v[140:143], v[80:83]
    ds_read_b64_tr_b16 v[98:99], v1 offset:22784
    s_waitcnt lgkmcnt(8)
    v_mfma_f32_16x16x32_bf16 v[64:67], v[124:127], v[136:139], v[64:67]
    ds_read_b64_tr_b16 v[100:101], v1 offset:21512
    ds_read_b64_tr_b16 v[102:103], v1 offset:22792
    v_mfma_f32_16x16x32_bf16 v[84:87], v[124:127], v[140:143], v[84:87]
    ds_read_b64_tr_b16 v[104:105], v1 offset:21520
    s_waitcnt lgkmcnt(9)
    v_mfma_f32_16x16x32_bf16 v[68:71], v[128:131], v[136:139], v[68:71]
    ds_read_b64_tr_b16 v[106:107], v1 offset:22800
    v_mfma_f32_16x16x32_bf16 v[88:91], v[128:131], v[140:143], v[88:91]
    ds_read_b64_tr_b16 v[108:109], v1 offset:21528
    s_waitcnt lgkmcnt(9)
    v_mfma_f32_16x16x32_bf16 v[72:75], v[132:135], v[136:139], v[72:75]
    ds_read_b64_tr_b16 v[110:111], v1 offset:22808
    v_mfma_f32_16x16x32_bf16 v[92:95], v[132:135], v[140:143], v[92:95]
    ds_read_b64_tr_b16 v[112:113], v1 offset:21536
    ds_read_b64_tr_b16 v[114:115], v1 offset:22816
    s_waitcnt lgkmcnt(8)
    v_mfma_f32_16x16x32_bf16 v[16:19], v[96:99], v[144:147], v[16:19]
    ds_read_b64_tr_b16 v[116:117], v1 offset:31744
    v_mfma_f32_16x16x32_bf16 v[36:39], v[96:99], v[148:151], v[36:39]
    ds_read_b64_tr_b16 v[118:119], v1 offset:33024
    s_waitcnt lgkmcnt(8)
    v_mfma_f32_16x16x32_bf16 v[20:23], v[100:103], v[144:147], v[20:23]
    ds_read_b64_tr_b16 v[120:121], v1 offset:31752
    v_mfma_f32_16x16x32_bf16 v[40:43], v[100:103], v[148:151], v[40:43]
    ds_read_b64_tr_b16 v[122:123], v1 offset:33032
    s_waitcnt lgkmcnt(8)
    v_mfma_f32_16x16x32_bf16 v[24:27], v[104:107], v[144:147], v[24:27]
    ds_read_b64_tr_b16 v[124:125], v1 offset:31760
    v_mfma_f32_16x16x32_bf16 v[44:47], v[104:107], v[148:151], v[44:47]
    ds_read_b64_tr_b16 v[126:127], v1 offset:33040
    s_waitcnt lgkmcnt(8)
    v_mfma_f32_16x16x32_bf16 v[28:31], v[108:111], v[144:147], v[28:31]
    ds_read_b64_tr_b16 v[128:129], v1 offset:31768
    v_mfma_f32_16x16x32_bf16 v[48:51], v[108:111], v[148:151], v[48:51]
    ds_read_b64_tr_b16 v[130:131], v1 offset:33048
    s_waitcnt lgkmcnt(8)
    v_mfma_f32_16x16x32_bf16 v[32:35], v[112:115], v[144:147], v[32:35]
    ds_read_b64_tr_b16 v[132:133], v1 offset:31776
    v_mfma_f32_16x16x32_bf16 v[52:55], v[112:115], v[148:151], v[52:55]
    ds_read_b64_tr_b16 v[134:135], v1 offset:33056
    s_waitcnt lgkmcnt(8)
    v_mfma_f32_16x16x32_bf16 v[56:59], v[116:119], v[144:147], v[56:59]
    v_add_u32 v1, 4294930432, v1
    v_mfma_f32_16x16x32_bf16 v[76:79], v[116:119], v[148:151], v[76:79]
    v_add_u32 v2, 4294930432, v2
    v_add_u32 v3, 4294930432, v3
    s_waitcnt lgkmcnt(6)
    v_mfma_f32_16x16x32_bf16 v[60:63], v[120:123], v[144:147], v[60:63]
    s_barrier
    v_mfma_f32_16x16x32_bf16 v[80:83], v[120:123], v[148:151], v[80:83]
    ds_read_b128 v[136:139], v2 offset:0
    ds_read_b128 v[140:143], v2 offset:2048
    s_waitcnt lgkmcnt(6)
    v_mfma_f32_16x16x32_bf16 v[64:67], v[124:127], v[144:147], v[64:67]
    ds_read_b64_tr_b16 v[96:97], v1 offset:16384
    ds_read_b64_tr_b16 v[98:99], v1 offset:17664
    v_mfma_f32_16x16x32_bf16 v[84:87], v[124:127], v[148:151], v[84:87]
    ds_read_b64_tr_b16 v[100:101], v1 offset:16392
    s_waitcnt lgkmcnt(7)
    v_mfma_f32_16x16x32_bf16 v[68:71], v[128:131], v[144:147], v[68:71]
    ds_read_b64_tr_b16 v[102:103], v1 offset:17672
    ds_read_b64_tr_b16 v[104:105], v1 offset:16400
    v_mfma_f32_16x16x32_bf16 v[88:91], v[128:131], v[148:151], v[88:91]
    ds_read_b64_tr_b16 v[106:107], v1 offset:17680
    s_waitcnt lgkmcnt(8)
    v_mfma_f32_16x16x32_bf16 v[72:75], v[132:135], v[144:147], v[72:75]
    ds_read_b64_tr_b16 v[108:109], v1 offset:16408
    ds_read_b64_tr_b16 v[110:111], v1 offset:17688
    v_mfma_f32_16x16x32_bf16 v[92:95], v[132:135], v[148:151], v[92:95]
    ds_read_b64_tr_b16 v[112:113], v1 offset:16416
    ds_read_b64_tr_b16 v[114:115], v1 offset:17696
    s_waitcnt lgkmcnt(8)
    v_mfma_f32_16x16x32_bf16 v[16:19], v[96:99], v[136:139], v[16:19]
    ds_read_b64_tr_b16 v[116:117], v1 offset:26624
    v_mfma_f32_16x16x32_bf16 v[36:39], v[96:99], v[140:143], v[36:39]
    ds_read_b64_tr_b16 v[118:119], v1 offset:27904
    s_waitcnt lgkmcnt(8)
    v_mfma_f32_16x16x32_bf16 v[20:23], v[100:103], v[136:139], v[20:23]
    ds_read_b64_tr_b16 v[120:121], v1 offset:26632
    v_mfma_f32_16x16x32_bf16 v[40:43], v[100:103], v[140:143], v[40:43]
    ds_read_b64_tr_b16 v[122:123], v1 offset:27912
    s_waitcnt lgkmcnt(8)
    v_mfma_f32_16x16x32_bf16 v[24:27], v[104:107], v[136:139], v[24:27]
    ds_read_b64_tr_b16 v[124:125], v1 offset:26640
    v_mfma_f32_16x16x32_bf16 v[44:47], v[104:107], v[140:143], v[44:47]
    ds_read_b64_tr_b16 v[126:127], v1 offset:27920
    s_waitcnt lgkmcnt(8)
    v_mfma_f32_16x16x32_bf16 v[28:31], v[108:111], v[136:139], v[28:31]
    ds_read_b64_tr_b16 v[128:129], v1 offset:26648
    v_mfma_f32_16x16x32_bf16 v[48:51], v[108:111], v[140:143], v[48:51]
    ds_read_b64_tr_b16 v[130:131], v1 offset:27928
    s_waitcnt lgkmcnt(8)
    v_mfma_f32_16x16x32_bf16 v[32:35], v[112:115], v[136:139], v[32:35]
    ds_read_b64_tr_b16 v[132:133], v1 offset:26656
    v_mfma_f32_16x16x32_bf16 v[52:55], v[112:115], v[140:143], v[52:55]
    ds_read_b64_tr_b16 v[134:135], v1 offset:27936
    s_waitcnt lgkmcnt(8)
    v_mfma_f32_16x16x32_bf16 v[56:59], v[116:119], v[136:139], v[56:59]
    ds_read_b128 v[144:147], v3 offset:0
    v_mfma_f32_16x16x32_bf16 v[76:79], v[116:119], v[140:143], v[76:79]
    ds_read_b128 v[148:151], v3 offset:2048
    s_waitcnt lgkmcnt(8)
    v_mfma_f32_16x16x32_bf16 v[60:63], v[120:123], v[136:139], v[60:63]
    ds_read_b64_tr_b16 v[96:97], v1 offset:21504
    v_mfma_f32_16x16x32_bf16 v[80:83], v[120:123], v[140:143], v[80:83]
    ds_read_b64_tr_b16 v[98:99], v1 offset:22784
    s_waitcnt lgkmcnt(8)
    v_mfma_f32_16x16x32_bf16 v[64:67], v[124:127], v[136:139], v[64:67]
    ds_read_b64_tr_b16 v[100:101], v1 offset:21512
    ds_read_b64_tr_b16 v[102:103], v1 offset:22792
    v_mfma_f32_16x16x32_bf16 v[84:87], v[124:127], v[140:143], v[84:87]
    ds_read_b64_tr_b16 v[104:105], v1 offset:21520
    s_waitcnt lgkmcnt(9)
    v_mfma_f32_16x16x32_bf16 v[68:71], v[128:131], v[136:139], v[68:71]
    ds_read_b64_tr_b16 v[106:107], v1 offset:22800
    v_mfma_f32_16x16x32_bf16 v[88:91], v[128:131], v[140:143], v[88:91]
    ds_read_b64_tr_b16 v[108:109], v1 offset:21528
    s_waitcnt lgkmcnt(9)
    v_mfma_f32_16x16x32_bf16 v[72:75], v[132:135], v[136:139], v[72:75]
    ds_read_b64_tr_b16 v[110:111], v1 offset:22808
    v_mfma_f32_16x16x32_bf16 v[92:95], v[132:135], v[140:143], v[92:95]
    ds_read_b64_tr_b16 v[112:113], v1 offset:21536
    ds_read_b64_tr_b16 v[114:115], v1 offset:22816
    s_waitcnt lgkmcnt(8)
    v_mfma_f32_16x16x32_bf16 v[16:19], v[96:99], v[144:147], v[16:19]
    ds_read_b64_tr_b16 v[116:117], v1 offset:31744
    v_mfma_f32_16x16x32_bf16 v[36:39], v[96:99], v[148:151], v[36:39]
    ds_read_b64_tr_b16 v[118:119], v1 offset:33024
    s_waitcnt lgkmcnt(8)
    v_mfma_f32_16x16x32_bf16 v[20:23], v[100:103], v[144:147], v[20:23]
    ds_read_b64_tr_b16 v[120:121], v1 offset:31752
    v_mfma_f32_16x16x32_bf16 v[40:43], v[100:103], v[148:151], v[40:43]
    ds_read_b64_tr_b16 v[122:123], v1 offset:33032
    s_waitcnt lgkmcnt(8)
    v_mfma_f32_16x16x32_bf16 v[24:27], v[104:107], v[144:147], v[24:27]
    ds_read_b64_tr_b16 v[124:125], v1 offset:31760
    v_mfma_f32_16x16x32_bf16 v[44:47], v[104:107], v[148:151], v[44:47]
    ds_read_b64_tr_b16 v[126:127], v1 offset:33040
    s_waitcnt lgkmcnt(8)
    v_mfma_f32_16x16x32_bf16 v[28:31], v[108:111], v[144:147], v[28:31]
    ds_read_b64_tr_b16 v[128:129], v1 offset:31768
    v_mfma_f32_16x16x32_bf16 v[48:51], v[108:111], v[148:151], v[48:51]
    ds_read_b64_tr_b16 v[130:131], v1 offset:33048
    s_waitcnt lgkmcnt(8)
    v_mfma_f32_16x16x32_bf16 v[32:35], v[112:115], v[144:147], v[32:35]
    ds_read_b64_tr_b16 v[132:133], v1 offset:31776
    v_mfma_f32_16x16x32_bf16 v[52:55], v[112:115], v[148:151], v[52:55]
    ds_read_b64_tr_b16 v[134:135], v1 offset:33056
    s_waitcnt lgkmcnt(8)
    v_mfma_f32_16x16x32_bf16 v[56:59], v[116:119], v[144:147], v[56:59]
    v_add_u32 v1, 110592, v1
    v_mfma_f32_16x16x32_bf16 v[76:79], v[116:119], v[148:151], v[76:79]
    v_add_u32 v2, 110592, v2
    v_add_u32 v3, 110592, v3
    s_waitcnt lgkmcnt(6)
    v_mfma_f32_16x16x32_bf16 v[60:63], v[120:123], v[144:147], v[60:63]
    s_barrier
    v_mfma_f32_16x16x32_bf16 v[80:83], v[120:123], v[148:151], v[80:83]
    ds_read_b128 v[136:139], v2 offset:0
    ds_read_b128 v[140:143], v2 offset:2048
    s_waitcnt lgkmcnt(6)
    v_mfma_f32_16x16x32_bf16 v[64:67], v[124:127], v[144:147], v[64:67]
    ds_read_b64_tr_b16 v[96:97], v1 offset:16384
    ds_read_b64_tr_b16 v[98:99], v1 offset:17664
    v_mfma_f32_16x16x32_bf16 v[84:87], v[124:127], v[148:151], v[84:87]
    ds_read_b64_tr_b16 v[100:101], v1 offset:16392
    s_waitcnt lgkmcnt(7)
    v_mfma_f32_16x16x32_bf16 v[68:71], v[128:131], v[144:147], v[68:71]
    ds_read_b64_tr_b16 v[102:103], v1 offset:17672
    ds_read_b64_tr_b16 v[104:105], v1 offset:16400
    v_mfma_f32_16x16x32_bf16 v[88:91], v[128:131], v[148:151], v[88:91]
    ds_read_b64_tr_b16 v[106:107], v1 offset:17680
    s_waitcnt lgkmcnt(8)
    v_mfma_f32_16x16x32_bf16 v[72:75], v[132:135], v[144:147], v[72:75]
    ds_read_b64_tr_b16 v[108:109], v1 offset:16408
    ds_read_b64_tr_b16 v[110:111], v1 offset:17688
    v_mfma_f32_16x16x32_bf16 v[92:95], v[132:135], v[148:151], v[92:95]
    ds_read_b64_tr_b16 v[112:113], v1 offset:16416
    ds_read_b64_tr_b16 v[114:115], v1 offset:17696
    s_waitcnt lgkmcnt(8)
    v_mfma_f32_16x16x32_bf16 v[16:19], v[96:99], v[136:139], v[16:19]
    ds_read_b64_tr_b16 v[116:117], v1 offset:26624
    v_mfma_f32_16x16x32_bf16 v[36:39], v[96:99], v[140:143], v[36:39]
    ds_read_b64_tr_b16 v[118:119], v1 offset:27904
    s_waitcnt lgkmcnt(8)
    v_mfma_f32_16x16x32_bf16 v[20:23], v[100:103], v[136:139], v[20:23]
    ds_read_b64_tr_b16 v[120:121], v1 offset:26632
    v_mfma_f32_16x16x32_bf16 v[40:43], v[100:103], v[140:143], v[40:43]
    ds_read_b64_tr_b16 v[122:123], v1 offset:27912
    s_waitcnt lgkmcnt(8)
    v_mfma_f32_16x16x32_bf16 v[24:27], v[104:107], v[136:139], v[24:27]
    ds_read_b64_tr_b16 v[124:125], v1 offset:26640
    v_mfma_f32_16x16x32_bf16 v[44:47], v[104:107], v[140:143], v[44:47]
    ds_read_b64_tr_b16 v[126:127], v1 offset:27920
    s_waitcnt lgkmcnt(8)
    v_mfma_f32_16x16x32_bf16 v[28:31], v[108:111], v[136:139], v[28:31]
    ds_read_b64_tr_b16 v[128:129], v1 offset:26648
    v_mfma_f32_16x16x32_bf16 v[48:51], v[108:111], v[140:143], v[48:51]
    ds_read_b64_tr_b16 v[130:131], v1 offset:27928
    s_waitcnt lgkmcnt(8)
    v_mfma_f32_16x16x32_bf16 v[32:35], v[112:115], v[136:139], v[32:35]
    ds_read_b64_tr_b16 v[132:133], v1 offset:26656
    v_mfma_f32_16x16x32_bf16 v[52:55], v[112:115], v[140:143], v[52:55]
    ds_read_b64_tr_b16 v[134:135], v1 offset:27936
    s_waitcnt lgkmcnt(8)
    v_mfma_f32_16x16x32_bf16 v[56:59], v[116:119], v[136:139], v[56:59]
    ds_read_b128 v[144:147], v3 offset:0
    v_mfma_f32_16x16x32_bf16 v[76:79], v[116:119], v[140:143], v[76:79]
    ds_read_b128 v[148:151], v3 offset:2048
    s_waitcnt lgkmcnt(8)
    v_mfma_f32_16x16x32_bf16 v[60:63], v[120:123], v[136:139], v[60:63]
    ds_read_b64_tr_b16 v[96:97], v1 offset:21504
    v_mfma_f32_16x16x32_bf16 v[80:83], v[120:123], v[140:143], v[80:83]
    ds_read_b64_tr_b16 v[98:99], v1 offset:22784
    s_waitcnt lgkmcnt(8)
    v_mfma_f32_16x16x32_bf16 v[64:67], v[124:127], v[136:139], v[64:67]
    ds_read_b64_tr_b16 v[100:101], v1 offset:21512
    ds_read_b64_tr_b16 v[102:103], v1 offset:22792
    v_mfma_f32_16x16x32_bf16 v[84:87], v[124:127], v[140:143], v[84:87]
    ds_read_b64_tr_b16 v[104:105], v1 offset:21520
    s_waitcnt lgkmcnt(9)
    v_mfma_f32_16x16x32_bf16 v[68:71], v[128:131], v[136:139], v[68:71]
    ds_read_b64_tr_b16 v[106:107], v1 offset:22800
    v_mfma_f32_16x16x32_bf16 v[88:91], v[128:131], v[140:143], v[88:91]
    ds_read_b64_tr_b16 v[108:109], v1 offset:21528
    s_waitcnt lgkmcnt(9)
    v_mfma_f32_16x16x32_bf16 v[72:75], v[132:135], v[136:139], v[72:75]
    ds_read_b64_tr_b16 v[110:111], v1 offset:22808
    v_mfma_f32_16x16x32_bf16 v[92:95], v[132:135], v[140:143], v[92:95]
    ds_read_b64_tr_b16 v[112:113], v1 offset:21536
    ds_read_b64_tr_b16 v[114:115], v1 offset:22816
    s_waitcnt lgkmcnt(8)
    v_mfma_f32_16x16x32_bf16 v[16:19], v[96:99], v[144:147], v[16:19]
    ds_read_b64_tr_b16 v[116:117], v1 offset:31744
    v_mfma_f32_16x16x32_bf16 v[36:39], v[96:99], v[148:151], v[36:39]
    ds_read_b64_tr_b16 v[118:119], v1 offset:33024
    s_waitcnt lgkmcnt(8)
    v_mfma_f32_16x16x32_bf16 v[20:23], v[100:103], v[144:147], v[20:23]
    ds_read_b64_tr_b16 v[120:121], v1 offset:31752
    v_mfma_f32_16x16x32_bf16 v[40:43], v[100:103], v[148:151], v[40:43]
    ds_read_b64_tr_b16 v[122:123], v1 offset:33032
    s_waitcnt lgkmcnt(8)
    v_mfma_f32_16x16x32_bf16 v[24:27], v[104:107], v[144:147], v[24:27]
    ds_read_b64_tr_b16 v[124:125], v1 offset:31760
    v_mfma_f32_16x16x32_bf16 v[44:47], v[104:107], v[148:151], v[44:47]
    ds_read_b64_tr_b16 v[126:127], v1 offset:33040
    s_waitcnt lgkmcnt(8)
    v_mfma_f32_16x16x32_bf16 v[28:31], v[108:111], v[144:147], v[28:31]
    ds_read_b64_tr_b16 v[128:129], v1 offset:31768
    v_mfma_f32_16x16x32_bf16 v[48:51], v[108:111], v[148:151], v[48:51]
    ds_read_b64_tr_b16 v[130:131], v1 offset:33048
    s_waitcnt lgkmcnt(8)
    v_mfma_f32_16x16x32_bf16 v[32:35], v[112:115], v[144:147], v[32:35]
    ds_read_b64_tr_b16 v[132:133], v1 offset:31776
    v_mfma_f32_16x16x32_bf16 v[52:55], v[112:115], v[148:151], v[52:55]
    ds_read_b64_tr_b16 v[134:135], v1 offset:33056
    s_waitcnt lgkmcnt(8)
    v_mfma_f32_16x16x32_bf16 v[56:59], v[116:119], v[144:147], v[56:59]
    v_add_u32 v1, 4294930432, v1
    v_mfma_f32_16x16x32_bf16 v[76:79], v[116:119], v[148:151], v[76:79]
    v_add_u32 v2, 4294930432, v2
    v_add_u32 v3, 4294930432, v3
    s_waitcnt lgkmcnt(6)
    v_mfma_f32_16x16x32_bf16 v[60:63], v[120:123], v[144:147], v[60:63]
    s_barrier
    v_mfma_f32_16x16x32_bf16 v[80:83], v[120:123], v[148:151], v[80:83]
    ds_read_b128 v[136:139], v2 offset:0
    ds_read_b128 v[140:143], v2 offset:2048
    s_waitcnt lgkmcnt(6)
    v_mfma_f32_16x16x32_bf16 v[64:67], v[124:127], v[144:147], v[64:67]
    ds_read_b64_tr_b16 v[96:97], v1 offset:16384
    ds_read_b64_tr_b16 v[98:99], v1 offset:17664
    v_mfma_f32_16x16x32_bf16 v[84:87], v[124:127], v[148:151], v[84:87]
    ds_read_b64_tr_b16 v[100:101], v1 offset:16392
    s_waitcnt lgkmcnt(7)
    v_mfma_f32_16x16x32_bf16 v[68:71], v[128:131], v[144:147], v[68:71]
    ds_read_b64_tr_b16 v[102:103], v1 offset:17672
    ds_read_b64_tr_b16 v[104:105], v1 offset:16400
    v_mfma_f32_16x16x32_bf16 v[88:91], v[128:131], v[148:151], v[88:91]
    ds_read_b64_tr_b16 v[106:107], v1 offset:17680
    s_waitcnt lgkmcnt(8)
    v_mfma_f32_16x16x32_bf16 v[72:75], v[132:135], v[144:147], v[72:75]
    ds_read_b64_tr_b16 v[108:109], v1 offset:16408
    ds_read_b64_tr_b16 v[110:111], v1 offset:17688
    v_mfma_f32_16x16x32_bf16 v[92:95], v[132:135], v[148:151], v[92:95]
    ds_read_b64_tr_b16 v[112:113], v1 offset:16416
    ds_read_b64_tr_b16 v[114:115], v1 offset:17696
    s_waitcnt lgkmcnt(8)
    v_mfma_f32_16x16x32_bf16 v[16:19], v[96:99], v[136:139], v[16:19]
    ds_read_b64_tr_b16 v[116:117], v1 offset:26624
    v_mfma_f32_16x16x32_bf16 v[36:39], v[96:99], v[140:143], v[36:39]
    ds_read_b64_tr_b16 v[118:119], v1 offset:27904
    s_waitcnt lgkmcnt(8)
    v_mfma_f32_16x16x32_bf16 v[20:23], v[100:103], v[136:139], v[20:23]
    ds_read_b64_tr_b16 v[120:121], v1 offset:26632
    v_mfma_f32_16x16x32_bf16 v[40:43], v[100:103], v[140:143], v[40:43]
    ds_read_b64_tr_b16 v[122:123], v1 offset:27912
    s_waitcnt lgkmcnt(8)
    v_mfma_f32_16x16x32_bf16 v[24:27], v[104:107], v[136:139], v[24:27]
    ds_read_b64_tr_b16 v[124:125], v1 offset:26640
    v_mfma_f32_16x16x32_bf16 v[44:47], v[104:107], v[140:143], v[44:47]
    ds_read_b64_tr_b16 v[126:127], v1 offset:27920
    s_waitcnt lgkmcnt(8)
    v_mfma_f32_16x16x32_bf16 v[28:31], v[108:111], v[136:139], v[28:31]
    ds_read_b64_tr_b16 v[128:129], v1 offset:26648
    v_mfma_f32_16x16x32_bf16 v[48:51], v[108:111], v[140:143], v[48:51]
    ds_read_b64_tr_b16 v[130:131], v1 offset:27928
    s_waitcnt lgkmcnt(8)
    v_mfma_f32_16x16x32_bf16 v[32:35], v[112:115], v[136:139], v[32:35]
    ds_read_b64_tr_b16 v[132:133], v1 offset:26656
    v_mfma_f32_16x16x32_bf16 v[52:55], v[112:115], v[140:143], v[52:55]
    ds_read_b64_tr_b16 v[134:135], v1 offset:27936
    s_waitcnt lgkmcnt(8)
    v_mfma_f32_16x16x32_bf16 v[56:59], v[116:119], v[136:139], v[56:59]
    ds_read_b128 v[144:147], v3 offset:0
    v_mfma_f32_16x16x32_bf16 v[76:79], v[116:119], v[140:143], v[76:79]
    ds_read_b128 v[148:151], v3 offset:2048
    s_waitcnt lgkmcnt(8)
    v_mfma_f32_16x16x32_bf16 v[60:63], v[120:123], v[136:139], v[60:63]
    ds_read_b64_tr_b16 v[96:97], v1 offset:21504
    v_mfma_f32_16x16x32_bf16 v[80:83], v[120:123], v[140:143], v[80:83]
    ds_read_b64_tr_b16 v[98:99], v1 offset:22784
    s_waitcnt lgkmcnt(8)
    v_mfma_f32_16x16x32_bf16 v[64:67], v[124:127], v[136:139], v[64:67]
    ds_read_b64_tr_b16 v[100:101], v1 offset:21512
    ds_read_b64_tr_b16 v[102:103], v1 offset:22792
    v_mfma_f32_16x16x32_bf16 v[84:87], v[124:127], v[140:143], v[84:87]
    ds_read_b64_tr_b16 v[104:105], v1 offset:21520
    s_waitcnt lgkmcnt(9)
    v_mfma_f32_16x16x32_bf16 v[68:71], v[128:131], v[136:139], v[68:71]
    ds_read_b64_tr_b16 v[106:107], v1 offset:22800
    v_mfma_f32_16x16x32_bf16 v[88:91], v[128:131], v[140:143], v[88:91]
    ds_read_b64_tr_b16 v[108:109], v1 offset:21528
    s_waitcnt lgkmcnt(9)
    v_mfma_f32_16x16x32_bf16 v[72:75], v[132:135], v[136:139], v[72:75]
    ds_read_b64_tr_b16 v[110:111], v1 offset:22808
L_wb_3:
    s_cbranch_execz L_wb_4
    v_mfma_f32_16x16x32_bf16 v[92:95], v[132:135], v[140:143], v[92:95]
    ds_read_b64_tr_b16 v[112:113], v1 offset:21536
    ds_read_b64_tr_b16 v[114:115], v1 offset:22816
    s_waitcnt lgkmcnt(8)
    v_mfma_f32_16x16x32_bf16 v[16:19], v[96:99], v[144:147], v[16:19]
    ds_read_b64_tr_b16 v[116:117], v1 offset:31744
    v_mfma_f32_16x16x32_bf16 v[36:39], v[96:99], v[148:151], v[36:39]
    ds_read_b64_tr_b16 v[118:119], v1 offset:33024
    s_waitcnt lgkmcnt(8)
    v_mfma_f32_16x16x32_bf16 v[20:23], v[100:103], v[144:147], v[20:23]
    ds_read_b64_tr_b16 v[120:121], v1 offset:31752
    v_mfma_f32_16x16x32_bf16 v[40:43], v[100:103], v[148:151], v[40:43]
    ds_read_b64_tr_b16 v[122:123], v1 offset:33032
    s_waitcnt lgkmcnt(8)
    v_mfma_f32_16x16x32_bf16 v[24:27], v[104:107], v[144:147], v[24:27]
    ds_read_b64_tr_b16 v[124:125], v1 offset:31760
    v_mfma_f32_16x16x32_bf16 v[44:47], v[104:107], v[148:151], v[44:47]
    ds_read_b64_tr_b16 v[126:127], v1 offset:33040
    s_waitcnt lgkmcnt(8)
    v_mfma_f32_16x16x32_bf16 v[28:31], v[108:111], v[144:147], v[28:31]
    ds_read_b64_tr_b16 v[128:129], v1 offset:31768
    v_mfma_f32_16x16x32_bf16 v[48:51], v[108:111], v[148:151], v[48:51]
    ds_read_b64_tr_b16 v[130:131], v1 offset:33048
    s_waitcnt lgkmcnt(8)
    v_mfma_f32_16x16x32_bf16 v[32:35], v[112:115], v[144:147], v[32:35]
    ds_read_b64_tr_b16 v[132:133], v1 offset:31776
    v_mfma_f32_16x16x32_bf16 v[52:55], v[112:115], v[148:151], v[52:55]
    ds_read_b64_tr_b16 v[134:135], v1 offset:33056
    s_waitcnt lgkmcnt(8)
    v_mfma_f32_16x16x32_bf16 v[56:59], v[116:119], v[144:147], v[56:59]
    v_add_u32 v1, 4294930432, v1
    v_mfma_f32_16x16x32_bf16 v[76:79], v[116:119], v[148:151], v[76:79]
    v_add_u32 v2, 4294930432, v2
    v_add_u32 v3, 4294930432, v3
    s_waitcnt lgkmcnt(6)
    v_mfma_f32_16x16x32_bf16 v[60:63], v[120:123], v[144:147], v[60:63]
    s_barrier
    v_mfma_f32_16x16x32_bf16 v[80:83], v[120:123], v[148:151], v[80:83]
    ds_read_b128 v[136:139], v2 offset:0
    ds_read_b128 v[140:143], v2 offset:2048
    s_waitcnt lgkmcnt(6)
    v_mfma_f32_16x16x32_bf16 v[64:67], v[124:127], v[144:147], v[64:67]
    ds_read_b64_tr_b16 v[96:97], v1 offset:16384
    ds_read_b64_tr_b16 v[98:99], v1 offset:17664
    v_mfma_f32_16x16x32_bf16 v[84:87], v[124:127], v[148:151], v[84:87]
    ds_read_b64_tr_b16 v[100:101], v1 offset:16392
    s_waitcnt lgkmcnt(7)
    v_mfma_f32_16x16x32_bf16 v[68:71], v[128:131], v[144:147], v[68:71]
    ds_read_b64_tr_b16 v[102:103], v1 offset:17672
    ds_read_b64_tr_b16 v[104:105], v1 offset:16400
    v_mfma_f32_16x16x32_bf16 v[88:91], v[128:131], v[148:151], v[88:91]
    ds_read_b64_tr_b16 v[106:107], v1 offset:17680
    s_waitcnt lgkmcnt(8)
    v_mfma_f32_16x16x32_bf16 v[72:75], v[132:135], v[144:147], v[72:75]
    ds_read_b64_tr_b16 v[108:109], v1 offset:16408
    ds_read_b64_tr_b16 v[110:111], v1 offset:17688
    v_mfma_f32_16x16x32_bf16 v[92:95], v[132:135], v[148:151], v[92:95]
    ds_read_b64_tr_b16 v[112:113], v1 offset:16416
    ds_read_b64_tr_b16 v[114:115], v1 offset:17696
    s_waitcnt lgkmcnt(8)
    v_mfma_f32_16x16x32_bf16 v[16:19], v[96:99], v[136:139], v[16:19]
    ds_read_b64_tr_b16 v[116:117], v1 offset:26624
    v_mfma_f32_16x16x32_bf16 v[36:39], v[96:99], v[140:143], v[36:39]
    ds_read_b64_tr_b16 v[118:119], v1 offset:27904
    s_waitcnt lgkmcnt(8)
    v_mfma_f32_16x16x32_bf16 v[20:23], v[100:103], v[136:139], v[20:23]
    ds_read_b64_tr_b16 v[120:121], v1 offset:26632
    v_mfma_f32_16x16x32_bf16 v[40:43], v[100:103], v[140:143], v[40:43]
    ds_read_b64_tr_b16 v[122:123], v1 offset:27912
    s_waitcnt lgkmcnt(8)
    v_mfma_f32_16x16x32_bf16 v[24:27], v[104:107], v[136:139], v[24:27]
    ds_read_b64_tr_b16 v[124:125], v1 offset:26640
    v_mfma_f32_16x16x32_bf16 v[44:47], v[104:107], v[140:143], v[44:47]
    ds_read_b64_tr_b16 v[126:127], v1 offset:27920
    s_waitcnt lgkmcnt(8)
    v_mfma_f32_16x16x32_bf16 v[28:31], v[108:111], v[136:139], v[28:31]
    ds_read_b64_tr_b16 v[128:129], v1 offset:26648
    v_mfma_f32_16x16x32_bf16 v[48:51], v[108:111], v[140:143], v[48:51]
    ds_read_b64_tr_b16 v[130:131], v1 offset:27928
    s_waitcnt lgkmcnt(8)
    v_mfma_f32_16x16x32_bf16 v[32:35], v[112:115], v[136:139], v[32:35]
    ds_read_b64_tr_b16 v[132:133], v1 offset:26656
    v_mfma_f32_16x16x32_bf16 v[52:55], v[112:115], v[140:143], v[52:55]
    ds_read_b64_tr_b16 v[134:135], v1 offset:27936
    s_waitcnt lgkmcnt(8)
    v_mfma_f32_16x16x32_bf16 v[56:59], v[116:119], v[136:139], v[56:59]
    ds_read_b128 v[144:147], v3 offset:0
    v_mfma_f32_16x16x32_bf16 v[76:79], v[116:119], v[140:143], v[76:79]
    ds_read_b128 v[148:151], v3 offset:2048
    s_waitcnt lgkmcnt(8)
    v_mfma_f32_16x16x32_bf16 v[60:63], v[120:123], v[136:139], v[60:63]
    ds_read_b64_tr_b16 v[96:97], v1 offset:21504
    v_mfma_f32_16x16x32_bf16 v[80:83], v[120:123], v[140:143], v[80:83]
    ds_read_b64_tr_b16 v[98:99], v1 offset:22784
    s_waitcnt lgkmcnt(8)
    v_mfma_f32_16x16x32_bf16 v[64:67], v[124:127], v[136:139], v[64:67]
    ds_read_b64_tr_b16 v[100:101], v1 offset:21512
    ds_read_b64_tr_b16 v[102:103], v1 offset:22792
    v_mfma_f32_16x16x32_bf16 v[84:87], v[124:127], v[140:143], v[84:87]
    ds_read_b64_tr_b16 v[104:105], v1 offset:21520
    s_waitcnt lgkmcnt(9)
    v_mfma_f32_16x16x32_bf16 v[68:71], v[128:131], v[136:139], v[68:71]
    ds_read_b64_tr_b16 v[106:107], v1 offset:22800
    v_mfma_f32_16x16x32_bf16 v[88:91], v[128:131], v[140:143], v[88:91]
    ds_read_b64_tr_b16 v[108:109], v1 offset:21528
    s_waitcnt lgkmcnt(9)
    v_mfma_f32_16x16x32_bf16 v[72:75], v[132:135], v[136:139], v[72:75]
    ds_read_b64_tr_b16 v[110:111], v1 offset:22808
    v_mfma_f32_16x16x32_bf16 v[92:95], v[132:135], v[140:143], v[92:95]
    ds_read_b64_tr_b16 v[112:113], v1 offset:21536
    ds_read_b64_tr_b16 v[114:115], v1 offset:22816
    s_waitcnt lgkmcnt(8)
    v_mfma_f32_16x16x32_bf16 v[16:19], v[96:99], v[144:147], v[16:19]
    ds_read_b64_tr_b16 v[116:117], v1 offset:31744
    v_mfma_f32_16x16x32_bf16 v[36:39], v[96:99], v[148:151], v[36:39]
    ds_read_b64_tr_b16 v[118:119], v1 offset:33024
    s_waitcnt lgkmcnt(8)
    v_mfma_f32_16x16x32_bf16 v[20:23], v[100:103], v[144:147], v[20:23]
    ds_read_b64_tr_b16 v[120:121], v1 offset:31752
    v_mfma_f32_16x16x32_bf16 v[40:43], v[100:103], v[148:151], v[40:43]
    ds_read_b64_tr_b16 v[122:123], v1 offset:33032
    s_waitcnt lgkmcnt(8)
    v_mfma_f32_16x16x32_bf16 v[24:27], v[104:107], v[144:147], v[24:27]
    ds_read_b64_tr_b16 v[124:125], v1 offset:31760
    v_mfma_f32_16x16x32_bf16 v[44:47], v[104:107], v[148:151], v[44:47]
    ds_read_b64_tr_b16 v[126:127], v1 offset:33040
    s_waitcnt lgkmcnt(8)
    v_mfma_f32_16x16x32_bf16 v[28:31], v[108:111], v[144:147], v[28:31]
    ds_read_b64_tr_b16 v[128:129], v1 offset:31768
    v_mfma_f32_16x16x32_bf16 v[48:51], v[108:111], v[148:151], v[48:51]
    ds_read_b64_tr_b16 v[130:131], v1 offset:33048
    s_waitcnt lgkmcnt(8)
    v_mfma_f32_16x16x32_bf16 v[32:35], v[112:115], v[144:147], v[32:35]
    ds_read_b64_tr_b16 v[132:133], v1 offset:31776
    v_mfma_f32_16x16x32_bf16 v[52:55], v[112:115], v[148:151], v[52:55]
    ds_read_b64_tr_b16 v[134:135], v1 offset:33056
    s_waitcnt lgkmcnt(8)
    v_mfma_f32_16x16x32_bf16 v[56:59], v[116:119], v[144:147], v[56:59]
    v_add_u32 v1, 4294930432, v1
    v_mfma_f32_16x16x32_bf16 v[76:79], v[116:119], v[148:151], v[76:79]
    v_add_u32 v2, 4294930432, v2
    v_add_u32 v3, 4294930432, v3
    s_waitcnt lgkmcnt(6)
    v_mfma_f32_16x16x32_bf16 v[60:63], v[120:123], v[144:147], v[60:63]
    s_waitcnt lgkmcnt(0)
    s_barrier
    v_mfma_f32_16x16x32_bf16 v[80:83], v[120:123], v[148:151], v[80:83]
    ds_read_b128 v[136:139], v2 offset:0
    ds_read_b128 v[140:143], v2 offset:2048
    v_mfma_f32_16x16x32_bf16 v[64:67], v[124:127], v[144:147], v[64:67]
    ds_read_b64_tr_b16 v[96:97], v1 offset:16384
    ds_read_b64_tr_b16 v[98:99], v1 offset:17664
    v_mfma_f32_16x16x32_bf16 v[84:87], v[124:127], v[148:151], v[84:87]
    ds_read_b64_tr_b16 v[100:101], v1 offset:16392
    v_mfma_f32_16x16x32_bf16 v[68:71], v[128:131], v[144:147], v[68:71]
    ds_read_b64_tr_b16 v[102:103], v1 offset:17672
    ds_read_b64_tr_b16 v[104:105], v1 offset:16400
    v_mfma_f32_16x16x32_bf16 v[88:91], v[128:131], v[148:151], v[88:91]
    ds_read_b64_tr_b16 v[106:107], v1 offset:17680
    v_mfma_f32_16x16x32_bf16 v[72:75], v[132:135], v[144:147], v[72:75]
    ds_read_b64_tr_b16 v[108:109], v1 offset:16408
    ds_read_b64_tr_b16 v[110:111], v1 offset:17688
    v_mfma_f32_16x16x32_bf16 v[92:95], v[132:135], v[148:151], v[92:95]
    ds_read_b64_tr_b16 v[112:113], v1 offset:16416
    ds_read_b64_tr_b16 v[114:115], v1 offset:17696
    s_waitcnt lgkmcnt(8)
    v_mfma_f32_16x16x32_bf16 v[16:19], v[96:99], v[136:139], v[16:19]
    ds_read_b64_tr_b16 v[116:117], v1 offset:26624
    v_mfma_f32_16x16x32_bf16 v[36:39], v[96:99], v[140:143], v[36:39]
    ds_read_b64_tr_b16 v[118:119], v1 offset:27904
    s_waitcnt lgkmcnt(8)
    v_mfma_f32_16x16x32_bf16 v[20:23], v[100:103], v[136:139], v[20:23]
    ds_read_b64_tr_b16 v[120:121], v1 offset:26632
    v_mfma_f32_16x16x32_bf16 v[40:43], v[100:103], v[140:143], v[40:43]
    ds_read_b64_tr_b16 v[122:123], v1 offset:27912
    s_waitcnt lgkmcnt(8)
    v_mfma_f32_16x16x32_bf16 v[24:27], v[104:107], v[136:139], v[24:27]
    ds_read_b64_tr_b16 v[124:125], v1 offset:26640
    v_mfma_f32_16x16x32_bf16 v[44:47], v[104:107], v[140:143], v[44:47]
    ds_read_b64_tr_b16 v[126:127], v1 offset:27920
    s_waitcnt lgkmcnt(8)
    v_mfma_f32_16x16x32_bf16 v[28:31], v[108:111], v[136:139], v[28:31]
    ds_read_b64_tr_b16 v[128:129], v1 offset:26648
    v_mfma_f32_16x16x32_bf16 v[48:51], v[108:111], v[140:143], v[48:51]
    ds_read_b64_tr_b16 v[130:131], v1 offset:27928
    s_waitcnt lgkmcnt(8)
    v_mfma_f32_16x16x32_bf16 v[32:35], v[112:115], v[136:139], v[32:35]
    ds_read_b64_tr_b16 v[132:133], v1 offset:26656
    v_mfma_f32_16x16x32_bf16 v[52:55], v[112:115], v[140:143], v[52:55]
    ds_read_b64_tr_b16 v[134:135], v1 offset:27936
    s_waitcnt lgkmcnt(8)
    v_mfma_f32_16x16x32_bf16 v[56:59], v[116:119], v[136:139], v[56:59]
    ds_read_b128 v[144:147], v3 offset:0
    v_mfma_f32_16x16x32_bf16 v[76:79], v[116:119], v[140:143], v[76:79]
    ds_read_b128 v[148:151], v3 offset:2048
    s_waitcnt lgkmcnt(8)
    v_mfma_f32_16x16x32_bf16 v[60:63], v[120:123], v[136:139], v[60:63]
    ds_read_b64_tr_b16 v[96:97], v1 offset:21504
    v_mfma_f32_16x16x32_bf16 v[80:83], v[120:123], v[140:143], v[80:83]
    ds_read_b64_tr_b16 v[98:99], v1 offset:22784
    s_waitcnt lgkmcnt(8)
    v_mfma_f32_16x16x32_bf16 v[64:67], v[124:127], v[136:139], v[64:67]
    ds_read_b64_tr_b16 v[100:101], v1 offset:21512
    ds_read_b64_tr_b16 v[102:103], v1 offset:22792
    v_mfma_f32_16x16x32_bf16 v[84:87], v[124:127], v[140:143], v[84:87]
    ds_read_b64_tr_b16 v[104:105], v1 offset:21520
    s_waitcnt lgkmcnt(9)
    v_mfma_f32_16x16x32_bf16 v[68:71], v[128:131], v[136:139], v[68:71]
    ds_read_b64_tr_b16 v[106:107], v1 offset:22800
    v_mfma_f32_16x16x32_bf16 v[88:91], v[128:131], v[140:143], v[88:91]
    ds_read_b64_tr_b16 v[108:109], v1 offset:21528
    s_waitcnt lgkmcnt(9)
    v_mfma_f32_16x16x32_bf16 v[72:75], v[132:135], v[136:139], v[72:75]
    ds_read_b64_tr_b16 v[110:111], v1 offset:22808
    v_mfma_f32_16x16x32_bf16 v[92:95], v[132:135], v[140:143], v[92:95]
    ds_read_b64_tr_b16 v[112:113], v1 offset:21536
    ds_read_b64_tr_b16 v[114:115], v1 offset:22816
    s_waitcnt lgkmcnt(8)
    v_mfma_f32_16x16x32_bf16 v[16:19], v[96:99], v[144:147], v[16:19]
    ds_read_b64_tr_b16 v[116:117], v1 offset:31744
    v_mfma_f32_16x16x32_bf16 v[36:39], v[96:99], v[148:151], v[36:39]
    ds_read_b64_tr_b16 v[118:119], v1 offset:33024
    s_waitcnt lgkmcnt(8)
    v_mfma_f32_16x16x32_bf16 v[20:23], v[100:103], v[144:147], v[20:23]
    ds_read_b64_tr_b16 v[120:121], v1 offset:31752
    v_mfma_f32_16x16x32_bf16 v[40:43], v[100:103], v[148:151], v[40:43]
    ds_read_b64_tr_b16 v[122:123], v1 offset:33032
    s_waitcnt lgkmcnt(8)
    v_mfma_f32_16x16x32_bf16 v[24:27], v[104:107], v[144:147], v[24:27]
    ds_read_b64_tr_b16 v[124:125], v1 offset:31760
    v_mfma_f32_16x16x32_bf16 v[44:47], v[104:107], v[148:151], v[44:47]
    ds_read_b64_tr_b16 v[126:127], v1 offset:33040
    s_waitcnt lgkmcnt(8)
    v_mfma_f32_16x16x32_bf16 v[28:31], v[108:111], v[144:147], v[28:31]
    ds_read_b64_tr_b16 v[128:129], v1 offset:31768
    v_mfma_f32_16x16x32_bf16 v[48:51], v[108:111], v[148:151], v[48:51]
    ds_read_b64_tr_b16 v[130:131], v1 offset:33048
    s_waitcnt lgkmcnt(8)
    v_mfma_f32_16x16x32_bf16 v[32:35], v[112:115], v[144:147], v[32:35]
    ds_read_b64_tr_b16 v[132:133], v1 offset:31776
    v_mfma_f32_16x16x32_bf16 v[52:55], v[112:115], v[148:151], v[52:55]
    ds_read_b64_tr_b16 v[134:135], v1 offset:33056
    s_waitcnt lgkmcnt(8)
    v_mfma_f32_16x16x32_bf16 v[56:59], v[116:119], v[144:147], v[56:59]
    v_add_u32 v1, 110592, v1
    v_mfma_f32_16x16x32_bf16 v[76:79], v[116:119], v[148:151], v[76:79]
    v_add_u32 v2, 110592, v2
    v_add_u32 v3, 110592, v3
    s_waitcnt lgkmcnt(6)
    v_mfma_f32_16x16x32_bf16 v[60:63], v[120:123], v[144:147], v[60:63]
    s_waitcnt lgkmcnt(0)
    s_barrier
    v_mfma_f32_16x16x32_bf16 v[80:83], v[120:123], v[148:151], v[80:83]
    ds_read_b128 v[136:139], v2 offset:0
    ds_read_b128 v[140:143], v2 offset:2048
    v_mfma_f32_16x16x32_bf16 v[64:67], v[124:127], v[144:147], v[64:67]
    ds_read_b64_tr_b16 v[96:97], v1 offset:16384
    ds_read_b64_tr_b16 v[98:99], v1 offset:17664
    v_mfma_f32_16x16x32_bf16 v[84:87], v[124:127], v[148:151], v[84:87]
    ds_read_b64_tr_b16 v[100:101], v1 offset:16392
    v_mfma_f32_16x16x32_bf16 v[68:71], v[128:131], v[144:147], v[68:71]
    ds_read_b64_tr_b16 v[102:103], v1 offset:17672
    ds_read_b64_tr_b16 v[104:105], v1 offset:16400
    v_mfma_f32_16x16x32_bf16 v[88:91], v[128:131], v[148:151], v[88:91]
    ds_read_b64_tr_b16 v[106:107], v1 offset:17680
    v_mfma_f32_16x16x32_bf16 v[72:75], v[132:135], v[144:147], v[72:75]
    ds_read_b64_tr_b16 v[108:109], v1 offset:16408
    ds_read_b64_tr_b16 v[110:111], v1 offset:17688
    v_mfma_f32_16x16x32_bf16 v[92:95], v[132:135], v[148:151], v[92:95]
    ds_read_b64_tr_b16 v[112:113], v1 offset:16416
    ds_read_b64_tr_b16 v[114:115], v1 offset:17696
    s_waitcnt lgkmcnt(8)
    v_mfma_f32_16x16x32_bf16 v[16:19], v[96:99], v[136:139], v[16:19]
    ds_read_b128 v[144:147], v3 offset:0
    v_mfma_f32_16x16x32_bf16 v[36:39], v[96:99], v[140:143], v[36:39]
    ds_read_b128 v[148:151], v3 offset:2048
    s_waitcnt lgkmcnt(8)
    v_mfma_f32_16x16x32_bf16 v[20:23], v[100:103], v[136:139], v[20:23]
    ds_read_b64_tr_b16 v[116:117], v1 offset:21504
    v_mfma_f32_16x16x32_bf16 v[40:43], v[100:103], v[140:143], v[40:43]
    ds_read_b64_tr_b16 v[118:119], v1 offset:22784
    s_waitcnt lgkmcnt(8)
    v_mfma_f32_16x16x32_bf16 v[24:27], v[104:107], v[136:139], v[24:27]
    ds_read_b64_tr_b16 v[120:121], v1 offset:21512
    ds_read_b64_tr_b16 v[122:123], v1 offset:22792
    v_mfma_f32_16x16x32_bf16 v[44:47], v[104:107], v[140:143], v[44:47]
    ds_read_b64_tr_b16 v[124:125], v1 offset:21520
    s_waitcnt lgkmcnt(9)
    v_mfma_f32_16x16x32_bf16 v[28:31], v[108:111], v[136:139], v[28:31]
    ds_read_b64_tr_b16 v[126:127], v1 offset:22800
    v_mfma_f32_16x16x32_bf16 v[48:51], v[108:111], v[140:143], v[48:51]
    ds_read_b64_tr_b16 v[128:129], v1 offset:21528
    s_waitcnt lgkmcnt(9)
    v_mfma_f32_16x16x32_bf16 v[32:35], v[112:115], v[136:139], v[32:35]
    ds_read_b64_tr_b16 v[130:131], v1 offset:22808
    v_mfma_f32_16x16x32_bf16 v[52:55], v[112:115], v[140:143], v[52:55]
    ds_read_b64_tr_b16 v[132:133], v1 offset:21536
    ds_read_b64_tr_b16 v[134:135], v1 offset:22816
    s_waitcnt lgkmcnt(8)
    v_mfma_f32_16x16x32_bf16 v[16:19], v[116:119], v[144:147], v[16:19]
    ds_read_b64_tr_b16 v[96:97], v1 offset:26624
    s_waitcnt lgkmcnt(7)
    v_mfma_f32_16x16x32_bf16 v[20:23], v[120:123], v[144:147], v[20:23]
    ds_read_b64_tr_b16 v[98:99], v1 offset:27904
    s_waitcnt lgkmcnt(6)
    v_mfma_f32_16x16x32_bf16 v[24:27], v[124:127], v[144:147], v[24:27]
    ds_read_b64_tr_b16 v[100:101], v1 offset:26632
    s_waitcnt lgkmcnt(5)
    v_mfma_f32_16x16x32_bf16 v[28:31], v[128:131], v[144:147], v[28:31]
    ds_read_b64_tr_b16 v[102:103], v1 offset:27912
    s_waitcnt lgkmcnt(4)
    v_mfma_f32_16x16x32_bf16 v[32:35], v[132:135], v[144:147], v[32:35]
    ds_read_b64_tr_b16 v[104:105], v1 offset:26640
    v_mfma_f32_16x16x32_bf16 v[36:39], v[116:119], v[148:151], v[36:39]
    ds_read_b64_tr_b16 v[106:107], v1 offset:27920
    v_mfma_f32_16x16x32_bf16 v[40:43], v[120:123], v[148:151], v[40:43]
    ds_read_b64_tr_b16 v[108:109], v1 offset:26648
    v_mfma_f32_16x16x32_bf16 v[44:47], v[124:127], v[148:151], v[44:47]
    ds_read_b64_tr_b16 v[110:111], v1 offset:27928
    v_mfma_f32_16x16x32_bf16 v[48:51], v[128:131], v[148:151], v[48:51]
    ds_read_b64_tr_b16 v[112:113], v1 offset:26656
    v_mfma_f32_16x16x32_bf16 v[52:55], v[132:135], v[148:151], v[52:55]
    ds_read_b64_tr_b16 v[114:115], v1 offset:27936
    v_cvt_pk_bf16_f32 v16, v16, v17
    v_cvt_pk_bf16_f32 v17, v18, v19
    v_cvt_pk_bf16_f32 v18, v20, v21
    v_cvt_pk_bf16_f32 v19, v22, v23
    v_cvt_pk_bf16_f32 v20, v24, v25
    v_cvt_pk_bf16_f32 v21, v26, v27
    v_cvt_pk_bf16_f32 v22, v28, v29
    v_cvt_pk_bf16_f32 v23, v30, v31
    v_cvt_pk_bf16_f32 v24, v32, v33
    v_cvt_pk_bf16_f32 v25, v34, v35
    v_mfma_f32_16x16x32_bf16 v[202:205], v[152:155], v[16:19], 0
    ds_read_b64_tr_b16 v[116:117], v1 offset:31744
    v_mfma_f32_16x16x32_bf16 v[206:209], v[162:165], v[16:19], 0
    ds_read_b64_tr_b16 v[118:119], v1 offset:33024
    v_mfma_f32_16x16x32_bf16 v[210:213], v[172:175], v[16:19], 0
    ds_read_b64_tr_b16 v[120:121], v1 offset:31752
    ds_read_b64_tr_b16 v[122:123], v1 offset:33032
    v_mfma_f32_16x16x32_bf16 v[214:217], v[182:185], v[16:19], 0
    ds_read_b64_tr_b16 v[124:125], v1 offset:31760
    v_mfma_f32_16x16x32_bf16 v[218:221], v[192:195], v[16:19], 0
    ds_read_b64_tr_b16 v[126:127], v1 offset:33040
    v_mfma_f32_16x16x32_bf16 v[202:205], v[156:159], v[20:23], v[202:205]
    ds_read_b64_tr_b16 v[128:129], v1 offset:31768
    ds_read_b64_tr_b16 v[130:131], v1 offset:33048
    v_mfma_f32_16x16x32_bf16 v[206:209], v[166:169], v[20:23], v[206:209]
    ds_read_b64_tr_b16 v[132:133], v1 offset:31776
    v_mfma_f32_16x16x32_bf16 v[210:213], v[176:179], v[20:23], v[210:213]
    ds_read_b64_tr_b16 v[134:135], v1 offset:33056
    v_mfma_f32_16x16x32_bf16 v[214:217], v[186:189], v[20:23], v[214:217]
    v_cvt_pk_bf16_f32 v36, v36, v37
    v_cvt_pk_bf16_f32 v37, v38, v39
    v_mfma_f32_16x16x32_bf16 v[218:221], v[196:199], v[20:23], v[218:221]
    v_cvt_pk_bf16_f32 v38, v40, v41
    v_mfma_f32_16x16x16_bf16 v[202:205], v[160:161], v[24:25], v[202:205]
    v_cvt_pk_bf16_f32 v39, v42, v43
    v_mfma_f32_16x16x16_bf16 v[206:209], v[170:171], v[24:25], v[206:209]
    v_cvt_pk_bf16_f32 v40, v44, v45
    v_cvt_pk_bf16_f32 v41, v46, v47
    v_mfma_f32_16x16x16_bf16 v[210:213], v[180:181], v[24:25], v[210:213]
    v_cvt_pk_bf16_f32 v42, v48, v49
    v_mfma_f32_16x16x16_bf16 v[214:217], v[190:191], v[24:25], v[214:217]
    v_cvt_pk_bf16_f32 v43, v50, v51
    v_mfma_f32_16x16x16_bf16 v[218:221], v[200:201], v[24:25], v[218:221]
    v_cvt_pk_bf16_f32 v44, v52, v53
    v_cvt_pk_bf16_f32 v45, v54, v55
    s_waitcnt lgkmcnt(0)
    s_barrier
    v_mfma_f32_16x16x32_bf16 v[56:59], v[96:99], v[136:139], v[56:59]
    v_mfma_f32_16x16x32_bf16 v[76:79], v[96:99], v[140:143], v[76:79]
    v_mfma_f32_16x16x32_bf16 v[60:63], v[100:103], v[136:139], v[60:63]
    v_mfma_f32_16x16x32_bf16 v[80:83], v[100:103], v[140:143], v[80:83]
    v_max3_f32 v46, v202, v203, v204
    v_mfma_f32_16x16x32_bf16 v[64:67], v[104:107], v[136:139], v[64:67]
    v_max3_f32 v46, v205, v206, v46
    v_max3_f32 v46, v207, v208, v46
    v_mfma_f32_16x16x32_bf16 v[84:87], v[104:107], v[140:143], v[84:87]
    v_max3_f32 v46, v209, v210, v46
    v_mfma_f32_16x16x32_bf16 v[68:71], v[108:111], v[136:139], v[68:71]
    v_max3_f32 v46, v211, v212, v46
    v_max3_f32 v46, v213, v214, v46
    v_mfma_f32_16x16x32_bf16 v[88:91], v[108:111], v[140:143], v[88:91]
    v_max3_f32 v46, v215, v216, v46
    v_mfma_f32_16x16x32_bf16 v[72:75], v[112:115], v[136:139], v[72:75]
    v_max3_f32 v46, v217, v218, v46
    v_max3_f32 v46, v219, v220, v46
    v_mfma_f32_16x16x32_bf16 v[92:95], v[112:115], v[140:143], v[92:95]
    v_max_f32_e64 v46, v221, v46
    v_mfma_f32_16x16x32_bf16 v[56:59], v[116:119], v[144:147], v[56:59]
    v_mul_f32_e64 v46, s56, v46
    v_fma_f32 v16, v202, s56, -v46
    v_mfma_f32_16x16x32_bf16 v[60:63], v[120:123], v[144:147], v[60:63]
    v_fma_f32 v17, v203, s56, -v46
    v_mfma_f32_16x16x32_bf16 v[64:67], v[124:127], v[144:147], v[64:67]
    v_fma_f32 v18, v204, s56, -v46
    v_fma_f32 v19, v205, s56, -v46
    v_mfma_f32_16x16x32_bf16 v[68:71], v[128:131], v[144:147], v[68:71]
    v_fma_f32 v20, v206, s56, -v46
    v_fma_f32 v21, v207, s56, -v46
    v_mfma_f32_16x16x32_bf16 v[72:75], v[132:135], v[144:147], v[72:75]
    v_fma_f32 v22, v208, s56, -v46
    v_mfma_f32_16x16x32_bf16 v[76:79], v[116:119], v[148:151], v[76:79]
    v_fma_f32 v23, v209, s56, -v46
    v_fma_f32 v24, v210, s56, -v46
    v_mfma_f32_16x16x32_bf16 v[80:83], v[120:123], v[148:151], v[80:83]
    v_fma_f32 v25, v211, s56, -v46
    v_mfma_f32_16x16x32_bf16 v[84:87], v[124:127], v[148:151], v[84:87]
    v_fma_f32 v26, v212, s56, -v46
    v_fma_f32 v27, v213, s56, -v46
    v_mfma_f32_16x16x32_bf16 v[88:91], v[128:131], v[148:151], v[88:91]
    v_fma_f32 v28, v214, s56, -v46
    v_mfma_f32_16x16x32_bf16 v[92:95], v[132:135], v[148:151], v[92:95]
    v_fma_f32 v29, v215, s56, -v46
    v_fma_f32 v30, v216, s56, -v46
    v_mfma_f32_16x16x32_bf16 v[222:225], v[152:155], v[36:39], 0
    v_fma_f32 v31, v217, s56, -v46
    v_mfma_f32_16x16x32_bf16 v[226:229], v[162:165], v[36:39], 0
    v_fma_f32 v32, v218, s56, -v46
    v_fma_f32 v33, v219, s56, -v46
    v_mfma_f32_16x16x32_bf16 v[230:233], v[172:175], v[36:39], 0
    v_fma_f32 v34, v220, s56, -v46
    v_fma_f32 v35, v221, s56, -v46
    v_mfma_f32_16x16x32_bf16 v[234:237], v[182:185], v[36:39], 0
    v_cvt_pk_bf16_f32 v56, v56, v57
    v_cvt_pk_bf16_f32 v57, v58, v59
    v_mfma_f32_16x16x32_bf16 v[238:241], v[192:195], v[36:39], 0
    v_cvt_pk_bf16_f32 v58, v60, v61
    v_cvt_pk_bf16_f32 v59, v62, v63
    v_mfma_f32_16x16x32_bf16 v[222:225], v[156:159], v[40:43], v[222:225]
    v_cvt_pk_bf16_f32 v60, v64, v65
    v_cvt_pk_bf16_f32 v61, v66, v67
    v_mfma_f32_16x16x32_bf16 v[226:229], v[166:169], v[40:43], v[226:229]
    v_cvt_pk_bf16_f32 v62, v68, v69
    v_cvt_pk_bf16_f32 v63, v70, v71
    v_mfma_f32_16x16x32_bf16 v[230:233], v[176:179], v[40:43], v[230:233]
    v_cvt_pk_bf16_f32 v64, v72, v73
    v_cvt_pk_bf16_f32 v65, v74, v75
    v_mfma_f32_16x16x32_bf16 v[234:237], v[186:189], v[40:43], v[234:237]
    v_mov_b32 v66, 0x3f80
    v_mov_b32_e64 v67, 0
    v_mfma_f32_16x16x32_bf16 v[238:241], v[196:199], v[40:43], v[238:241]
    v_cvt_pk_bf16_f32 v76, v76, v77
    v_cvt_pk_bf16_f32 v77, v78, v79
    v_mfma_f32_16x16x16_bf16 v[222:225], v[160:161], v[44:45], v[222:225]
    v_cvt_pk_bf16_f32 v78, v80, v81
    v_cvt_pk_bf16_f32 v79, v82, v83
    v_mfma_f32_16x16x16_bf16 v[226:229], v[170:171], v[44:45], v[226:229]
    v_cvt_pk_bf16_f32 v80, v84, v85
    v_cvt_pk_bf16_f32 v81, v86, v87
    v_mfma_f32_16x16x16_bf16 v[230:233], v[180:181], v[44:45], v[230:233]
    v_cvt_pk_bf16_f32 v82, v88, v89
    v_cvt_pk_bf16_f32 v83, v90, v91
    v_mfma_f32_16x16x16_bf16 v[234:237], v[190:191], v[44:45], v[234:237]
    v_cvt_pk_bf16_f32 v84, v92, v93
    v_cvt_pk_bf16_f32 v85, v94, v95
    v_mfma_f32_16x16x16_bf16 v[238:241], v[200:201], v[44:45], v[238:241]
    v_mov_b32 v86, 0x3f80
    v_mov_b32 v87, 0
    v_exp_f32 v16, v16
    v_exp_f32 v17, v17
    v_exp_f32 v18, v18
    v_exp_f32 v19, v19
    v_exp_f32 v20, v20
    v_exp_f32 v21, v21
    v_add_f32 v50, v16, v18
    v_add_f32 v51, v17, v19
    v_exp_f32 v22, v22
    v_exp_f32 v23, v23
    v_add_f32 v50, v50, v20
    v_add_f32_e64 v51, v51, v21
    ds_write_b128 v248, v[56:59] offset:0
    v_exp_f32 v24, v24
    v_exp_f32 v25, v25
    v_add_f32 v50, v50, v22
    v_add_f32 v51, v51, v23
    v_exp_f32 v26, v26
    v_exp_f32 v27, v27
    v_add_f32 v50, v50, v24
    v_add_f32 v51, v51, v25
    v_exp_f32 v28, v28
    v_exp_f32 v29, v29
    v_add_f32 v50, v50, v26
    v_add_f32 v51, v51, v27
    ds_write_b128 v248, v[60:63] offset:16
    v_exp_f32 v30, v30
    v_exp_f32 v31, v31
    v_add_f32 v50, v50, v28
    v_add_f32 v51, v51, v29
    v_exp_f32 v32, v32
    v_exp_f32 v33, v33
    v_add_f32 v50, v50, v30
    v_add_f32 v51, v51, v31
    v_exp_f32 v34, v34
    v_exp_f32 v35, v35
    v_add_f32 v50, v50, v32
    v_add_f32 v51, v51, v33
    ds_write_b128 v248, v[64:67] offset:32
    v_rcp_f32 v116, v16
    v_rcp_f32 v117, v17
    v_add_f32 v50, v50, v34
    v_add_f32 v51, v51, v35
    v_add_f32 v50, v50, v51
    v_rcp_f32 v46, v50
    v_rcp_f32 v118, v18
    v_rcp_f32 v119, v19
    v_rcp_f32 v120, v20
    v_rcp_f32 v121, v21
    v_add_f32 v52, v116, v118
    v_add_f32 v53, v117, v119
    v_rcp_f32 v122, v22
    v_rcp_f32 v123, v23
    v_add_f32 v52, v52, v120
    v_add_f32 v53, v53, v121
    v_mul_f32 v16, v16, v46
    v_mul_f32 v17, v17, v46
    v_cvt_pk_bf16_f32 v96, v16, v17
    v_rcp_f32 v124, v24
    v_rcp_f32 v125, v25
    v_add_f32 v52, v52, v122
    v_add_f32 v53, v53, v123
    v_mul_f32 v18, v18, v46
    v_mul_f32 v19, v19, v46
    v_cvt_pk_bf16_f32 v97, v18, v19
    v_rcp_f32 v126, v26
    v_rcp_f32 v127, v27
    v_add_f32 v52, v52, v124
    v_add_f32 v53, v53, v125
    v_mul_f32 v20, v20, v46
    v_mul_f32 v21, v21, v46
    v_cvt_pk_bf16_f32 v98, v20, v21
    v_rcp_f32 v128, v28
    v_rcp_f32 v129, v29
    v_add_f32 v52, v52, v126
    v_add_f32 v53, v53, v127
    v_mul_f32 v22, v22, v46
    v_mul_f32 v23, v23, v46
    v_cvt_pk_bf16_f32 v99, v22, v23
    ds_write_b128 v13, v[96:99] offset:0
    v_rcp_f32 v130, v30
    v_rcp_f32 v131, v31
    v_add_f32 v52, v52, v128
    v_add_f32 v53, v53, v129
    v_mul_f32 v24, v24, v46
    v_mul_f32 v25, v25, v46
    v_cvt_pk_bf16_f32 v100, v24, v25
    v_rcp_f32 v132, v32
    v_rcp_f32 v133, v33
    v_add_f32 v52, v52, v130
    v_add_f32 v53, v53, v131
    v_mul_f32 v26, v26, v46
    v_mul_f32 v27, v27, v46
    v_cvt_pk_bf16_f32 v101, v26, v27
    v_rcp_f32 v134, v34
    v_rcp_f32 v135, v35
    v_add_f32 v52, v52, v132
    v_add_f32 v53, v53, v133
    v_mul_f32 v28, v28, v46
    v_mul_f32 v29, v29, v46
    v_cvt_pk_bf16_f32 v102, v28, v29
    v_mul_f32 v30, v30, v46
    v_add_f32 v52, v52, v134
    v_add_f32 v53, v53, v135
    v_add_f32 v52, v52, v53
    v_cmp_ngt_f32 vcc, 0x71800000, v52
    v_mul_f32_e64 v31, v31, v46
    v_cvt_pk_bf16_f32 v103, v30, v31
    ds_write_b128 v13, v[100:103] offset:16
    v_mul_f32 v32, v32, v46
    v_mul_f32 v33, v33, v46
    v_cvt_pk_bf16_f32 v104, v32, v33
    v_mul_f32 v34, v34, v46
    v_mul_f32 v35, v35, v46
    v_cvt_pk_bf16_f32 v105, v34, v35
    s_cbranch_vccnz L_k0_fix
L_k0_ok:
    v_rcp_f32 v48, v52
    s_nop 0
    v_mul_f32 v116, v116, v48
    v_mul_f32_e64 v117, v117, v48
    v_cvt_pk_bf16_f32 v106, v116, v117
    v_mul_f32 v118, v118, v48
    v_mul_f32 v119, v119, v48
    v_cvt_pk_bf16_f32 v107, v118, v119
    ds_write_b128 v13, v[104:107] offset:32
    v_mul_f32 v120, v120, v48
    v_mul_f32 v121, v121, v48
    v_cvt_pk_bf16_f32 v108, v120, v121
    v_mul_f32 v122, v122, v48
    v_mul_f32 v123, v123, v48
    v_cvt_pk_bf16_f32 v109, v122, v123
    v_mul_f32 v124, v124, v48
    v_mul_f32 v125, v125, v48
    v_cvt_pk_bf16_f32 v110, v124, v125
    v_mul_f32 v126, v126, v48
    v_mul_f32 v127, v127, v48
    v_cvt_pk_bf16_f32 v111, v126, v127
    ds_write_b128 v13, v[108:111] offset:48
L_wb_4:
    s_cbranch_execz L_wb_5
    v_mul_f32 v128, v128, v48
    v_mul_f32_e64 v129, v129, v48
    v_cvt_pk_bf16_f32 v112, v128, v129
    v_mul_f32 v130, v130, v48
    v_mul_f32 v131, v131, v48
    v_cvt_pk_bf16_f32 v113, v130, v131
    v_mul_f32 v132, v132, v48
    v_mul_f32 v133, v133, v48
    v_cvt_pk_bf16_f32 v114, v132, v133
    v_mul_f32 v134, v134, v48
    v_mul_f32 v135, v135, v48
    v_cvt_pk_bf16_f32 v115, v134, v135
    ds_write_b128 v13, v[112:115] offset:64
    global_load_dword v250, v251, s[32:33] sc1
    v_max3_f32 v46, v222, v223, v224
    v_max3_f32 v46, v225, v226, v46
    v_max3_f32 v46, v227, v228, v46
    v_max3_f32 v46, v229, v230, v46
    v_max3_f32 v46, v231, v232, v46
    v_max3_f32 v46, v233, v234, v46
    v_max3_f32 v46, v235, v236, v46
    v_max3_f32 v46, v237, v238, v46
    v_max3_f32 v46, v239, v240, v46
    v_max_f32 v46, v241, v46
    v_mul_f32 v46, s56, v46
    v_pk_fma_f32 v[16:17], v[222:223], s[56:57], v[46:47] op_sel_hi:[1,1,0] neg_lo:[0,0,1] neg_hi:[0,0,1]
    v_pk_fma_f32 v[18:19], v[224:225], s[56:57], v[46:47] op_sel_hi:[1,1,0] neg_lo:[0,0,1] neg_hi:[0,0,1]
    v_pk_fma_f32 v[20:21], v[226:227], s[56:57], v[46:47] op_sel_hi:[1,1,0] neg_lo:[0,0,1] neg_hi:[0,0,1]
    v_pk_fma_f32 v[22:23], v[228:229], s[56:57], v[46:47] op_sel_hi:[1,1,0] neg_lo:[0,0,1] neg_hi:[0,0,1]
    v_pk_fma_f32 v[24:25], v[230:231], s[56:57], v[46:47] op_sel_hi:[1,1,0] neg_lo:[0,0,1] neg_hi:[0,0,1]
    v_pk_fma_f32 v[26:27], v[232:233], s[56:57], v[46:47] op_sel_hi:[1,1,0] neg_lo:[0,0,1] neg_hi:[0,0,1]
    v_pk_fma_f32 v[28:29], v[234:235], s[56:57], v[46:47] op_sel_hi:[1,1,0] neg_lo:[0,0,1] neg_hi:[0,0,1]
    v_pk_fma_f32 v[30:31], v[236:237], s[56:57], v[46:47] op_sel_hi:[1,1,0] neg_lo:[0,0,1] neg_hi:[0,0,1]
    v_pk_fma_f32 v[32:33], v[238:239], s[56:57], v[46:47] op_sel_hi:[1,1,0] neg_lo:[0,0,1] neg_hi:[0,0,1]
    v_pk_fma_f32 v[34:35], v[240:241], s[56:57], v[46:47] op_sel_hi:[1,1,0] neg_lo:[0,0,1] neg_hi:[0,0,1]
    v_exp_f32 v16, v16
    v_exp_f32 v17, v17
    v_exp_f32 v18, v18
    v_exp_f32 v19, v19
    v_exp_f32 v20, v20
    v_exp_f32 v21, v21
    v_pk_add_f32 v[50:51], v[16:17], v[18:19]
    v_exp_f32 v22, v22
    v_exp_f32 v23, v23
    v_pk_add_f32 v[50:51], v[50:51], v[20:21]
    ds_write_b128 v248, v[76:79] offset:768
    v_exp_f32 v24, v24
    v_exp_f32 v25, v25
    v_pk_add_f32 v[50:51], v[50:51], v[22:23]
    v_exp_f32 v26, v26
    v_exp_f32 v27, v27
    v_pk_add_f32 v[50:51], v[50:51], v[24:25]
    v_exp_f32 v28, v28
    v_exp_f32 v29, v29
    v_pk_add_f32 v[50:51], v[50:51], v[26:27]
    ds_write_b128 v248, v[80:83] offset:784
    v_exp_f32 v30, v30
    v_exp_f32 v31, v31
    v_pk_add_f32 v[50:51], v[50:51], v[28:29]
    v_exp_f32 v32, v32
    v_exp_f32 v33, v33
    v_pk_add_f32 v[50:51], v[50:51], v[30:31]
    v_exp_f32 v34, v34
    v_exp_f32 v35, v35
    v_pk_add_f32 v[50:51], v[50:51], v[32:33]
    ds_write_b128 v248, v[84:87] offset:800
    v_rcp_f32 v202, v16
    v_rcp_f32 v203, v17
    v_pk_add_f32 v[50:51], v[50:51], v[34:35]
    v_add_f32 v50, v50, v51
    v_rcp_f32 v46, v50
    v_rcp_f32 v204, v18
    v_rcp_f32 v205, v19
    v_rcp_f32 v206, v20
    v_rcp_f32 v207, v21
    v_pk_add_f32 v[52:53], v[202:203], v[204:205]
    v_rcp_f32 v208, v22
    v_rcp_f32 v209, v23
    v_pk_add_f32 v[52:53], v[52:53], v[206:207]
    v_pk_mul_f32 v[16:17], v[16:17], v[46:47] op_sel_hi:[1,0]
    v_cvt_pk_bf16_f32 v116, v16, v17
    v_rcp_f32 v210, v24
    v_rcp_f32 v211, v25
    v_pk_add_f32 v[52:53], v[52:53], v[208:209]
    v_pk_mul_f32 v[18:19], v[18:19], v[46:47] op_sel_hi:[1,0]
    v_cvt_pk_bf16_f32 v117, v18, v19
    v_rcp_f32 v212, v26
    v_rcp_f32 v213, v27
    v_pk_add_f32 v[52:53], v[52:53], v[210:211]
    v_pk_mul_f32 v[20:21], v[20:21], v[46:47] op_sel_hi:[1,0]
    v_cvt_pk_bf16_f32 v118, v20, v21
    v_rcp_f32 v214, v28
    v_rcp_f32 v215, v29
    v_pk_add_f32 v[52:53], v[52:53], v[212:213]
    v_pk_mul_f32 v[22:23], v[22:23], v[46:47] op_sel_hi:[1,0]
    v_cvt_pk_bf16_f32 v119, v22, v23
    ds_write_b128 v13, v[116:119] offset:1280
    v_rcp_f32 v216, v30
    v_rcp_f32 v217, v31
    v_pk_add_f32 v[52:53], v[52:53], v[214:215]
    v_pk_mul_f32 v[24:25], v[24:25], v[46:47] op_sel_hi:[1,0]
    v_cvt_pk_bf16_f32 v120, v24, v25
    v_rcp_f32 v218, v32
    v_rcp_f32 v219, v33
    v_pk_add_f32 v[52:53], v[52:53], v[216:217]
    v_pk_mul_f32 v[26:27], v[26:27], v[46:47] op_sel_hi:[1,0]
    v_cvt_pk_bf16_f32 v121, v26, v27
    v_rcp_f32 v220, v34
    v_rcp_f32 v221, v35
    v_pk_add_f32 v[52:53], v[52:53], v[218:219]
    v_pk_mul_f32 v[28:29], v[28:29], v[46:47] op_sel_hi:[1,0]
    v_cvt_pk_bf16_f32 v122, v28, v29
    v_pk_mul_f32 v[30:31], v[30:31], v[46:47] op_sel_hi:[1,0]
    v_pk_add_f32 v[52:53], v[52:53], v[220:221]
    v_add_f32_e64 v52, v52, v53
    v_cmp_ngt_f32 vcc, 0x71800000, v52
    v_cvt_pk_bf16_f32 v123, v30, v31
    ds_write_b128 v13, v[120:123] offset:1296
    v_pk_mul_f32 v[32:33], v[32:33], v[46:47] op_sel_hi:[1,0]
    v_cvt_pk_bf16_f32 v124, v32, v33
    v_pk_mul_f32 v[34:35], v[34:35], v[46:47] op_sel_hi:[1,0]
    v_cvt_pk_bf16_f32 v125, v34, v35
    s_cbranch_vccnz L_k1_fix
L_k1_ok:
    v_rcp_f32_e64 v48, v52
    s_nop 0
    v_pk_mul_f32 v[202:203], v[202:203], v[48:49] op_sel_hi:[1,0]
    v_cvt_pk_bf16_f32 v126, v202, v203
    v_pk_mul_f32 v[204:205], v[204:205], v[48:49] op_sel_hi:[1,0]
    v_cvt_pk_bf16_f32 v127, v204, v205
    ds_write_b128 v13, v[124:127] offset:1312
    v_pk_mul_f32 v[206:207], v[206:207], v[48:49] op_sel_hi:[1,0]
    v_cvt_pk_bf16_f32 v128, v206, v207
    v_pk_mul_f32 v[208:209], v[208:209], v[48:49] op_sel_hi:[1,0]
    v_cvt_pk_bf16_f32 v129, v208, v209
    v_pk_mul_f32 v[210:211], v[210:211], v[48:49] op_sel_hi:[1,0]
    v_cvt_pk_bf16_f32 v130, v210, v211
    v_pk_mul_f32 v[212:213], v[212:213], v[48:49] op_sel_hi:[1,0]
    v_cvt_pk_bf16_f32 v131, v212, v213
    ds_write_b128 v13, v[128:131] offset:1328
    v_pk_mul_f32 v[214:215], v[214:215], v[48:49] op_sel_hi:[1,0]
    v_cvt_pk_bf16_f32 v132, v214, v215
    v_pk_mul_f32 v[216:217], v[216:217], v[48:49] op_sel_hi:[1,0]
    v_cvt_pk_bf16_f32 v133, v216, v217
    v_pk_mul_f32 v[218:219], v[218:219], v[48:49] op_sel_hi:[1,0]
    v_cvt_pk_bf16_f32 v134, v218, v219
    v_pk_mul_f32 v[220:221], v[220:221], v[48:49] op_sel_hi:[1,0]
    v_cvt_pk_bf16_f32 v135, v220, v221
    ds_write_b128 v13, v[132:135] offset:1344
    s_mul_i32 s58, s36, 4352
    s_add_u32 s58, s58, s63
    s_waitcnt lgkmcnt(0)
    s_barrier
    s_nop 0
    ds_read_b64_tr_b16 v[108:109], v15 offset:0
    ds_read_b64_tr_b16 v[110:111], v15 offset:48
    ds_read_b64_tr_b16 v[104:105], v14 offset:64
    ds_read_b64_tr_b16 v[106:107], v14 offset:144
    ds_read_b64_tr_b16 v[112:113], v15 offset:32
    ds_read_b64_tr_b16 v[114:115], v15 offset:80
    ds_read_b64_tr_b16 v[128:129], v15 offset:1536
    ds_read_b64_tr_b16 v[130:131], v15 offset:1584
    ds_read_b64_tr_b16 v[124:125], v14 offset:2624
    ds_read_b64_tr_b16 v[126:127], v14 offset:2704
    ds_read_b64_tr_b16 v[132:133], v15 offset:1568
    ds_read_b64_tr_b16 v[134:135], v15 offset:1616
    ds_read_b64_tr_b16 v[148:149], v15 offset:3072
    ds_read_b64_tr_b16 v[150:151], v15 offset:3120
    ds_read_b64_tr_b16 v[144:145], v14 offset:5184
    ds_read_b64_tr_b16 v[146:147], v14 offset:5264
    ds_read_b64_tr_b16 v[152:153], v15 offset:3104
    ds_read_b64_tr_b16 v[154:155], v15 offset:3152
    ds_read_b64_tr_b16 v[168:169], v15 offset:4608
    ds_read_b64_tr_b16 v[170:171], v15 offset:4656
    ds_read_b64_tr_b16 v[164:165], v14 offset:7744
    ds_read_b64_tr_b16 v[166:167], v14 offset:7824
    ds_read_b64_tr_b16 v[172:173], v15 offset:4640
    ds_read_b64_tr_b16 v[174:175], v15 offset:4688
    s_waitcnt lgkmcnt(15)
    v_mfma_f32_16x16x32_bf16 v[32:35], v[108:111], v[104:107], 0
    ds_read_b64_tr_b16 v[96:97], v14 offset:0
    ds_read_b64_tr_b16 v[98:99], v14 offset:80
    v_mfma_f32_16x16x32_bf16 v[36:39], v[112:115], v[104:107], 0
    ds_read_b64_tr_b16 v[100:101], v14 offset:32
    ds_read_b64_tr_b16 v[102:103], v14 offset:112
    s_waitcnt lgkmcnt(15)
    v_mfma_f32_16x16x32_bf16 v[32:35], v[128:131], v[124:127], v[32:35]
    ds_read_b64_tr_b16 v[116:117], v14 offset:2560
    ds_read_b64_tr_b16 v[118:119], v14 offset:2640
    v_mfma_f32_16x16x32_bf16 v[36:39], v[132:135], v[124:127], v[36:39]
    ds_read_b64_tr_b16 v[120:121], v14 offset:2592
    ds_read_b64_tr_b16 v[122:123], v14 offset:2672
    s_waitcnt lgkmcnt(15)
    v_mfma_f32_16x16x32_bf16 v[32:35], v[148:151], v[144:147], v[32:35]
    ds_read_b64_tr_b16 v[136:137], v14 offset:5120
    ds_read_b64_tr_b16 v[138:139], v14 offset:5200
    s_waitcnt lgkmcnt(15)
    v_mfma_f32_16x16x32_bf16 v[36:39], v[152:155], v[144:147], v[36:39]
    ds_read_b64_tr_b16 v[140:141], v14 offset:5152
    ds_read_b64_tr_b16 v[142:143], v14 offset:5232
    s_waitcnt lgkmcnt(14)
    v_mfma_f32_16x16x32_bf16 v[32:35], v[168:171], v[164:167], v[32:35]
    ds_read_b64_tr_b16 v[156:157], v14 offset:7680
    ds_read_b64_tr_b16 v[158:159], v14 offset:7760
    s_waitcnt lgkmcnt(14)
    v_mfma_f32_16x16x32_bf16 v[36:39], v[172:175], v[164:167], v[36:39]
    ds_read_b64_tr_b16 v[160:161], v14 offset:7712
    ds_read_b64_tr_b16 v[162:163], v14 offset:7792
    s_waitcnt vmcnt(0)
    v_cmp_gt_u32_e64 vcc, 48, v250
    s_waitcnt lgkmcnt(14)
    v_mfma_f32_16x16x32_bf16 v[24:27], v[112:115], v[96:99], 0
    s_waitcnt lgkmcnt(12)
    v_mfma_f32_16x16x32_bf16 v[28:31], v[112:115], v[100:103], 0
    s_waitcnt lgkmcnt(10)
    v_mfma_f32_16x16x32_bf16 v[24:27], v[132:135], v[116:119], v[24:27]
    s_waitcnt lgkmcnt(8)
    v_mfma_f32_16x16x32_bf16 v[28:31], v[132:135], v[120:123], v[28:31]
    s_waitcnt lgkmcnt(6)
    v_mfma_f32_16x16x32_bf16 v[24:27], v[152:155], v[136:139], v[24:27]
    s_waitcnt lgkmcnt(4)
    v_mfma_f32_16x16x32_bf16 v[28:31], v[152:155], v[140:143], v[28:31]
    v_mov_b32_dpp v32, v36 row_shr:8 row_mask:0xf bank_mask:0xc
    v_mov_b32_dpp v33, v37 row_shr:8 row_mask:0xf bank_mask:0xc
    s_waitcnt lgkmcnt(2)
    v_mfma_f32_16x16x32_bf16 v[24:27], v[172:175], v[156:159], v[24:27]
    v_mov_b32_dpp v34, v38 row_shr:8 row_mask:0xf bank_mask:0xc
    v_mov_b32_dpp v35, v39 row_shr:8 row_mask:0xf bank_mask:0xc
    s_waitcnt lgkmcnt(0)
    v_mfma_f32_16x16x32_bf16 v[28:31], v[172:175], v[160:163], v[28:31]
    s_cbranch_vccz L_flag_x
    s_mov_b32 s55, 65536
L_flag:
    global_load_dword v250, v251, s[32:33] sc1
    s_sub_u32 s55, s55, 1
    s_waitcnt vmcnt(0)
    s_cbranch_scc1 L_flag_x
    v_cmp_gt_u32 vcc, 48, v250
    s_nop 4
    s_cbranch_vccnz L_flag
L_flag_x:
    buffer_store_dwordx4 v[32:35], v12, s[48:51], s58 offen offset:3072 sc1
    v_mfma_f32_16x16x32_bf16 v[16:19], v[108:111], v[96:99], 0
    v_mfma_f32_16x16x32_bf16 v[16:19], v[128:131], v[116:119], v[16:19]
    v_mfma_f32_16x16x32_bf16 v[16:19], v[148:151], v[136:139], v[16:19]
    v_mfma_f32_16x16x32_bf16 v[16:19], v[168:171], v[156:159], v[16:19]
    v_mfma_f32_16x16x32_bf16 v[20:23], v[108:111], v[100:103], 0
    v_mfma_f32_16x16x32_bf16 v[20:23], v[128:131], v[120:123], v[20:23]
    v_permlane32_swap_b32 v24, v28
    v_mfma_f32_16x16x32_bf16 v[20:23], v[148:151], v[140:143], v[20:23]
    v_permlane32_swap_b32 v25, v29
    v_permlane32_swap_b32 v26, v30
    v_mfma_f32_16x16x32_bf16 v[20:23], v[168:171], v[160:163], v[20:23]
    v_permlane32_swap_b32 v27, v31
    buffer_store_dwordx4 v[24:27], v12, s[48:51], s58 offen offset:2048 sc1
    buffer_store_dwordx4 v[16:19], v12, s[48:51], s58 offen offset:0 sc1
    s_nop 4
    s_nop 0
    buffer_store_dwordx4 v[20:23], v12, s[48:51], s58 offen offset:1024 sc1
    s_mul_i32 s59, s38, 10240
    s_add_u32 m0, s59, 92160
    s_mul_i32 s39, s38, 81920
    s_add_u32 s39, s39, s52
    s_nop 0
    s_add_u32 s39, s39, 491520
    buffer_load_dwordx4 v4, s[40:43], s39 offen offset:0 lds
    buffer_load_dwordx4 v5, s[40:43], s39 offen offset:1024 lds
    buffer_load_dwordx4 v6, s[40:43], s39 offen offset:2048 lds
    buffer_load_dwordx4 v7, s[40:43], s39 offen offset:3072 lds
    s_add_u32 m0, m0, 4096
    s_nop 0
    s_nop 0
    buffer_load_dwordx4 v8, s[40:43], s39 offen offset:0 lds
    s_mul_i32 s59, s38, 10240
    s_add_u32 m0, s59, 97280
    s_mul_i32 s39, s38, 81920
    s_add_u32 s39, s39, s52
    s_nop 0
    s_add_u32 s39, s39, 532480
    buffer_load_dwordx4 v4, s[40:43], s39 offen offset:0 lds
    buffer_load_dwordx4 v5, s[40:43], s39 offen offset:1024 lds
    buffer_load_dwordx4 v6, s[40:43], s39 offen offset:2048 lds
    buffer_load_dwordx4 v7, s[40:43], s39 offen offset:3072 lds
    s_add_u32 m0, m0, 4096
    s_nop 0
    buffer_load_dwordx4 v8, s[40:43], s39 offen offset:0 lds
    s_waitcnt vmcnt(10)
    s_add_u32 s58, s63, 0
    s_nop 0
    buffer_load_dwordx4 v[144:147], v11, s[48:51], s58 offen sc1
    s_add_u32 s58, s63, 17408
    buffer_load_dwordx4 v[148:151], v11, s[48:51], s58 offen sc1
    s_add_u32 s58, s63, 34816
    buffer_load_dwordx4 v[152:155], v11, s[48:51], s58 offen sc1
    s_add_u32 s58, s63, 52224
    buffer_load_dwordx4 v[156:159], v11, s[48:51], s58 offen sc1
    global_load_dword v250, v251, s[32:33] offset:128 sc1
    s_waitcnt vmcnt(4)
    v_max3_u32 v104, v144, v145, v146
    s_waitcnt vmcnt(3)
    v_max3_u32 v104, v147, v148, v104
    v_max3_u32 v104, v149, v150, v104
    s_waitcnt vmcnt(2)
    v_max3_u32 v104, v151, v152, v104
    v_max3_u32 v104, v153, v154, v104
    s_waitcnt vmcnt(1)
    v_max3_u32 v104, v155, v156, v104
    v_max3_u32 v104, v157, v158, v104
    v_max_u32 v104, v159, v104
    v_cmp_eq_u32 vcc, -1, v104
    s_nop 4
    s_cbranch_vccz L_hop_a_x
    s_mov_b32 s55, 65536
L_hop_a:
    s_add_u32 s58, s63, 0
    s_nop 0
    buffer_load_dwordx4 v[144:147], v11, s[48:51], s58 offen sc1
    s_add_u32 s58, s63, 17408
    buffer_load_dwordx4 v[148:151], v11, s[48:51], s58 offen sc1
    s_add_u32 s58, s63, 34816
    buffer_load_dwordx4 v[152:155], v11, s[48:51], s58 offen sc1
    s_add_u32 s58, s63, 52224
    buffer_load_dwordx4 v[156:159], v11, s[48:51], s58 offen sc1
    s_sub_u32 s55, s55, 1
    s_waitcnt vmcnt(0)
    s_cbranch_scc1 L_hop_a_x
    s_nop 0
    v_max3_u32 v104, v144, v145, v146
    v_max3_u32 v104, v147, v148, v104
    v_max3_u32 v104, v149, v150, v104
    v_max3_u32 v104, v151, v152, v104
    v_max3_u32 v104, v153, v154, v104
    v_max3_u32 v104, v155, v156, v104
    v_max3_u32 v104, v157, v158, v104
    v_max_u32 v104, v159, v104
    v_cmp_eq_u32 vcc, -1, v104
    s_nop 4
    s_cbranch_vccnz L_hop_a
L_hop_a_x:
    v_add_f32 v144, v144, v152
    v_add_f32 v145, v145, v153
    v_add_f32 v146, v146, v154
    v_add_f32 v147, v147, v155
    v_add_f32 v148, v148, v156
    v_add_f32 v149, v149, v157
    v_add_f32 v150, v150, v158
    v_add_f32 v151, v151, v159
    v_add_f32 v144, v144, v148
    v_add_f32 v145, v145, v149
    v_add_f32 v146, v146, v150
    v_add_f32 v147, v147, v151
    v_permlane32_swap_b32 v144, v145
    s_nop 0
    v_permlane32_swap_b32 v146, v147
    v_add_f32 v144, v144, v145
    v_add_f32 v146, v146, v147
    s_nop 1
    v_permlane16_swap_b32 v144, v146
    v_add_f32 v144, v144, v146
    buffer_store_dword v144, v10, s[48:51], s68 offen sc1
    s_waitcnt vmcnt(1)
    v_cmp_gt_u32 vcc, 48, v250
    s_nop 4
    s_cbranch_vccz L_flag2_x
    s_mov_b32 s55, 65536
L_flag2:
    global_load_dword v250, v251, s[32:33] offset:128 sc1
    s_sub_u32 s55, s55, 1
    s_waitcnt vmcnt(0)
    s_cbranch_scc1 L_flag2_x
    v_cmp_gt_u32 vcc, 48, v250
    s_nop 4
    s_cbranch_vccnz L_flag2
L_flag2_x:
    v_mov_b32 v104, 161664
L_qdone:
    ds_read_b128 v[106:109], v104
    s_waitcnt lgkmcnt(0)
    v_min3_u32 v106, v106, v107, v108
    v_min_u32 v106, v106, v109
    v_cmp_eq_u32_e64 vcc, 0, v106
    s_nop 4
    s_cbranch_vccnz L_qdone
    s_mul_i32 s59, s38, 5120
    s_add_u32 m0, s59, 71680
    s_mul_i32 s39, s38, 40960
    s_add_u32 s39, s39, s52
    s_nop 0
    s_add_u32 s39, s39, 327680
    buffer_load_dwordx4 v4, s[40:43], s39 offen offset:0 lds
    buffer_load_dwordx4 v5, s[40:43], s39 offen offset:1024 lds
    buffer_load_dwordx4 v6, s[40:43], s39 offen offset:2048 lds
    buffer_load_dwordx4 v7, s[40:43], s39 offen offset:3072 lds
    s_add_u32 m0, m0, 4096
    s_nop 0
    s_nop 0
    buffer_load_dwordx4 v8, s[40:43], s39 offen offset:0 lds
    s_mul_i32 s59, s38, 5120
    s_add_u32 m0, s59, 51200
    s_mul_i32 s39, s38, 40960
    s_add_u32 s39, s39, s52
    s_nop 0
    s_add_u32 s39, s39, 163840
    buffer_load_dwordx4 v4, s[40:43], s39 offen offset:0 lds
    buffer_load_dwordx4 v5, s[40:43], s39 offen offset:1024 lds
    buffer_load_dwordx4 v6, s[40:43], s39 offen offset:2048 lds
    buffer_load_dwordx4 v7, s[40:43], s39 offen offset:3072 lds
    s_add_u32 m0, m0, 4096
    s_nop 0
    buffer_load_dwordx4 v8, s[40:43], s39 offen offset:0 lds
    s_waitcnt vmcnt(10)
    buffer_load_dwordx4 v[160:163], v12, s[48:51], s68 offen offset:0 sc1
    buffer_load_dwordx4 v[164:167], v12, s[48:51], s68 offen offset:1024 sc1
    buffer_load_dwordx4 v[168:171], v12, s[48:51], s68 offen offset:2048 sc1
    buffer_load_dwordx4 v[172:175], v12, s[48:51], s68 offen offset:3072 sc1
    s_waitcnt vmcnt(3)
    v_max3_u32 v104, v160, v161, v162
    s_waitcnt vmcnt(2)
    v_max3_u32 v104, v163, v164, v104
    v_max3_u32 v104, v165, v166, v104
    s_waitcnt vmcnt(1)
    v_max3_u32 v104, v167, v168, v104
    v_max3_u32 v104, v169, v170, v104
    s_waitcnt vmcnt(0)
    v_max3_u32 v104, v171, v172, v104
    v_max3_u32 v104, v173, v174, v104
    v_max_u32 v104, v175, v104
    v_cmp_eq_u32 vcc, -1, v104
    s_nop 4
    s_cbranch_vccz L_hop_b_x
    s_mov_b32 s55, 65536
L_hop_b:
    buffer_load_dwordx4 v[160:163], v12, s[48:51], s68 offen offset:0 sc1
    buffer_load_dwordx4 v[164:167], v12, s[48:51], s68 offen offset:1024 sc1
    buffer_load_dwordx4 v[168:171], v12, s[48:51], s68 offen offset:2048 sc1
    buffer_load_dwordx4 v[172:175], v12, s[48:51], s68 offen offset:3072 sc1
    s_sub_u32 s55, s55, 1
    s_waitcnt vmcnt(0)
    s_cbranch_scc1 L_hop_b_x
    s_nop 0
    v_max3_u32 v104, v160, v161, v162
    v_max3_u32 v104, v163, v164, v104
    v_max3_u32 v104, v165, v166, v104
    v_max3_u32 v104, v167, v168, v104
    v_max3_u32 v104, v169, v170, v104
    v_max3_u32 v104, v171, v172, v104
    v_max3_u32 v104, v173, v174, v104
    v_max_u32 v104, v175, v104
    v_cmp_eq_u32 vcc, -1, v104
    s_nop 4
    s_cbranch_vccnz L_hop_b
L_hop_b_x:
    v_cvt_pk_bf16_f32 v160, v160, v161
    v_cvt_pk_bf16_f32 v161, v162, v163
    ds_write_b64 v244, v[160:161] offset:0
    v_cvt_pk_bf16_f32 v164, v164, v165
    v_cvt_pk_bf16_f32 v165, v166, v167
    ds_write_b64 v244, v[164:165] offset:32
    v_add_f32 v168, v168, v252
    v_add_f32 v169, v169, v252
    v_add_f32 v170, v170, v252
    v_add_f32 v171, v171, v252
    v_cvt_pk_bf16_f32 v168, v168, v169
    v_cvt_pk_bf16_f32 v169, v170, v171
    ds_write_b64 v245, v[168:169] offset:1280
    v_cvt_pk_bf16_f32 v172, v172, v173
    v_cvt_pk_bf16_f32 v173, v174, v175
    ds_write_b64 v246, v[172:173] offset:64
    s_waitcnt lgkmcnt(0)
    s_barrier
    s_setprio 0
    s_mul_i32 s59, s38, 5120
    s_add_u32 m0, s59, 30720
    s_mul_i32 s39, s38, 40960
    s_add_u32 s39, s39, s52
    s_add_u32 s39, s39, 0
    s_nop 0
    buffer_load_dwordx4 v4, s[40:43], s39 offen offset:0 lds
    buffer_load_dwordx4 v5, s[40:43], s39 offen offset:1024 lds
    buffer_load_dwordx4 v6, s[40:43], s39 offen offset:2048 lds
    buffer_load_dwordx4 v7, s[40:43], s39 offen offset:3072 lds
    s_add_u32 m0, m0, 4096
    s_nop 0
    buffer_load_dwordx4 v8, s[40:43], s39 offen offset:0 lds
    v_mul_u32_u24 v190, 40, v0
    v_bfe_u32 v3, v0, 2, 2
    v_mul_u32_u24 v12, 3040, v3
    v_lshrrev_b32_e64 v3, 4, v0
    v_mul_u32_u24 v3, 480, v3
    v_sub_u32_e64 v3, v12, v3
    v_add_u32 v3, 2560, v3
    s_xor_b32 s58, s37, 4
    s_mul_i32 s39, s58, 12800
    s_add_u32 s39, s39, 30720
    v_add_u32 v4, s39, v190
    v_add_u32_e64 v5, v4, v3
    s_mul_i32 s58, s58, 2560
    s_add_u32 s54, s58, s69
    s_xor_b32 s58, s37, 5
    s_mul_i32 s39, s58, 12800
    s_add_u32 s39, s39, 30720
    v_add_u32 v6, s39, v190
    v_add_u32 v7, v6, v3
    s_mul_i32 s58, s58, 2560
    s_add_u32 s61, s58, s69
    s_xor_b32 s58, s37, 6
    s_mul_i32 s39, s58, 12800
    s_add_u32 s39, s39, 30720
    v_add_u32 v8, s39, v190
    v_add_u32 v9, v8, v3
    s_mul_i32 s58, s58, 2560
    s_add_u32 s63, s58, s69
    s_xor_b32 s58, s37, 7
    s_mul_i32 s39, s58, 12800
    s_add_u32 s39, s39, 30720
    v_add_u32 v10, s39, v190
    v_add_u32 v11, v10, v3
    s_mul_i32 s58, s58, 2560
    s_add_u32 s68, s58, s69
    v_lshlrev_b32 v12, 4, v0
    v_lshlrev_b32 v13, 3, v0
    s_mov_b32 s52, 0
    s_mov_b32 s53, 20480
    s_waitcnt vmcnt(0)
    s_barrier
    ds_read_b64_tr_b16 v[56:57], v4 offset:0
    ds_read_b64_tr_b16 v[58:59], v4 offset:3200
    ds_read_b64_tr_b16 v[60:61], v4 offset:8
    ds_read_b64_tr_b16 v[62:63], v4 offset:3208
    ds_read_b64_tr_b16 v[64:65], v4 offset:16
    ds_read_b64_tr_b16 v[66:67], v4 offset:3216
    ds_read_b64_tr_b16 v[68:69], v4 offset:24
    ds_read_b64_tr_b16 v[70:71], v4 offset:3224
    ds_read_b64_tr_b16 v[72:73], v4 offset:32
    ds_read_b64_tr_b16 v[74:75], v4 offset:3232
    s_barrier
    s_add_u32 s39, s54, s52
    buffer_load_dwordx4 v[96:99], v12, s[48:51], s39 offen sc1
    buffer_load_dwordx4 v[100:103], v12, s[48:51], s39 offen offset:1024 sc1
    buffer_load_dwordx2 v[104:105], v13, s[48:51], s39 offen offset:2048 sc1
    s_add_u32 s39, s54, s53
    buffer_load_dwordx4 v[136:139], v12, s[48:51], s39 offen sc1
    buffer_load_dwordx4 v[140:143], v12, s[48:51], s39 offen offset:1024 sc1
    buffer_load_dwordx2 v[144:145], v13, s[48:51], s39 offen offset:2048 sc1
    s_add_u32 s39, s61, s52
    buffer_load_dwordx4 v[106:109], v12, s[48:51], s39 offen sc1
    buffer_load_dwordx4 v[110:113], v12, s[48:51], s39 offen offset:1024 sc1
    buffer_load_dwordx2 v[114:115], v13, s[48:51], s39 offen offset:2048 sc1
    s_add_u32 s39, s61, s53
    s_nop 0
    buffer_load_dwordx4 v[146:149], v12, s[48:51], s39 offen sc1
    buffer_load_dwordx4 v[150:153], v12, s[48:51], s39 offen offset:1024 sc1
    buffer_load_dwordx2 v[154:155], v13, s[48:51], s39 offen offset:2048 sc1
    v_mul_u32_u24 v190, 205, v0
    v_lshlrev_b32 v191, 4, v0
    s_movk_i32 s39, 2400
    s_movk_i32 s58, 10240
    v_lshrrev_b32 v180, 11, v190
    v_mad_u32_u24 v180, v180, s39, v191
    v_add_u32 v190, 13120, v190
    v_add_u32 v191, 1024, v191
    v_lshrrev_b32_e64 v181, 11, v190
    v_mad_u32_u24 v181, v181, s39, v191
    v_add_u32 v190, 13120, v190
    v_add_u32 v191, 1024, v191
    v_lshrrev_b32_e64 v182, 11, v190
    v_mad_u32_u24 v182, v182, s39, v191
    v_cmp_gt_u32 vcc, 32, v0
    v_mov_b32 v190, 1073741824
    v_mul_u32_u24 v192, 205, v0
    v_lshlrev_b32 v193, 4, v0
    s_movk_i32 s39, 16
    s_movk_i32 s58, 704
    v_lshrrev_b32 v184, 11, v192
    v_mad_u32_u24 v184, v184, s39, v193
    v_add_u32 v192, 13120, v192
    v_add_u32 v193, 1024, v193
    v_lshrrev_b32_e64 v185, 11, v192
    v_mad_u32_u24 v185, v185, s39, v193
    v_add_u32 v192, 13120, v192
    v_add_u32 v193, 1024, v193
    v_lshrrev_b32_e64 v186, 11, v192
    v_mad_u32_u24 v186, v186, s39, v193
    v_cndmask_b32_e64 v182, v190, v182, vcc
    s_mul_i32 s58, s38, 5120
    v_add_u32_e64 v191, s58, v12
    v_add_u32 v177, 133120, v191
    v_add_u32_e64 v178, 0, v191
    s_mul_i32 s58, s3, 2816
    s_add_u32 s58, s58, 30720
    v_add_u32 v184, s58, v184
    v_add_u32 v185, s58, v185
    v_add_u32 v186, s58, v186
    v_and_b32 v190, 15, v0
    v_mul_u32_u24 v190, 176, v190
    v_lshrrev_b32 v191, 4, v0
    v_mul_u32_u24 v191, 40, v191
    v_add3_u32 v176, v190, v191, s58
    s_mov_b32 s44, s30
    s_mov_b32 s45, s31
    s_mov_b32 s46, 5242880
    s_mov_b32 s47, 0x20000
    s_lshl_b32 s60, s60, 1
    s_mul_i32 s58, s37, 160
    s_add_u32 s60, s60, s58
    s_add_u32 s60, s60, 1280
    s_waitcnt vmcnt(11)
    v_max3_u32 v3, v96, v97, v98
    s_waitcnt vmcnt(10)
    v_max3_u32 v3, v99, v100, v3
    v_max3_u32 v3, v101, v102, v3
    s_waitcnt vmcnt(9)
    v_max3_u32 v3, v103, v104, v3
    s_waitcnt vmcnt(8)
    v_max3_u32 v3, v105, v136, v3
    v_max3_u32 v3, v137, v138, v3
    s_waitcnt vmcnt(7)
    v_max3_u32 v3, v139, v140, v3
    v_max3_u32 v3, v141, v142, v3
    s_waitcnt vmcnt(6)
    v_max3_u32 v3, v143, v144, v3
    v_max_u32 v3, v145, v3
    v_cmp_eq_u32_e64 vcc, -1, v3
    s_nop 4
    s_cbranch_vccnz L_redo0
L_ok0:
    s_waitcnt lgkmcnt(4)
    v_mfma_f32_16x16x32_bf16 v[16:19], v[56:59], v[96:99], 0
    ds_read_b64_tr_b16 v[76:77], v4 offset:6400
    v_mfma_f32_16x16x32_bf16 v[36:39], v[56:59], v[136:139], 0
    ds_read_b64_tr_b16 v[78:79], v4 offset:9600
    v_mfma_f32_16x16x32_bf16 v[20:23], v[60:63], v[96:99], 0
    ds_read_b64_tr_b16 v[80:81], v4 offset:6408
    v_mfma_f32_16x16x32_bf16 v[40:43], v[60:63], v[136:139], 0
    ds_read_b64_tr_b16 v[82:83], v4 offset:9608
    v_mfma_f32_16x16x32_bf16 v[24:27], v[64:67], v[96:99], 0
    ds_read_b64_tr_b16 v[84:85], v4 offset:6416
    v_mfma_f32_16x16x32_bf16 v[44:47], v[64:67], v[136:139], 0
    ds_read_b64_tr_b16 v[86:87], v4 offset:9616
    s_waitcnt lgkmcnt(6)
    v_mfma_f32_16x16x32_bf16 v[28:31], v[68:71], v[96:99], 0
    ds_read_b64_tr_b16 v[88:89], v4 offset:6424
    v_mfma_f32_16x16x32_bf16 v[48:51], v[68:71], v[136:139], 0
L_wb_5:
    s_cbranch_execz L_wb_6
    ds_read_b64_tr_b16 v[90:91], v4 offset:9624
    v_mfma_f32_16x16x32_bf16 v[32:35], v[72:75], v[96:99], 0
    ds_read_b64_tr_b16 v[92:93], v4 offset:6432
    v_mfma_f32_16x16x32_bf16 v[52:55], v[72:75], v[136:139], 0
    ds_read_b64_tr_b16 v[94:95], v4 offset:9632
    s_waitcnt lgkmcnt(4)
    v_mfma_f32_16x16x32_bf16 v[16:19], v[76:79], v[100:103], v[16:19]
    ds_read_b64_tr_b16 v[56:57], v5 offset:0
    v_mfma_f32_16x16x32_bf16 v[36:39], v[76:79], v[140:143], v[36:39]
    ds_read_b64_tr_b16 v[58:59], v6 offset:0
    v_mfma_f32_16x16x32_bf16 v[20:23], v[80:83], v[100:103], v[20:23]
    ds_read_b64_tr_b16 v[60:61], v5 offset:8
    v_mfma_f32_16x16x32_bf16 v[40:43], v[80:83], v[140:143], v[40:43]
    ds_read_b64_tr_b16 v[62:63], v6 offset:8
    v_mfma_f32_16x16x32_bf16 v[24:27], v[84:87], v[100:103], v[24:27]
    ds_read_b64_tr_b16 v[64:65], v5 offset:16
    v_mfma_f32_16x16x32_bf16 v[44:47], v[84:87], v[140:143], v[44:47]
    ds_read_b64_tr_b16 v[66:67], v6 offset:16
    s_waitcnt lgkmcnt(6)
    v_mfma_f32_16x16x32_bf16 v[28:31], v[88:91], v[100:103], v[28:31]
    ds_read_b64_tr_b16 v[68:69], v5 offset:24
    v_mfma_f32_16x16x32_bf16 v[48:51], v[88:91], v[140:143], v[48:51]
    ds_read_b64_tr_b16 v[70:71], v6 offset:24
    v_mfma_f32_16x16x32_bf16 v[32:35], v[92:95], v[100:103], v[32:35]
    ds_read_b64_tr_b16 v[72:73], v5 offset:32
    v_mfma_f32_16x16x32_bf16 v[52:55], v[92:95], v[140:143], v[52:55]
    ds_read_b64_tr_b16 v[74:75], v6 offset:32
L_P3:
    s_waitcnt vmcnt(5)
    v_max3_u32 v3, v106, v107, v108
    s_waitcnt vmcnt(4)
    v_max3_u32 v3, v109, v110, v3
    v_max3_u32 v3, v111, v112, v3
    s_waitcnt vmcnt(3)
    v_max3_u32 v3, v113, v114, v3
    s_waitcnt vmcnt(2)
    v_max3_u32 v3, v115, v146, v3
    v_max3_u32 v3, v147, v148, v3
    s_waitcnt vmcnt(1)
    v_max3_u32 v3, v149, v150, v3
    v_max3_u32 v3, v151, v152, v3
    s_waitcnt vmcnt(0)
    v_max3_u32 v3, v153, v154, v3
    v_max_u32 v3, v155, v3
    v_cmp_eq_u32_e64 vcc, -1, v3
    s_nop 4
    s_cbranch_vccnz L_redo1
L_ok1:
    s_waitcnt lgkmcnt(4)
    v_mfma_f32_16x16x32_bf16 v[16:19], v[56:59], v[104:107], v[16:19]
    s_add_u32 s39, s63, s52
    v_mfma_f32_16x16x32_bf16 v[36:39], v[56:59], v[144:147], v[36:39]
    buffer_load_dwordx4 v[116:119], v12, s[48:51], s39 offen sc1
    buffer_load_dwordx4 v[120:123], v12, s[48:51], s39 offen offset:1024 sc1
    v_mfma_f32_16x16x32_bf16 v[20:23], v[60:63], v[104:107], v[20:23]
    buffer_load_dwordx2 v[124:125], v13, s[48:51], s39 offen offset:2048 sc1
    s_add_u32 s39, s63, s53
    v_mfma_f32_16x16x32_bf16 v[40:43], v[60:63], v[144:147], v[40:43]
    buffer_load_dwordx4 v[156:159], v12, s[48:51], s39 offen sc1
    buffer_load_dwordx4 v[160:163], v12, s[48:51], s39 offen offset:1024 sc1
    v_mfma_f32_16x16x32_bf16 v[24:27], v[64:67], v[104:107], v[24:27]
    buffer_load_dwordx2 v[164:165], v13, s[48:51], s39 offen offset:2048 sc1
    ds_read_b64_tr_b16 v[76:77], v6 offset:3200
    v_mfma_f32_16x16x32_bf16 v[44:47], v[64:67], v[144:147], v[44:47]
    ds_read_b64_tr_b16 v[78:79], v6 offset:6400
    s_waitcnt lgkmcnt(2)
    v_mfma_f32_16x16x32_bf16 v[28:31], v[68:71], v[104:107], v[28:31]
    ds_read_b64_tr_b16 v[80:81], v6 offset:3208
    ds_read_b64_tr_b16 v[82:83], v6 offset:6408
    v_mfma_f32_16x16x32_bf16 v[48:51], v[68:71], v[144:147], v[48:51]
    ds_read_b64_tr_b16 v[84:85], v6 offset:3216
    ds_read_b64_tr_b16 v[86:87], v6 offset:6416
    v_mfma_f32_16x16x32_bf16 v[32:35], v[72:75], v[104:107], v[32:35]
    ds_read_b64_tr_b16 v[88:89], v6 offset:3224
    ds_read_b64_tr_b16 v[90:91], v6 offset:6424
    v_mfma_f32_16x16x32_bf16 v[52:55], v[72:75], v[144:147], v[52:55]
    ds_read_b64_tr_b16 v[92:93], v6 offset:3232
    ds_read_b64_tr_b16 v[94:95], v6 offset:6432
    s_waitcnt lgkmcnt(4)
    v_mfma_f32_16x16x32_bf16 v[16:19], v[76:79], v[108:111], v[16:19]
    s_add_u32 s39, s68, s52
    v_mfma_f32_16x16x32_bf16 v[36:39], v[76:79], v[148:151], v[36:39]
    buffer_load_dwordx4 v[126:129], v12, s[48:51], s39 offen sc1
    buffer_load_dwordx4 v[130:133], v12, s[48:51], s39 offen offset:1024 sc1
    v_mfma_f32_16x16x32_bf16 v[20:23], v[80:83], v[108:111], v[20:23]
    buffer_load_dwordx2 v[134:135], v13, s[48:51], s39 offen offset:2048 sc1
    s_add_u32 s39, s68, s53
    v_mfma_f32_16x16x32_bf16 v[40:43], v[80:83], v[148:151], v[40:43]
    buffer_load_dwordx4 v[166:169], v12, s[48:51], s39 offen sc1
    buffer_load_dwordx4 v[170:173], v12, s[48:51], s39 offen offset:1024 sc1
    v_mfma_f32_16x16x32_bf16 v[24:27], v[84:87], v[108:111], v[24:27]
    buffer_load_dwordx2 v[174:175], v13, s[48:51], s39 offen offset:2048 sc1
    ds_read_b64_tr_b16 v[56:57], v6 offset:9600
    v_mfma_f32_16x16x32_bf16 v[44:47], v[84:87], v[148:151], v[44:47]
    ds_read_b64_tr_b16 v[58:59], v7 offset:0
    s_waitcnt lgkmcnt(2)
    v_mfma_f32_16x16x32_bf16 v[28:31], v[88:91], v[108:111], v[28:31]
    ds_read_b64_tr_b16 v[60:61], v6 offset:9608
    ds_read_b64_tr_b16 v[62:63], v7 offset:8
    v_mfma_f32_16x16x32_bf16 v[48:51], v[88:91], v[148:151], v[48:51]
    ds_read_b64_tr_b16 v[64:65], v6 offset:9616
    ds_read_b64_tr_b16 v[66:67], v7 offset:16
    v_mfma_f32_16x16x32_bf16 v[32:35], v[92:95], v[108:111], v[32:35]
    ds_read_b64_tr_b16 v[68:69], v6 offset:9624
    ds_read_b64_tr_b16 v[70:71], v7 offset:24
    v_mfma_f32_16x16x32_bf16 v[52:55], v[92:95], v[148:151], v[52:55]
    ds_read_b64_tr_b16 v[72:73], v6 offset:9632
    ds_read_b64_tr_b16 v[74:75], v7 offset:32
    s_waitcnt lgkmcnt(4)
    v_mfma_f32_16x16x32_bf16 v[16:19], v[56:59], v[112:115], v[16:19]
    ds_read_b64_tr_b16 v[76:77], v8 offset:0
    ds_read_b64_tr_b16 v[78:79], v8 offset:3200
    v_mfma_f32_16x16x32_bf16 v[36:39], v[56:59], v[152:155], v[36:39]
    ds_read_b64_tr_b16 v[80:81], v8 offset:8
    ds_read_b64_tr_b16 v[82:83], v8 offset:3208
    v_mfma_f32_16x16x32_bf16 v[20:23], v[60:63], v[112:115], v[20:23]
    ds_read_b64_tr_b16 v[84:85], v8 offset:16
    ds_read_b64_tr_b16 v[86:87], v8 offset:3216
    v_mfma_f32_16x16x32_bf16 v[40:43], v[60:63], v[152:155], v[40:43]
    ds_read_b64_tr_b16 v[88:89], v8 offset:24
    ds_read_b64_tr_b16 v[90:91], v8 offset:3224
    v_mfma_f32_16x16x32_bf16 v[24:27], v[64:67], v[112:115], v[24:27]
    ds_read_b64_tr_b16 v[92:93], v8 offset:32
    ds_read_b64_tr_b16 v[94:95], v8 offset:3232
    s_waitcnt vmcnt(11)
    v_max3_u32 v3, v116, v117, v118
    v_mfma_f32_16x16x32_bf16 v[44:47], v[64:67], v[152:155], v[44:47]
    s_waitcnt vmcnt(10)
    v_max3_u32 v3, v119, v120, v3
    v_max3_u32 v3, v121, v122, v3
    s_waitcnt lgkmcnt(10)
    v_mfma_f32_16x16x32_bf16 v[28:31], v[68:71], v[112:115], v[28:31]
    s_waitcnt vmcnt(9)
    v_max3_u32 v3, v123, v124, v3
    s_waitcnt vmcnt(8)
    v_max3_u32 v3, v125, v156, v3
    v_mfma_f32_16x16x32_bf16 v[48:51], v[68:71], v[152:155], v[48:51]
    v_max3_u32 v3, v157, v158, v3
    s_waitcnt vmcnt(7)
    v_max3_u32 v3, v159, v160, v3
    v_mfma_f32_16x16x32_bf16 v[32:35], v[72:75], v[112:115], v[32:35]
    v_max3_u32 v3, v161, v162, v3
    s_waitcnt vmcnt(6)
    v_max3_u32 v3, v163, v164, v3
    v_mfma_f32_16x16x32_bf16 v[52:55], v[72:75], v[152:155], v[52:55]
    v_max_u32 v3, v165, v3
    v_cmp_eq_u32 vcc, -1, v3
    s_nop 4
    s_cbranch_vccnz L_redo2
L_ok2:
    s_waitcnt lgkmcnt(4)
    v_mfma_f32_16x16x32_bf16 v[16:19], v[76:79], v[116:119], v[16:19]
    ds_read_b64_tr_b16 v[56:57], v8 offset:6400
    v_mfma_f32_16x16x32_bf16 v[36:39], v[76:79], v[156:159], v[36:39]
    ds_read_b64_tr_b16 v[58:59], v8 offset:9600
    v_mfma_f32_16x16x32_bf16 v[20:23], v[80:83], v[116:119], v[20:23]
    ds_read_b64_tr_b16 v[60:61], v8 offset:6408
    v_mfma_f32_16x16x32_bf16 v[40:43], v[80:83], v[156:159], v[40:43]
    ds_read_b64_tr_b16 v[62:63], v8 offset:9608
    v_mfma_f32_16x16x32_bf16 v[24:27], v[84:87], v[116:119], v[24:27]
    ds_read_b64_tr_b16 v[64:65], v8 offset:6416
    v_mfma_f32_16x16x32_bf16 v[44:47], v[84:87], v[156:159], v[44:47]
    ds_read_b64_tr_b16 v[66:67], v8 offset:9616
    s_waitcnt lgkmcnt(6)
    v_mfma_f32_16x16x32_bf16 v[28:31], v[88:91], v[116:119], v[28:31]
    ds_read_b64_tr_b16 v[68:69], v8 offset:6424
    v_mfma_f32_16x16x32_bf16 v[48:51], v[88:91], v[156:159], v[48:51]
    ds_read_b64_tr_b16 v[70:71], v8 offset:9624
    v_mfma_f32_16x16x32_bf16 v[32:35], v[92:95], v[116:119], v[32:35]
    ds_read_b64_tr_b16 v[72:73], v8 offset:6432
    v_mfma_f32_16x16x32_bf16 v[52:55], v[92:95], v[156:159], v[52:55]
    ds_read_b64_tr_b16 v[74:75], v8 offset:9632
    s_waitcnt lgkmcnt(4)
    v_mfma_f32_16x16x32_bf16 v[16:19], v[56:59], v[120:123], v[16:19]
    ds_read_b64_tr_b16 v[76:77], v9 offset:0
    ds_read_b64_tr_b16 v[78:79], v10 offset:0
    v_mfma_f32_16x16x32_bf16 v[36:39], v[56:59], v[160:163], v[36:39]
    ds_read_b64_tr_b16 v[80:81], v9 offset:8
    ds_read_b64_tr_b16 v[82:83], v10 offset:8
    v_mfma_f32_16x16x32_bf16 v[20:23], v[60:63], v[120:123], v[20:23]
    ds_read_b64_tr_b16 v[84:85], v9 offset:16
    ds_read_b64_tr_b16 v[86:87], v10 offset:16
    v_mfma_f32_16x16x32_bf16 v[40:43], v[60:63], v[160:163], v[40:43]
    ds_read_b64_tr_b16 v[88:89], v9 offset:24
    ds_read_b64_tr_b16 v[90:91], v10 offset:24
    v_mfma_f32_16x16x32_bf16 v[24:27], v[64:67], v[120:123], v[24:27]
    ds_read_b64_tr_b16 v[92:93], v9 offset:32
    ds_read_b64_tr_b16 v[94:95], v10 offset:32
    s_waitcnt vmcnt(5)
    v_max3_u32 v3, v126, v127, v128
    v_mfma_f32_16x16x32_bf16 v[44:47], v[64:67], v[160:163], v[44:47]
    s_waitcnt vmcnt(4)
    v_max3_u32 v3, v129, v130, v3
    v_max3_u32 v3, v131, v132, v3
    s_waitcnt lgkmcnt(10)
    v_mfma_f32_16x16x32_bf16 v[28:31], v[68:71], v[120:123], v[28:31]
    s_waitcnt vmcnt(3)
    v_max3_u32 v3, v133, v134, v3
    s_waitcnt vmcnt(2)
    v_max3_u32 v3, v135, v166, v3
    v_mfma_f32_16x16x32_bf16 v[48:51], v[68:71], v[160:163], v[48:51]
    v_max3_u32 v3, v167, v168, v3
    s_waitcnt vmcnt(1)
    v_max3_u32 v3, v169, v170, v3
    v_mfma_f32_16x16x32_bf16 v[32:35], v[72:75], v[120:123], v[32:35]
    v_max3_u32 v3, v171, v172, v3
    s_waitcnt vmcnt(0)
    v_max3_u32 v3, v173, v174, v3
    v_mfma_f32_16x16x32_bf16 v[52:55], v[72:75], v[160:163], v[52:55]
    v_max_u32 v3, v175, v3
    v_cmp_eq_u32 vcc, -1, v3
    s_nop 4
    s_cbranch_vccnz L_redo3
L_ok3:
    s_waitcnt lgkmcnt(4)
    v_mfma_f32_16x16x32_bf16 v[16:19], v[76:79], v[124:127], v[16:19]
    ds_read_b64_tr_b16 v[56:57], v10 offset:3200
    v_mfma_f32_16x16x32_bf16 v[36:39], v[76:79], v[164:167], v[36:39]
    ds_read_b64_tr_b16 v[58:59], v10 offset:6400
    v_mfma_f32_16x16x32_bf16 v[20:23], v[80:83], v[124:127], v[20:23]
    ds_read_b64_tr_b16 v[60:61], v10 offset:3208
    v_mfma_f32_16x16x32_bf16 v[40:43], v[80:83], v[164:167], v[40:43]
    ds_read_b64_tr_b16 v[62:63], v10 offset:6408
    v_mfma_f32_16x16x32_bf16 v[24:27], v[84:87], v[124:127], v[24:27]
    ds_read_b64_tr_b16 v[64:65], v10 offset:3216
    v_mfma_f32_16x16x32_bf16 v[44:47], v[84:87], v[164:167], v[44:47]
    ds_read_b64_tr_b16 v[66:67], v10 offset:6416
    s_waitcnt lgkmcnt(6)
    v_mfma_f32_16x16x32_bf16 v[28:31], v[88:91], v[124:127], v[28:31]
    ds_read_b64_tr_b16 v[68:69], v10 offset:3224
    v_mfma_f32_16x16x32_bf16 v[48:51], v[88:91], v[164:167], v[48:51]
    ds_read_b64_tr_b16 v[70:71], v10 offset:6424
    v_mfma_f32_16x16x32_bf16 v[32:35], v[92:95], v[124:127], v[32:35]
    ds_read_b64_tr_b16 v[72:73], v10 offset:3232
    v_mfma_f32_16x16x32_bf16 v[52:55], v[92:95], v[164:167], v[52:55]
    ds_read_b64_tr_b16 v[74:75], v10 offset:6432
    s_waitcnt lgkmcnt(8)
    v_mfma_f32_16x16x32_bf16 v[36:39], v[56:59], v[168:171], v[36:39]
    ds_read_b64_tr_b16 v[76:77], v10 offset:9600
    ds_read_b64_tr_b16 v[78:79], v11 offset:0
    s_waitcnt lgkmcnt(8)
    v_mfma_f32_16x16x32_bf16 v[40:43], v[60:63], v[168:171], v[40:43]
    ds_read_b64_tr_b16 v[80:81], v10 offset:9608
    ds_read_b64_tr_b16 v[82:83], v11 offset:8
    s_waitcnt lgkmcnt(8)
    v_mfma_f32_16x16x32_bf16 v[44:47], v[64:67], v[168:171], v[44:47]
    ds_read_b64_tr_b16 v[84:85], v10 offset:9616
    ds_read_b64_tr_b16 v[86:87], v11 offset:16
    s_waitcnt lgkmcnt(8)
    v_mfma_f32_16x16x32_bf16 v[48:51], v[68:71], v[168:171], v[48:51]
    ds_read_b64_tr_b16 v[88:89], v10 offset:9624
    ds_read_b64_tr_b16 v[90:91], v11 offset:24
    s_waitcnt lgkmcnt(8)
    v_mfma_f32_16x16x32_bf16 v[52:55], v[72:75], v[168:171], v[52:55]
    ds_read_b64_tr_b16 v[92:93], v10 offset:9632
    ds_read_b64_tr_b16 v[94:95], v11 offset:32
    s_waitcnt lgkmcnt(8)
    v_mfma_f32_16x16x32_bf16 v[36:39], v[76:79], v[172:175], v[36:39]
    s_waitcnt lgkmcnt(6)
    v_mfma_f32_16x16x32_bf16 v[40:43], v[80:83], v[172:175], v[40:43]
    s_waitcnt lgkmcnt(4)
    v_mfma_f32_16x16x32_bf16 v[44:47], v[84:87], v[172:175], v[44:47]
    s_waitcnt lgkmcnt(2)
    v_mfma_f32_16x16x32_bf16 v[48:51], v[88:91], v[172:175], v[48:51]
    s_waitcnt lgkmcnt(0)
    v_mfma_f32_16x16x32_bf16 v[52:55], v[92:95], v[172:175], v[52:55]
    v_mfma_f32_16x16x32_bf16 v[16:19], v[56:59], v[128:131], v[16:19]
    v_mfma_f32_16x16x32_bf16 v[20:23], v[60:63], v[128:131], v[20:23]
    v_mfma_f32_16x16x32_bf16 v[24:27], v[64:67], v[128:131], v[24:27]
    v_mfma_f32_16x16x32_bf16 v[28:31], v[68:71], v[128:131], v[28:31]
    v_mfma_f32_16x16x32_bf16 v[32:35], v[72:75], v[128:131], v[32:35]
    v_mfma_f32_16x16x32_bf16 v[16:19], v[76:79], v[132:135], v[16:19]
    ds_write_b128 v177, v[36:39] offset:0
    v_mfma_f32_16x16x32_bf16 v[20:23], v[80:83], v[132:135], v[20:23]
    ds_write_b128 v177, v[40:43] offset:1024
    v_mfma_f32_16x16x32_bf16 v[24:27], v[84:87], v[132:135], v[24:27]
    ds_write_b128 v177, v[44:47] offset:2048
    v_mfma_f32_16x16x32_bf16 v[28:31], v[88:91], v[132:135], v[28:31]
    ds_write_b128 v177, v[48:51] offset:3072
    v_mfma_f32_16x16x32_bf16 v[32:35], v[92:95], v[132:135], v[32:35]
    ds_write_b128 v177, v[52:55] offset:4096
    s_waitcnt lgkmcnt(0)
    s_barrier
    s_nop 0
    ds_read_b128 v[56:59], v178 offset:0
    ds_read_b128 v[60:63], v178 offset:1024
    ds_read_b128 v[64:67], v178 offset:2048
    ds_read_b128 v[68:71], v178 offset:3072
    ds_read_b128 v[72:75], v178 offset:4096
    s_waitcnt lgkmcnt(4)
    s_nop 0
    v_pk_add_f32 v[16:17], v[16:17], v[56:57]
    v_pk_add_f32 v[18:19], v[18:19], v[58:59]
    v_cvt_pk_bf16_f32 v16, v16, v17
    v_cvt_pk_bf16_f32 v17, v18, v19
    ds_write_b64 v176, v[16:17] offset:0
    s_waitcnt lgkmcnt(4)
    s_nop 0
    v_pk_add_f32 v[20:21], v[20:21], v[60:61]
    v_pk_add_f32 v[22:23], v[22:23], v[62:63]
    v_cvt_pk_bf16_f32 v20, v20, v21
    v_cvt_pk_bf16_f32 v21, v22, v23
    ds_write_b64 v176, v[20:21] offset:8
    s_waitcnt lgkmcnt(4)
    s_nop 0
    v_pk_add_f32 v[24:25], v[24:25], v[64:65]
    v_pk_add_f32 v[26:27], v[26:27], v[66:67]
    v_cvt_pk_bf16_f32 v24, v24, v25
    v_cvt_pk_bf16_f32 v25, v26, v27
    ds_write_b64 v176, v[24:25] offset:16
    s_waitcnt lgkmcnt(4)
    s_nop 0
    v_pk_add_f32 v[28:29], v[28:29], v[68:69]
    v_pk_add_f32 v[30:31], v[30:31], v[70:71]
    v_cvt_pk_bf16_f32 v28, v28, v29
    v_cvt_pk_bf16_f32 v29, v30, v31
    ds_write_b64 v176, v[28:29] offset:24
    s_waitcnt lgkmcnt(4)
    s_nop 0
    v_pk_add_f32 v[32:33], v[32:33], v[72:73]
    v_pk_add_f32 v[34:35], v[34:35], v[74:75]
    v_cvt_pk_bf16_f32 v32, v32, v33
    v_cvt_pk_bf16_f32 v33, v34, v35
    ds_write_b64 v176, v[32:33] offset:32
    ds_read_b128 v[96:99], v184
    ds_read_b128 v[100:103], v185
    ds_read_b128 v[104:107], v186
    s_waitcnt lgkmcnt(2)
    buffer_store_dwordx4 v[96:99], v180, s[44:47], s60 offen nt
    s_waitcnt lgkmcnt(1)
    buffer_store_dwordx4 v[100:103], v181, s[44:47], s60 offen nt
    s_waitcnt lgkmcnt(0)
    buffer_store_dwordx4 v[104:107], v182, s[44:47], s60 offen nt
    s_endpgm
L_redo0:
    s_mov_b32 s55, 65536
L_redo0_l:
    s_add_u32 s39, s54, s52
    buffer_load_dwordx4 v[96:99], v12, s[48:51], s39 offen sc1
    buffer_load_dwordx4 v[100:103], v12, s[48:51], s39 offen offset:1024 sc1
    buffer_load_dwordx2 v[104:105], v13, s[48:51], s39 offen offset:2048 sc1
    s_add_u32 s39, s54, s53
    buffer_load_dwordx4 v[136:139], v12, s[48:51], s39 offen sc1
    buffer_load_dwordx4 v[140:143], v12, s[48:51], s39 offen offset:1024 sc1
    buffer_load_dwordx2 v[144:145], v13, s[48:51], s39 offen offset:2048 sc1
    s_sub_u32 s55, s55, 1
    s_waitcnt vmcnt(0)
    s_cbranch_scc1 L_redo0_l_x
    s_nop 0
    v_max3_u32 v3, v96, v97, v98
    v_max3_u32 v3, v99, v100, v3
    v_max3_u32 v3, v101, v102, v3
    v_max3_u32 v3, v103, v104, v3
    v_max3_u32 v3, v105, v136, v3
    v_max3_u32 v3, v137, v138, v3
    v_max3_u32 v3, v139, v140, v3
    v_max3_u32 v3, v141, v142, v3
    v_max3_u32 v3, v143, v144, v3
    v_max_u32 v3, v145, v3
    v_cmp_eq_u32_e64 vcc, -1, v3
    s_nop 4
    s_cbranch_vccnz L_redo0_l
L_redo0_l_x:
    s_branch L_ok0
L_redo1:
    s_mov_b32 s55, 65536
L_redo1_l:
    s_add_u32 s39, s61, s52
    buffer_load_dwordx4 v[106:109], v12, s[48:51], s39 offen sc1
    buffer_load_dwordx4 v[110:113], v12, s[48:51], s39 offen offset:1024 sc1
    buffer_load_dwordx2 v[114:115], v13, s[48:51], s39 offen offset:2048 sc1
    s_add_u32 s39, s61, s53
    buffer_load_dwordx4 v[146:149], v12, s[48:51], s39 offen sc1
    buffer_load_dwordx4 v[150:153], v12, s[48:51], s39 offen offset:1024 sc1
    buffer_load_dwordx2 v[154:155], v13, s[48:51], s39 offen offset:2048 sc1
    s_sub_u32 s55, s55, 1
    s_waitcnt vmcnt(0)
    s_cbranch_scc1 L_redo1_l_x
    s_nop 0
    v_max3_u32 v3, v106, v107, v108
    v_max3_u32 v3, v109, v110, v3
    v_max3_u32 v3, v111, v112, v3
    v_max3_u32 v3, v113, v114, v3
    v_max3_u32 v3, v115, v146, v3
    v_max3_u32 v3, v147, v148, v3
    v_max3_u32 v3, v149, v150, v3
    v_max3_u32 v3, v151, v152, v3
    v_max3_u32 v3, v153, v154, v3
    v_max_u32 v3, v155, v3
    v_cmp_eq_u32_e64 vcc, -1, v3
    s_nop 4
    s_cbranch_vccnz L_redo1_l
L_redo1_l_x:
    s_branch L_ok1
L_redo2:
    s_mov_b32 s55, 65536
L_redo2_l:
    s_add_u32 s39, s63, s52
    buffer_load_dwordx4 v[116:119], v12, s[48:51], s39 offen sc1
    buffer_load_dwordx4 v[120:123], v12, s[48:51], s39 offen offset:1024 sc1
    buffer_load_dwordx2 v[124:125], v13, s[48:51], s39 offen offset:2048 sc1
    s_add_u32 s39, s63, s53
    buffer_load_dwordx4 v[156:159], v12, s[48:51], s39 offen sc1
    buffer_load_dwordx4 v[160:163], v12, s[48:51], s39 offen offset:1024 sc1
    buffer_load_dwordx2 v[164:165], v13, s[48:51], s39 offen offset:2048 sc1
    s_sub_u32 s55, s55, 1
    s_waitcnt vmcnt(0)
    s_cbranch_scc1 L_redo2_l_x
    s_nop 0
    v_max3_u32 v3, v116, v117, v118
    v_max3_u32 v3, v119, v120, v3
    v_max3_u32 v3, v121, v122, v3
    v_max3_u32 v3, v123, v124, v3
    v_max3_u32 v3, v125, v156, v3
    v_max3_u32 v3, v157, v158, v3
    v_max3_u32 v3, v159, v160, v3
    v_max3_u32 v3, v161, v162, v3
    v_max3_u32 v3, v163, v164, v3
    v_max_u32 v3, v165, v3
    v_cmp_eq_u32_e64 vcc, -1, v3
    s_nop 4
    s_cbranch_vccnz L_redo2_l
L_redo2_l_x:
    s_branch L_ok2
L_redo3:
    s_mov_b32 s55, 65536
L_redo3_l:
    s_add_u32 s39, s68, s52
    buffer_load_dwordx4 v[126:129], v12, s[48:51], s39 offen sc1
    buffer_load_dwordx4 v[130:133], v12, s[48:51], s39 offen offset:1024 sc1
    buffer_load_dwordx2 v[134:135], v13, s[48:51], s39 offen offset:2048 sc1
    s_add_u32 s39, s68, s53
    buffer_load_dwordx4 v[166:169], v12, s[48:51], s39 offen sc1
    buffer_load_dwordx4 v[170:173], v12, s[48:51], s39 offen offset:1024 sc1
    buffer_load_dwordx2 v[174:175], v13, s[48:51], s39 offen offset:2048 sc1
    s_sub_u32 s55, s55, 1
    s_waitcnt vmcnt(0)
    s_cbranch_scc1 L_redo3_l_x
    s_nop 0
    v_max3_u32 v3, v126, v127, v128
    v_max3_u32 v3, v129, v130, v3
    v_max3_u32 v3, v131, v132, v3
    v_max3_u32 v3, v133, v134, v3
    v_max3_u32 v3, v135, v166, v3
    v_max3_u32 v3, v167, v168, v3
    v_max3_u32 v3, v169, v170, v3
    v_max3_u32 v3, v171, v172, v3
    v_max3_u32 v3, v173, v174, v3
    v_max_u32 v3, v175, v3
    v_cmp_eq_u32_e64 vcc, -1, v3
    s_nop 4
    s_cbranch_vccnz L_redo3_l
L_redo3_l_x:
    s_branch L_ok3
L_q0_fix:
    v_min3_f32 v190, v148, v149, v150
    v_min3_f32 v190, v151, v152, v190
    v_min3_f32 v190, v153, v154, v190
    v_min3_f32 v190, v155, v156, v190
    v_min3_f32 v190, v157, v158, v190
    v_min3_f32 v190, v159, v160, v190
    v_min3_f32 v190, v161, v162, v190
    v_min3_f32 v190, v163, v164, v190
    v_min3_f32 v190, v165, v166, v190
    v_min_f32 v190, v167, v190
    v_mul_f32 v190, s56, v190
    v_fma_f32 v76, -v148, s56, v190
    v_fma_f32 v77, -v149, s56, v190
    v_fma_f32 v78, -v150, s56, v190
    v_fma_f32 v79, -v151, s56, v190
    v_fma_f32 v80, -v152, s56, v190
    v_fma_f32 v81, -v153, s56, v190
    v_fma_f32 v82, -v154, s56, v190
    v_fma_f32 v83, -v155, s56, v190
    v_fma_f32 v84, -v156, s56, v190
    v_fma_f32 v85, -v157, s56, v190
    v_fma_f32 v86, -v158, s56, v190
    v_fma_f32 v87, -v159, s56, v190
    v_fma_f32 v88, -v160, s56, v190
    v_fma_f32 v89, -v161, s56, v190
    v_fma_f32 v90, -v162, s56, v190
    v_fma_f32 v91, -v163, s56, v190
    v_fma_f32 v92, -v164, s56, v190
    v_fma_f32 v93, -v165, s56, v190
    v_fma_f32 v94, -v166, s56, v190
    v_fma_f32 v95, -v167, s56, v190
    v_exp_f32 v76, v76
    v_exp_f32 v77, v77
    v_exp_f32 v78, v78
    v_exp_f32 v79, v79
    v_exp_f32 v80, v80
    v_exp_f32 v81, v81
    v_add_f32 v194, v76, v78
    v_add_f32 v195, v77, v79
    v_exp_f32 v82, v82
    v_exp_f32 v83, v83
    v_add_f32 v194, v194, v80
    v_add_f32 v195, v195, v81
    v_exp_f32 v84, v84
    v_exp_f32 v85, v85
    v_add_f32 v194, v194, v82
    v_add_f32 v195, v195, v83
    v_exp_f32 v86, v86
    v_exp_f32 v87, v87
    v_add_f32 v194, v194, v84
    v_add_f32 v195, v195, v85
    v_exp_f32 v88, v88
    v_exp_f32 v89, v89
    v_add_f32 v194, v194, v86
    v_add_f32 v195, v195, v87
    v_exp_f32 v90, v90
    v_exp_f32 v91, v91
    v_add_f32 v194, v194, v88
    v_add_f32 v195, v195, v89
    v_exp_f32 v92, v92
    v_exp_f32 v93, v93
    v_add_f32 v194, v194, v90
    v_add_f32 v195, v195, v91
    v_exp_f32 v94, v94
    v_exp_f32 v95, v95
    v_add_f32 v194, v194, v92
    v_add_f32 v195, v195, v93
    v_add_f32 v194, v194, v94
    v_add_f32 v195, v195, v95
    v_add_f32 v194, v194, v195
    s_branch L_q0_ok
L_q1_fix:
    v_min3_f32 v190, v168, v169, v170
    v_min3_f32 v190, v171, v172, v190
    v_min3_f32 v190, v173, v174, v190
    v_min3_f32 v190, v175, v176, v190
    v_min3_f32 v190, v177, v178, v190
    v_min3_f32 v190, v179, v180, v190
    v_min3_f32 v190, v181, v182, v190
    v_min3_f32 v190, v183, v184, v190
    v_min3_f32 v190, v185, v186, v190
    v_min_f32 v190, v187, v190
    v_mul_f32 v190, s56, v190
    v_fma_f32 v76, -v168, s56, v190
    v_fma_f32 v77, -v169, s56, v190
    v_fma_f32 v78, -v170, s56, v190
    v_fma_f32 v79, -v171, s56, v190
    v_fma_f32 v80, -v172, s56, v190
    v_fma_f32 v81, -v173, s56, v190
    v_fma_f32 v82, -v174, s56, v190
    v_fma_f32 v83, -v175, s56, v190
    v_fma_f32 v84, -v176, s56, v190
    v_fma_f32 v85, -v177, s56, v190
    v_fma_f32 v86, -v178, s56, v190
    v_fma_f32 v87, -v179, s56, v190
    v_fma_f32 v88, -v180, s56, v190
    v_fma_f32 v89, -v181, s56, v190
    v_fma_f32 v90, -v182, s56, v190
    v_fma_f32 v91, -v183, s56, v190
    v_fma_f32 v92, -v184, s56, v190
    v_fma_f32 v93, -v185, s56, v190
    v_fma_f32 v94, -v186, s56, v190
    v_fma_f32 v95, -v187, s56, v190
    v_exp_f32 v76, v76
    v_exp_f32 v77, v77
    v_exp_f32 v78, v78
    v_exp_f32 v79, v79
    v_exp_f32 v80, v80
    v_exp_f32 v81, v81
    v_add_f32 v194, v76, v78
    v_add_f32 v195, v77, v79
    v_exp_f32 v82, v82
    v_exp_f32 v83, v83
    v_add_f32 v194, v194, v80
    v_add_f32 v195, v195, v81
    v_exp_f32 v84, v84
    v_exp_f32 v85, v85
    v_add_f32 v194, v194, v82
    v_add_f32 v195, v195, v83
    v_exp_f32 v86, v86
    v_exp_f32 v87, v87
    v_add_f32 v194, v194, v84
    v_add_f32 v195, v195, v85
    v_exp_f32 v88, v88
    v_exp_f32 v89, v89
    v_add_f32 v194, v194, v86
    v_add_f32 v195, v195, v87
    v_exp_f32 v90, v90
    v_exp_f32 v91, v91
    v_add_f32 v194, v194, v88
    v_add_f32 v195, v195, v89
    v_exp_f32 v92, v92
    v_exp_f32 v93, v93
    v_add_f32 v194, v194, v90
    v_add_f32 v195, v195, v91
    v_exp_f32 v94, v94
    v_exp_f32 v95, v95
    v_add_f32 v194, v194, v92
    v_add_f32 v195, v195, v93
    v_add_f32 v194, v194, v94
    v_add_f32 v195, v195, v95
    v_add_f32 v194, v194, v195
    s_branch L_q1_ok
L_k0_fix:
    v_min3_f32 v48, v202, v203, v204
    v_min3_f32 v48, v205, v206, v48
    v_min3_f32 v48, v207, v208, v48
    v_min3_f32 v48, v209, v210, v48
    v_min3_f32 v48, v211, v212, v48
    v_min3_f32 v48, v213, v214, v48
    v_min3_f32 v48, v215, v216, v48
    v_min3_f32 v48, v217, v218, v48
    v_min3_f32 v48, v219, v220, v48
    v_min_f32 v48, v221, v48
    v_mul_f32 v48, s56, v48
    v_fma_f32 v116, -v202, s56, v48
    v_fma_f32 v117, -v203, s56, v48
    v_fma_f32 v118, -v204, s56, v48
    v_fma_f32 v119, -v205, s56, v48
    v_fma_f32 v120, -v206, s56, v48
    v_fma_f32 v121, -v207, s56, v48
    v_fma_f32 v122, -v208, s56, v48
    v_fma_f32 v123, -v209, s56, v48
    v_fma_f32 v124, -v210, s56, v48
    v_fma_f32 v125, -v211, s56, v48
    v_fma_f32 v126, -v212, s56, v48
    v_fma_f32 v127, -v213, s56, v48
    v_fma_f32 v128, -v214, s56, v48
    v_fma_f32 v129, -v215, s56, v48
    v_fma_f32 v130, -v216, s56, v48
    v_fma_f32 v131, -v217, s56, v48
    v_fma_f32 v132, -v218, s56, v48
    v_fma_f32 v133, -v219, s56, v48
    v_fma_f32 v134, -v220, s56, v48
    v_fma_f32 v135, -v221, s56, v48
L_wb_6:
    s_cbranch_execz L_wb_x
    v_exp_f32 v116, v116
    v_exp_f32 v117, v117
    v_exp_f32 v118, v118
    v_exp_f32 v119, v119
    v_exp_f32 v120, v120
    v_exp_f32 v121, v121
    v_add_f32 v52, v116, v118
    v_add_f32 v53, v117, v119
    v_exp_f32 v122, v122
    v_exp_f32 v123, v123
    v_add_f32 v52, v52, v120
    v_add_f32 v53, v53, v121
    v_exp_f32 v124, v124
    v_exp_f32 v125, v125
    v_add_f32 v52, v52, v122
    v_add_f32 v53, v53, v123
    v_exp_f32 v126, v126
    v_exp_f32 v127, v127
    v_add_f32 v52, v52, v124
    v_add_f32 v53, v53, v125
    v_exp_f32 v128, v128
    v_exp_f32 v129, v129
    v_add_f32 v52, v52, v126
    v_add_f32 v53, v53, v127
    v_exp_f32 v130, v130
    v_exp_f32 v131, v131
    v_add_f32 v52, v52, v128
    v_add_f32 v53, v53, v129
    v_exp_f32 v132, v132
    v_exp_f32 v133, v133
    v_add_f32 v52, v52, v130
    v_add_f32 v53, v53, v131
    v_exp_f32 v134, v134
    v_exp_f32 v135, v135
    v_add_f32 v52, v52, v132
    v_add_f32 v53, v53, v133
    v_add_f32 v52, v52, v134
    v_add_f32 v53, v53, v135
    v_add_f32_e64 v52, v52, v53
    s_branch L_k0_ok
L_k1_fix:
    v_min3_f32 v48, v222, v223, v224
    v_min3_f32 v48, v225, v226, v48
    v_min3_f32 v48, v227, v228, v48
    v_min3_f32 v48, v229, v230, v48
    v_min3_f32 v48, v231, v232, v48
    v_min3_f32 v48, v233, v234, v48
    v_min3_f32 v48, v235, v236, v48
    v_min3_f32 v48, v237, v238, v48
    v_min3_f32 v48, v239, v240, v48
    v_min_f32 v48, v241, v48
    v_mul_f32 v48, s56, v48
    v_fma_f32 v202, -v222, s56, v48
    v_fma_f32 v203, -v223, s56, v48
    v_fma_f32 v204, -v224, s56, v48
    v_fma_f32 v205, -v225, s56, v48
    v_fma_f32 v206, -v226, s56, v48
    v_fma_f32 v207, -v227, s56, v48
    v_fma_f32 v208, -v228, s56, v48
    v_fma_f32 v209, -v229, s56, v48
    v_fma_f32 v210, -v230, s56, v48
    v_fma_f32 v211, -v231, s56, v48
    v_fma_f32 v212, -v232, s56, v48
    v_fma_f32 v213, -v233, s56, v48
    v_fma_f32 v214, -v234, s56, v48
    v_fma_f32 v215, -v235, s56, v48
    v_fma_f32 v216, -v236, s56, v48
    v_fma_f32 v217, -v237, s56, v48
    v_fma_f32 v218, -v238, s56, v48
    v_fma_f32 v219, -v239, s56, v48
    v_fma_f32 v220, -v240, s56, v48
    v_fma_f32 v221, -v241, s56, v48
    v_exp_f32 v202, v202
    v_exp_f32 v203, v203
    v_exp_f32 v204, v204
    v_exp_f32 v205, v205
    v_exp_f32 v206, v206
    v_exp_f32 v207, v207
    v_add_f32 v52, v202, v204
    v_add_f32 v53, v203, v205
    v_exp_f32 v208, v208
    v_exp_f32 v209, v209
    v_add_f32 v52, v52, v206
    v_add_f32 v53, v53, v207
    v_exp_f32 v210, v210
    v_exp_f32 v211, v211
    v_add_f32 v52, v52, v208
    v_add_f32 v53, v53, v209
    v_exp_f32 v212, v212
    v_exp_f32 v213, v213
    v_add_f32 v52, v52, v210
    v_add_f32 v53, v53, v211
    v_exp_f32 v214, v214
    v_exp_f32 v215, v215
    v_add_f32 v52, v52, v212
    v_add_f32 v53, v53, v213
    v_exp_f32 v216, v216
    v_exp_f32 v217, v217
    v_add_f32 v52, v52, v214
    v_add_f32 v53, v53, v215
    v_exp_f32 v218, v218
    v_exp_f32 v219, v219
    v_add_f32 v52, v52, v216
    v_add_f32 v53, v53, v217
    v_exp_f32 v220, v220
    v_exp_f32 v221, v221
    v_add_f32 v52, v52, v218
    v_add_f32 v53, v53, v219
    v_add_f32 v52, v52, v220
    v_add_f32 v53, v53, v221
    v_add_f32 v52, v52, v53
    s_branch L_k1_ok
.p2align 6
L_A:
    s_mov_b32 s40, s4
    s_mov_b32 s41, s5
    s_mov_b32 s42, 2621440
    s_mov_b32 s43, 0x20000
    s_mov_b32 s44, s30
    s_mov_b32 s45, s31
    s_mov_b32 s46, 5242880
    s_mov_b32 s47, 0x20000
    s_mul_i32 s48, s3, 8704
    s_lshl_b32 s49, s3, 10
    s_add_u32 s49, s49, 104576
    s_mul_i32 s50, s3, 81920
    s_lshl_b32 s62, s55, 4
    s_add_u32 s50, s50, s62
    s_mul_i32 s51, s3, 163840
    s_add_u32 s51, s51, s62
    s_mov_b32 s52, 0x3fb8aa3b
    s_mov_b32 s53, 0x3e22f983
    s_mov_b32 s56, 0
    s_mov_b32 s57, 0x80000000
    v_mul_u32_u24 v86, 1280, v0
    v_mul_u32_u24 v87, 2560, v0
    v_and_b32 v36, 31, v0
    v_lshrrev_b32 v37, 5, v0
    v_mul_u32_u24 v38, 272, v36
    v_lshl_add_u32 v38, v37, 4, v38
    v_add_u32 v76, s48, v38
    v_lshlrev_b32 v38, 4, v36
    v_add_u32_e64 v38, s48, v38
    v_lshl_add_u32 v77, v37, 3, v38
    v_lshl_add_u32 v78, v37, 9, v38
    v_add_u32 v36, 31, v0
    v_and_b32 v36, 31, v36
    v_mul_u32_u24 v38, 272, v36
    v_lshl_add_u32 v38, v37, 4, v38
    v_add_u32 v79, s48, v38
    v_lshrrev_b32 v39, 4, v0
    v_bfe_u32 v40, v0, 2, 2
    v_and_b32_e64 v41, 3, v0
    s_mul_i32 s62, s3, 4368
    s_add_u32 s62, s62, 69632
    v_add_u32 v36, v39, v41
    v_lshlrev_b32 v36, 2, v36
    v_add_u32_e64 v36, v36, v40
    v_lshl_add_u32 v80, v36, 3, s62
    v_min_u32_e64 v36, 55, v0
    v_lshl_add_u32 v36, v36, 2, s62
    v_mov_b32_e64 v37, 0
    ds_write_b32 v36, v37
    v_lshl_add_u32 v36, v39, 2, v40
    v_sub_u32 v36, v41, v36
    v_add_u32 v36, 16, v36
    v_lshl_add_u32 v81, v36, 3, s48
    s_mul_i32 s39, s3, 4160
    s_add_u32 s39, s39, 104576
    v_lshl_add_u32 v82, v0, 1, s39
    v_lshl_add_u32 v36, v39, 2, v41
    v_lshlrev_b32 v36, 3, v36
    s_movk_i32 s54, 4160
    v_mad_u32_u24 v36, v40, s54, v36
    s_lshl_b32 s39, s3, 7
    s_add_u32 s39, s39, 104576
    v_add_u32 v83, s39, v36
    v_lshrrev_b32_e64 v36, 1, v41
    v_lshl_add_u32 v36, v39, 1, v36
    v_lshl_add_u32 v36, v36, 2, v40
    v_and_b32_e64 v37, 1, v41
    v_lshl_add_u32 v36, v36, 1, v37
    v_lshl_add_u32 v84, v36, 3, s49
    v_and_b32_e64 v36, 7, v0
    v_mul_u32_u24 v36, 4368, v36
    v_lshrrev_b32_e64 v37, 3, v0
    v_lshl_add_u32 v36, v37, 3, v36
    s_lshl_b32 s39, s3, 7
    s_add_u32 s39, s39, 69856
    v_add_u32 v85, s39, v36
    v_mov_b32 v74, 0x3f80
    v_mov_b32 v161, 0
    v_mov_b32 v162, 0
    v_mov_b32 v163, 0
    v_mov_b32 v164, 0
    v_mov_b32 v165, 0
    v_mov_b32 v166, 0
    v_mov_b32 v167, 0
    v_mov_b32 v168, 0
    v_mov_b32 v169, 0
    v_mov_b32 v170, 0
    v_mov_b32 v171, 0
    v_mov_b32 v172, 0
    v_mov_b32 v173, 0
    v_mov_b32 v174, 0
    v_mov_b32_e64 v175, 0
    s_mov_b32 m0, s48
    s_nop 0
    ds_write_addtid_b32 v74 offset:8432
    s_mov_b64 exec, 0
    s_branch L_wa_0
L_wa_x:
    s_mov_b64 exec, -1
    s_waitcnt vmcnt(0)
    global_load_dword v255, v250, s[96:97]
    s_barrier
    global_load_dword v255, v251, s[98:99]
    s_waitcnt vmcnt(0)
    s_barrier
    s_nop 0
    global_load_dword v255, v252, s[4:5] nt
    global_load_short_d16_hi v20, v34, s[18:19]
    global_load_short_d16_hi v21, v34, s[20:21]
    global_load_dword v8, v1, s[6:7] nt
    global_load_dword v9, v1, s[8:9] nt
    global_load_dword v10, v1, s[10:11] nt
    global_load_dword v11, v1, s[12:13] nt
    global_load_dword v12, v1, s[14:15] nt
    global_load_dword v13, v1, s[16:17] nt
    global_load_short_d16_hi v14, v35, s[6:7] offset:256 nt
    global_load_short_d16_hi v15, v35, s[8:9] offset:256 nt
    global_load_short_d16_hi v16, v35, s[10:11] offset:256 nt
    global_load_short_d16_hi v17, v35, s[12:13] offset:256 nt
    global_load_short_d16_hi v18, v35, s[14:15] offset:256 nt
    global_load_short_d16_hi v19, v35, s[16:17] offset:256 nt
    s_waitcnt vmcnt(13)
    v_mul_f32 v34, s52, v20
    v_fma_f32 v35, v20, s52, -v34
    v_fmac_f32 v35, 0x32a57060, v20
    v_exp_f32_e64 v34, v34
    v_mul_f32 v35, 0x3f317218, v35
    v_fmac_f32_e64 v34, v34, v35
    v_cvt_pk_bf16_f32 v34, v34, v34
    v_lshlrev_b32 v20, 16, v34
    s_waitcnt vmcnt(11)
    v_lshlrev_b32_e64 v2, 16, v8
    v_and_b32 v8, 0xffff0000, v8
    s_waitcnt vmcnt(10)
    v_lshlrev_b32 v3, 16, v9
    v_and_b32 v9, 0xffff0000, v9
    s_waitcnt vmcnt(9)
    v_lshlrev_b32 v4, 16, v10
    v_and_b32 v10, 0xffff0000, v10
    s_waitcnt vmcnt(8)
    v_lshlrev_b32 v5, 16, v11
    v_and_b32 v11, 0xffff0000, v11
    s_waitcnt vmcnt(7)
    v_lshlrev_b32 v6, 16, v12
    v_and_b32 v12, 0xffff0000, v12
    s_waitcnt vmcnt(6)
    v_lshlrev_b32 v7, 16, v13
    v_and_b32 v13, 0xffff0000, v13
    s_waitcnt vmcnt(0)
    v_add_u32 v252, 1310720, v252
    global_load_dword v255, v252, s[4:5] nt
    v_mul_f32 v34, v2, v20
    v_mul_f32 v35, v3, v20
    v_mul_f32 v34, s52, v34
    v_mul_f32_e64 v35, s53, v35
    v_mul_f32 v39, 0x41000000, v35
    v_fract_f32_e64 v41, v35
    v_mul_f32 v43, 0x43800000, v35
    v_mul_f32_e64 v4, v4, v20
    v_mul_f32 v38, 0x41000000, v34
    v_exp_f32_e64 v40, v34
    v_mul_f32 v42, 0x43800000, v34
    v_mul_f32 v5, v5, v20
    v_fract_f32 v39, v39
    v_cos_f32 v22, v41
    v_fract_f32 v43, v43
    v_mul_f32 v36, v6, v4
    v_exp_f32 v38, v38
    v_sin_f32 v23, v41
    v_exp_f32 v42, v42
    v_mul_f32 v37, v6, v5
    v_cos_f32 v28, v39
    v_mul_f32 v22, v22, v40
    v_cos_f32 v32, v43
    v_fma_f32 v36, -v7, v5, v36
    v_sin_f32 v29, v39
    v_mul_f32 v23, v23, v40
    v_sin_f32 v33, v43
    v_fmac_f32 v37, v7, v4
    v_mul_f32 v28, v28, v38
    v_mul_f32 v32, v32, v42
    v_mul_f32 v29, v29, v38
    v_mul_f32 v33, v33, v42
    v_pk_mul_f32 v[50:51], v[28:29], v[28:29] op_sel:[0,0] op_sel_hi:[1,0]
    v_pk_mul_f32 v[24:25], v[22:23], v[22:23] op_sel:[0,0] op_sel_hi:[1,0]
    v_pk_fma_f32 v[50:51], v[28:29], v[28:29], v[50:51] op_sel:[1,1,0] op_sel_hi:[0,1,1] neg_lo:[1,0,0]
    v_pk_mul_f32 v[30:31], v[50:51], v[50:51] op_sel:[0,0] op_sel_hi:[1,0]
    v_pk_fma_f32 v[24:25], v[22:23], v[22:23], v[24:25] op_sel:[1,1,0] op_sel_hi:[0,1,1] neg_lo:[1,0,0]
    v_cvt_pk_bf16_f32 v66, v50, -v51
    v_pk_mul_f32 v[52:53], v[50:51], v[28:29] op_sel:[0,0] op_sel_hi:[1,0]
    v_pk_fma_f32 v[30:31], v[50:51], v[50:51], v[30:31] op_sel:[1,1,0] op_sel_hi:[0,1,1] neg_lo:[1,0,0]
    ds_write_addtid_b32 v66 offset:272
    v_pk_mul_f32 v[26:27], v[24:25], v[24:25] op_sel:[0,0] op_sel_hi:[1,0]
    v_pk_fma_f32 v[52:53], v[50:51], v[28:29], v[52:53] op_sel:[1,1,0] op_sel_hi:[0,1,1] neg_lo:[1,0,0]
    v_cvt_pk_bf16_f32 v67, v30, -v31
    v_pk_fma_f32 v[26:27], v[24:25], v[24:25], v[26:27] op_sel:[1,1,0] op_sel_hi:[0,1,1] neg_lo:[1,0,0]
    v_cvt_pk_bf16_f32 v68, v52, -v53
    ds_write_addtid_b32 v67 offset:816
    v_pk_mul_f32 v[54:55], v[28:29], v[30:31] op_sel:[0,0] op_sel_hi:[1,0]
    ds_write_addtid_b32 v68 offset:544
    v_pk_mul_f32 v[56:57], v[50:51], v[30:31] op_sel:[0,0] op_sel_hi:[1,0]
    v_pk_fma_f32 v[54:55], v[28:29], v[30:31], v[54:55] op_sel:[1,1,0] op_sel_hi:[0,1,1] neg_lo:[1,0,0]
    v_cvt_pk_bf16_f32 v69, v28, -v29
    v_pk_mul_f32 v[58:59], v[52:53], v[30:31] op_sel:[0,0] op_sel_hi:[1,0]
    v_pk_fma_f32 v[56:57], v[50:51], v[30:31], v[56:57] op_sel:[1,1,0] op_sel_hi:[0,1,1] neg_lo:[1,0,0]
    v_cvt_pk_bf16_f32 v70, v54, -v55
    ds_write_addtid_b32 v69 offset:0
    v_pk_mul_f32 v[60:61], v[30:31], v[30:31] op_sel:[0,0] op_sel_hi:[1,0]
    v_pk_fma_f32 v[58:59], v[52:53], v[30:31], v[58:59] op_sel:[1,1,0] op_sel_hi:[0,1,1] neg_lo:[1,0,0]
    v_cvt_pk_bf16_f32 v71, v56, -v57
    ds_write_addtid_b32 v70 offset:1088
    v_pk_mul_f32 v[62:63], v[54:55], v[30:31] op_sel:[0,0] op_sel_hi:[1,0]
    v_pk_fma_f32 v[60:61], v[30:31], v[30:31], v[60:61] op_sel:[1,1,0] op_sel_hi:[0,1,1] neg_lo:[1,0,0]
    v_cvt_pk_bf16_f32 v72, v58, -v59
    ds_write_addtid_b32 v71 offset:1360
    v_pk_mul_f32 v[64:65], v[56:57], v[30:31] op_sel:[0,0] op_sel_hi:[1,0]
    v_pk_fma_f32 v[62:63], v[54:55], v[30:31], v[62:63] op_sel:[1,1,0] op_sel_hi:[0,1,1] neg_lo:[1,0,0]
    v_cvt_pk_bf16_f32 v73, v60, -v61
    ds_write_addtid_b32 v72 offset:1632
    v_pk_mul_f32 v[44:45], v[58:59], v[30:31] op_sel:[0,0] op_sel_hi:[1,0]
    v_pk_fma_f32 v[64:65], v[56:57], v[30:31], v[64:65] op_sel:[1,1,0] op_sel_hi:[0,1,1] neg_lo:[1,0,0]
    v_cvt_pk_bf16_f32 v66, v62, -v63
    ds_write_addtid_b32 v73 offset:1904
    v_pk_mul_f32 v[46:47], v[60:61], v[30:31] op_sel:[0,0] op_sel_hi:[1,0]
    v_pk_fma_f32 v[44:45], v[58:59], v[30:31], v[44:45] op_sel:[1,1,0] op_sel_hi:[0,1,1] neg_lo:[1,0,0]
    v_cvt_pk_bf16_f32 v67, v64, -v65
    ds_write_addtid_b32 v66 offset:2176
    v_pk_mul_f32 v[48:49], v[62:63], v[30:31] op_sel:[0,0] op_sel_hi:[1,0]
    v_pk_fma_f32 v[46:47], v[60:61], v[30:31], v[46:47] op_sel:[1,1,0] op_sel_hi:[0,1,1] neg_lo:[1,0,0]
    v_cvt_pk_bf16_f32 v68, v44, -v45
    ds_write_addtid_b32 v67 offset:2448
    v_pk_mul_f32 v[50:51], v[64:65], v[30:31] op_sel:[0,0] op_sel_hi:[1,0]
    v_pk_fma_f32 v[48:49], v[62:63], v[30:31], v[48:49] op_sel:[1,1,0] op_sel_hi:[0,1,1] neg_lo:[1,0,0]
    v_cvt_pk_bf16_f32 v69, v46, -v47
    ds_write_addtid_b32 v68 offset:2720
    v_pk_mul_f32 v[52:53], v[44:45], v[30:31] op_sel:[0,0] op_sel_hi:[1,0]
    v_pk_fma_f32 v[50:51], v[64:65], v[30:31], v[50:51] op_sel:[1,1,0] op_sel_hi:[0,1,1] neg_lo:[1,0,0]
    v_cvt_pk_bf16_f32 v70, v48, -v49
    ds_write_addtid_b32 v69 offset:2992
    v_pk_mul_f32 v[54:55], v[46:47], v[30:31] op_sel:[0,0] op_sel_hi:[1,0]
    v_pk_fma_f32 v[52:53], v[44:45], v[30:31], v[52:53] op_sel:[1,1,0] op_sel_hi:[0,1,1] neg_lo:[1,0,0]
    v_cvt_pk_bf16_f32 v71, v50, -v51
    ds_write_addtid_b32 v70 offset:3264
    v_pk_mul_f32 v[56:57], v[48:49], v[30:31] op_sel:[0,0] op_sel_hi:[1,0]
    v_pk_fma_f32 v[54:55], v[46:47], v[30:31], v[54:55] op_sel:[1,1,0] op_sel_hi:[0,1,1] neg_lo:[1,0,0]
    v_cvt_pk_bf16_f32 v72, v52, -v53
    ds_write_addtid_b32 v71 offset:3536
    v_pk_mul_f32 v[58:59], v[50:51], v[30:31] op_sel:[0,0] op_sel_hi:[1,0]
    v_pk_fma_f32 v[56:57], v[48:49], v[30:31], v[56:57] op_sel:[1,1,0] op_sel_hi:[0,1,1] neg_lo:[1,0,0]
    v_cvt_pk_bf16_f32 v73, v54, -v55
    ds_write_addtid_b32 v72 offset:3808
    v_pk_mul_f32 v[60:61], v[52:53], v[30:31] op_sel:[0,0] op_sel_hi:[1,0]
    v_pk_fma_f32 v[58:59], v[50:51], v[30:31], v[58:59] op_sel:[1,1,0] op_sel_hi:[0,1,1] neg_lo:[1,0,0]
    v_cvt_pk_bf16_f32 v66, v56, -v57
    ds_write_addtid_b32 v73 offset:4080
    v_pk_mul_f32 v[62:63], v[54:55], v[30:31] op_sel:[0,0] op_sel_hi:[1,0]
    v_pk_fma_f32 v[60:61], v[52:53], v[30:31], v[60:61] op_sel:[1,1,0] op_sel_hi:[0,1,1] neg_lo:[1,0,0]
    v_cvt_pk_bf16_f32 v67, v58, -v59
    ds_write_addtid_b32 v66 offset:4352
    v_pk_mul_f32 v[64:65], v[56:57], v[30:31] op_sel:[0,0] op_sel_hi:[1,0]
    v_pk_fma_f32 v[62:63], v[54:55], v[30:31], v[62:63] op_sel:[1,1,0] op_sel_hi:[0,1,1] neg_lo:[1,0,0]
    v_cvt_pk_bf16_f32 v68, v60, -v61
    ds_write_addtid_b32 v67 offset:4624
    v_pk_mul_f32 v[44:45], v[58:59], v[30:31] op_sel:[0,0] op_sel_hi:[1,0]
    v_pk_fma_f32 v[64:65], v[56:57], v[30:31], v[64:65] op_sel:[1,1,0] op_sel_hi:[0,1,1] neg_lo:[1,0,0]
    v_cvt_pk_bf16_f32 v69, v62, -v63
    ds_write_addtid_b32 v68 offset:4896
    v_pk_mul_f32 v[46:47], v[60:61], v[30:31] op_sel:[0,0] op_sel_hi:[1,0]
    v_pk_fma_f32 v[44:45], v[58:59], v[30:31], v[44:45] op_sel:[1,1,0] op_sel_hi:[0,1,1] neg_lo:[1,0,0]
    v_cvt_pk_bf16_f32 v70, v64, -v65
    ds_write_addtid_b32 v69 offset:5168
    v_pk_mul_f32 v[48:49], v[62:63], v[30:31] op_sel:[0,0] op_sel_hi:[1,0]
    v_pk_fma_f32 v[46:47], v[60:61], v[30:31], v[46:47] op_sel:[1,1,0] op_sel_hi:[0,1,1] neg_lo:[1,0,0]
    v_cvt_pk_bf16_f32 v71, v44, -v45
    ds_write_addtid_b32 v70 offset:5440
    v_pk_mul_f32 v[50:51], v[64:65], v[30:31] op_sel:[0,0] op_sel_hi:[1,0]
    v_pk_fma_f32 v[48:49], v[62:63], v[30:31], v[48:49] op_sel:[1,1,0] op_sel_hi:[0,1,1] neg_lo:[1,0,0]
    v_cvt_pk_bf16_f32 v72, v46, -v47
    ds_write_addtid_b32 v71 offset:5712
    v_pk_mul_f32 v[52:53], v[44:45], v[30:31] op_sel:[0,0] op_sel_hi:[1,0]
    v_pk_fma_f32 v[50:51], v[64:65], v[30:31], v[50:51] op_sel:[1,1,0] op_sel_hi:[0,1,1] neg_lo:[1,0,0]
    v_cvt_pk_bf16_f32 v73, v48, -v49
    ds_write_addtid_b32 v72 offset:5984
    v_pk_mul_f32 v[54:55], v[46:47], v[30:31] op_sel:[0,0] op_sel_hi:[1,0]
    v_pk_fma_f32 v[52:53], v[44:45], v[30:31], v[52:53] op_sel:[1,1,0] op_sel_hi:[0,1,1] neg_lo:[1,0,0]
    v_cvt_pk_bf16_f32 v66, v50, -v51
    ds_write_addtid_b32 v73 offset:6256
    v_pk_mul_f32 v[56:57], v[48:49], v[30:31] op_sel:[0,0] op_sel_hi:[1,0]
    v_pk_fma_f32 v[54:55], v[46:47], v[30:31], v[54:55] op_sel:[1,1,0] op_sel_hi:[0,1,1] neg_lo:[1,0,0]
    v_cvt_pk_bf16_f32 v67, v52, -v53
    ds_write_addtid_b32 v66 offset:6528
    v_pk_mul_f32 v[58:59], v[50:51], v[30:31] op_sel:[0,0] op_sel_hi:[1,0]
    v_pk_fma_f32 v[56:57], v[48:49], v[30:31], v[56:57] op_sel:[1,1,0] op_sel_hi:[0,1,1] neg_lo:[1,0,0]
    v_cvt_pk_bf16_f32 v68, v54, -v55
    ds_write_addtid_b32 v67 offset:6800
    v_pk_mul_f32 v[60:61], v[52:53], v[30:31] op_sel:[0,0] op_sel_hi:[1,0]
    v_pk_fma_f32 v[58:59], v[50:51], v[30:31], v[58:59] op_sel:[1,1,0] op_sel_hi:[0,1,1] neg_lo:[1,0,0]
    v_cvt_pk_bf16_f32 v69, v56, -v57
    ds_write_addtid_b32 v68 offset:7072
    v_pk_mul_f32 v[62:63], v[54:55], v[30:31] op_sel:[0,0] op_sel_hi:[1,0]
    v_pk_fma_f32 v[60:61], v[52:53], v[30:31], v[60:61] op_sel:[1,1,0] op_sel_hi:[0,1,1] neg_lo:[1,0,0]
    v_cvt_pk_bf16_f32 v70, v58, -v59
    ds_write_addtid_b32 v69 offset:7344
    v_pk_fma_f32 v[62:63], v[54:55], v[30:31], v[62:63] op_sel:[1,1,0] op_sel_hi:[0,1,1] neg_lo:[1,0,0]
    v_cvt_pk_bf16_f32 v71, v60, -v61
    ds_write_addtid_b32 v70 offset:7616
    v_cvt_pk_bf16_f32 v72, v62, -v63
    ds_write_addtid_b32 v71 offset:7888
    ds_write_addtid_b32 v72 offset:8160
    v_cmp_eq_u32 vcc, 0, v0
    s_nop 1
    v_cndmask_b32_e64 v160, 0, v21, vcc
    ds_read_b128 v[96:99], v79 offset:0
    v_pk_mul_f32 v[50:51], v[36:37], v[32:33] op_sel:[0,0] op_sel_hi:[1,0]
    v_pk_mul_f32 v[52:53], v[36:37], v[22:23] op_sel:[0,0] op_sel_hi:[1,0]
    ds_read_b128 v[100:103], v79 offset:32
    v_pk_fma_f32 v[50:51], v[36:37], v[32:33], v[50:51] op_sel:[1,1,0] op_sel_hi:[0,1,1] neg_lo:[1,0,0]
    v_pk_mul_f32 v[54:55], v[50:51], v[32:33] op_sel:[0,0] op_sel_hi:[1,0]
    ds_read_b128 v[104:107], v79 offset:64
    v_pk_fma_f32 v[52:53], v[36:37], v[22:23], v[52:53] op_sel:[1,1,0] op_sel_hi:[0,1,1] neg_lo:[1,0,0]
    v_cvt_pk_bf16_f32 v73, v50, v51
    ds_read_b128 v[108:111], v79 offset:96
    v_pk_mul_f32 v[56:57], v[36:37], v[24:25] op_sel:[0,0] op_sel_hi:[1,0]
    v_pk_fma_f32 v[54:55], v[50:51], v[32:33], v[54:55] op_sel:[1,1,0] op_sel_hi:[0,1,1] neg_lo:[1,0,0]
    v_cvt_pk_bf16_f32 v66, v52, v53
    ds_read_b128 v[112:115], v79 offset:128
    v_pk_mul_f32 v[58:59], v[54:55], v[32:33] op_sel:[0,0] op_sel_hi:[1,0]
    v_pk_fma_f32 v[56:57], v[36:37], v[24:25], v[56:57] op_sel:[1,1,0] op_sel_hi:[0,1,1] neg_lo:[1,0,0]
    ds_read_b128 v[116:119], v79 offset:160
    v_cvt_pk_bf16_f32 v67, v54, v55
    v_pk_mul_f32 v[60:61], v[52:53], v[24:25] op_sel:[0,0] op_sel_hi:[1,0]
    ds_read_b128 v[120:123], v79 offset:192
    v_pk_fma_f32 v[58:59], v[54:55], v[32:33], v[58:59] op_sel:[1,1,0] op_sel_hi:[0,1,1] neg_lo:[1,0,0]
    v_cvt_pk_bf16_f32 v68, v56, v57
    ds_read_b128 v[124:127], v79 offset:224
    v_pk_mul_f32 v[62:63], v[58:59], v[32:33] op_sel:[0,0] op_sel_hi:[1,0]
    v_pk_fma_f32 v[60:61], v[52:53], v[24:25], v[60:61] op_sel:[1,1,0] op_sel_hi:[0,1,1] neg_lo:[1,0,0]
    v_cvt_pk_bf16_f32 v69, v58, v59
    ds_write_addtid_b32 v73 offset:2176
    ds_write_addtid_b32 v73 offset:4080
    ds_write_addtid_b32 v66 offset:272
    ds_write_addtid_b32 v67 offset:4352
    ds_write_addtid_b32 v68 offset:544
    v_pk_mul_f32 v[64:65], v[36:37], v[26:27] op_sel:[0,0] op_sel_hi:[1,0]
    v_pk_fma_f32 v[62:63], v[58:59], v[32:33], v[62:63] op_sel:[1,1,0] op_sel_hi:[0,1,1] neg_lo:[1,0,0]
    v_cvt_pk_bf16_f32 v70, v60, v61
    ds_write_addtid_b32 v69 offset:5440
    v_pk_mul_f32 v[44:45], v[62:63], v[32:33] op_sel:[0,0] op_sel_hi:[1,0]
    v_pk_fma_f32 v[64:65], v[36:37], v[26:27], v[64:65] op_sel:[1,1,0] op_sel_hi:[0,1,1] neg_lo:[1,0,0]
    v_cvt_pk_bf16_f32 v71, v62, v63
    ds_write_addtid_b32 v70 offset:816
    v_pk_mul_f32 v[46:47], v[52:53], v[26:27] op_sel:[0,0] op_sel_hi:[1,0]
    v_pk_fma_f32 v[44:45], v[62:63], v[32:33], v[44:45] op_sel:[1,1,0] op_sel_hi:[0,1,1] neg_lo:[1,0,0]
    v_cvt_pk_bf16_f32 v72, v64, v65
    ds_write_addtid_b32 v71 offset:4896
    v_pk_mul_f32 v[48:49], v[44:45], v[32:33] op_sel:[0,0] op_sel_hi:[1,0]
    v_pk_fma_f32 v[46:47], v[52:53], v[26:27], v[46:47] op_sel:[1,1,0] op_sel_hi:[0,1,1] neg_lo:[1,0,0]
    v_cvt_pk_bf16_f32 v73, v44, v45
    ds_write_addtid_b32 v72 offset:1088
    v_pk_mul_f32 v[38:39], v[56:57], v[26:27] op_sel:[0,0] op_sel_hi:[1,0]
    v_pk_fma_f32 v[48:49], v[44:45], v[32:33], v[48:49] op_sel:[1,1,0] op_sel_hi:[0,1,1] neg_lo:[1,0,0]
    v_cvt_pk_bf16_f32 v66, v46, v47
    ds_write_addtid_b32 v73 offset:5984
    v_pk_mul_f32 v[40:41], v[48:49], v[32:33] op_sel:[0,0] op_sel_hi:[1,0]
    v_pk_fma_f32 v[38:39], v[56:57], v[26:27], v[38:39] op_sel:[1,1,0] op_sel_hi:[0,1,1] neg_lo:[1,0,0]
    v_cvt_pk_bf16_f32 v67, v48, v49
    ds_write_addtid_b32 v66 offset:1360
    v_pk_mul_f32 v[42:43], v[60:61], v[26:27] op_sel:[0,0] op_sel_hi:[1,0]
    v_pk_fma_f32 v[40:41], v[48:49], v[32:33], v[40:41] op_sel:[1,1,0] op_sel_hi:[0,1,1] neg_lo:[1,0,0]
    v_cvt_pk_bf16_f32 v68, v38, v39
    ds_write_addtid_b32 v67 offset:5168
    v_pk_mul_f32 v[62:63], v[40:41], v[32:33] op_sel:[0,0] op_sel_hi:[1,0]
    v_pk_fma_f32 v[42:43], v[60:61], v[26:27], v[42:43] op_sel:[1,1,0] op_sel_hi:[0,1,1] neg_lo:[1,0,0]
    v_cvt_pk_bf16_f32 v69, v40, v41
    ds_write_addtid_b32 v68 offset:1632
    v_pk_mul_f32 v[64:65], v[50:51], v[24:25] op_sel:[0,0] op_sel_hi:[1,0]
    v_pk_fma_f32 v[62:63], v[40:41], v[32:33], v[62:63] op_sel:[1,1,0] op_sel_hi:[0,1,1] neg_lo:[1,0,0]
    v_cvt_pk_bf16_f32 v70, v42, v43
    ds_write_addtid_b32 v69 offset:6256
    v_pk_mul_f32 v[52:53], v[50:51], v[26:27] op_sel:[0,0] op_sel_hi:[1,0]
    v_pk_fma_f32 v[64:65], v[50:51], v[24:25], v[64:65] op_sel:[1,1,0] op_sel_hi:[0,1,1] neg_lo:[1,0,0]
    v_cvt_pk_bf16_f32 v71, v62, v63
    ds_write_addtid_b32 v70 offset:1904
    v_pk_mul_f32 v[44:45], v[54:55], v[26:27] op_sel:[0,0] op_sel_hi:[1,0]
    v_pk_fma_f32 v[52:53], v[50:51], v[26:27], v[52:53] op_sel:[1,1,0] op_sel_hi:[0,1,1] neg_lo:[1,0,0]
    v_cvt_pk_bf16_f32 v72, v64, v65
    ds_write_addtid_b32 v71 offset:2992
    v_pk_mul_f32 v[46:47], v[64:65], v[26:27] op_sel:[0,0] op_sel_hi:[1,0]
    v_pk_fma_f32 v[44:45], v[54:55], v[26:27], v[44:45] op_sel:[1,1,0] op_sel_hi:[0,1,1] neg_lo:[1,0,0]
    v_cvt_pk_bf16_f32 v73, v52, v53
    ds_write_addtid_b32 v72 offset:2448
    v_pk_mul_f32 v[56:57], v[58:59], v[26:27] op_sel:[0,0] op_sel_hi:[1,0]
    v_pk_fma_f32 v[46:47], v[64:65], v[26:27], v[46:47] op_sel:[1,1,0] op_sel_hi:[0,1,1] neg_lo:[1,0,0]
    v_cvt_pk_bf16_f32 v66, v44, v45
    ds_write_addtid_b32 v73 offset:2720
    ds_write_addtid_b32 v73 offset:3264
    v_pk_fma_f32 v[56:57], v[58:59], v[26:27], v[56:57] op_sel:[1,1,0] op_sel_hi:[0,1,1] neg_lo:[1,0,0]
    v_cvt_pk_bf16_f32 v67, v46, v47
    ds_write_addtid_b32 v66 offset:4624
    v_cvt_pk_bf16_f32 v68, v56, v57
    ds_write_addtid_b32 v67 offset:3536
    v_cvt_pk_bf16_f32 v69, v36, v37
    ds_write_addtid_b32 v68 offset:5712
    ds_write_addtid_b32 v69 offset:0
    ds_read_b128 v[128:131], v76 offset:0
    ds_read_b128 v[132:135], v76 offset:32
    ds_read_b128 v[136:139], v76 offset:64
    ds_read_b128 v[140:143], v76 offset:96
    ds_read_b128 v[144:147], v76 offset:128
    ds_read_b128 v[148:151], v76 offset:160
    ds_read_b128 v[152:155], v76 offset:192
    ds_read_b128 v[156:159], v76 offset:224
    s_cmp_lt_u32 s3, 4
    s_cbranch_scc1 L_a_prio
    s_setprio 1
L_a_prio:
    v_mul_f32 v34, v8, v20
    v_mul_f32 v35, v9, v20
    v_mul_f32 v34, s52, v34
    v_mul_f32_e64 v35, s53, v35
    v_mul_f32 v39, 0x41000000, v35
    v_fract_f32 v41, v35
    s_waitcnt lgkmcnt(7)
    v_mfma_f32_32x32x16_bf16 v[160:175], v[128:131], v[96:99], v[160:175]
    v_mul_f32 v43, 0x43800000, v35
    v_mul_f32_e64 v10, v10, v20
    v_mul_f32 v38, 0x41000000, v34
    s_waitcnt lgkmcnt(6)
    v_mfma_f32_32x32x16_bf16 v[160:175], v[132:135], v[100:103], v[160:175]
    v_exp_f32 v40, v34
    v_mul_f32 v42, 0x43800000, v34
    v_mul_f32 v11, v11, v20
    s_waitcnt lgkmcnt(5)
    v_mfma_f32_32x32x16_bf16 v[160:175], v[136:139], v[104:107], v[160:175]
    v_fract_f32 v39, v39
    v_cos_f32 v22, v41
    v_fract_f32 v43, v43
    s_waitcnt lgkmcnt(4)
    v_mfma_f32_32x32x16_bf16 v[160:175], v[140:143], v[108:111], v[160:175]
    v_mul_f32 v36, v12, v10
    v_exp_f32 v38, v38
    v_sin_f32 v23, v41
    v_exp_f32_e64 v42, v42
    s_waitcnt lgkmcnt(3)
    v_mfma_f32_32x32x16_bf16 v[160:175], v[144:147], v[112:115], v[160:175]
    v_mul_f32 v37, v12, v11
    v_cos_f32 v28, v39
    v_mul_f32 v22, v22, v40
    s_waitcnt lgkmcnt(2)
    v_mfma_f32_32x32x16_bf16 v[160:175], v[148:151], v[116:119], v[160:175]
    v_cos_f32_e64 v32, v43
    v_fma_f32 v36, -v13, v11, v36
    v_sin_f32 v29, v39
    s_waitcnt lgkmcnt(1)
    v_mfma_f32_32x32x16_bf16 v[160:175], v[152:155], v[120:123], v[160:175]
    v_mul_f32 v23, v23, v40
    v_sin_f32 v33, v43
    v_fmac_f32 v37, v13, v10
    s_waitcnt lgkmcnt(0)
    v_mfma_f32_32x32x16_bf16 v[160:175], v[156:159], v[124:127], v[160:175]
    v_mul_f32 v28, v28, v38
    v_mul_f32 v32, v32, v42
    v_mul_f32 v29, v29, v38
    v_mul_f32 v33, v33, v42
    v_pk_mul_f32 v[50:51], v[28:29], v[28:29] op_sel:[0,0] op_sel_hi:[1,0]
    v_pk_mul_f32 v[24:25], v[22:23], v[22:23] op_sel:[0,0] op_sel_hi:[1,0]
    v_pk_fma_f32 v[50:51], v[28:29], v[28:29], v[50:51] op_sel:[1,1,0] op_sel_hi:[0,1,1] neg_lo:[1,0,0]
    v_pk_mul_f32 v[30:31], v[50:51], v[50:51] op_sel:[0,0] op_sel_hi:[1,0]
    v_pk_fma_f32 v[24:25], v[22:23], v[22:23], v[24:25] op_sel:[1,1,0] op_sel_hi:[0,1,1] neg_lo:[1,0,0]
    v_cvt_pk_bf16_f32 v70, v50, -v51
    v_pk_mul_f32 v[52:53], v[50:51], v[28:29] op_sel:[0,0] op_sel_hi:[1,0]
    v_pk_fma_f32 v[30:31], v[50:51], v[50:51], v[30:31] op_sel:[1,1,0] op_sel_hi:[0,1,1] neg_lo:[1,0,0]
    ds_write_addtid_b32 v70 offset:272
    v_pk_mul_f32 v[26:27], v[24:25], v[24:25] op_sel:[0,0] op_sel_hi:[1,0]
    v_pk_fma_f32 v[52:53], v[50:51], v[28:29], v[52:53] op_sel:[1,1,0] op_sel_hi:[0,1,1] neg_lo:[1,0,0]
    v_cvt_pk_bf16_f32 v71, v30, -v31
    v_pk_fma_f32 v[26:27], v[24:25], v[24:25], v[26:27] op_sel:[1,1,0] op_sel_hi:[0,1,1] neg_lo:[1,0,0]
    v_cvt_pk_bf16_f32 v72, v52, -v53
    ds_write_addtid_b32 v71 offset:816
    v_pk_mul_f32 v[54:55], v[28:29], v[30:31] op_sel:[0,0] op_sel_hi:[1,0]
    ds_write_addtid_b32 v72 offset:544
    v_pk_mul_f32 v[56:57], v[50:51], v[30:31] op_sel:[0,0] op_sel_hi:[1,0]
    v_pk_fma_f32 v[54:55], v[28:29], v[30:31], v[54:55] op_sel:[1,1,0] op_sel_hi:[0,1,1] neg_lo:[1,0,0]
    v_cvt_pk_bf16_f32 v73, v28, -v29
    v_pk_mul_f32 v[58:59], v[52:53], v[30:31] op_sel:[0,0] op_sel_hi:[1,0]
    v_pk_fma_f32 v[56:57], v[50:51], v[30:31], v[56:57] op_sel:[1,1,0] op_sel_hi:[0,1,1] neg_lo:[1,0,0]
    v_cvt_pk_bf16_f32 v66, v54, -v55
    ds_write_addtid_b32 v73 offset:0
    v_pk_mul_f32 v[60:61], v[30:31], v[30:31] op_sel:[0,0] op_sel_hi:[1,0]
    v_pk_fma_f32 v[58:59], v[52:53], v[30:31], v[58:59] op_sel:[1,1,0] op_sel_hi:[0,1,1] neg_lo:[1,0,0]
    v_cvt_pk_bf16_f32 v67, v56, -v57
    ds_write_addtid_b32 v66 offset:1088
    v_pk_mul_f32 v[62:63], v[54:55], v[30:31] op_sel:[0,0] op_sel_hi:[1,0]
    v_pk_fma_f32 v[60:61], v[30:31], v[30:31], v[60:61] op_sel:[1,1,0] op_sel_hi:[0,1,1] neg_lo:[1,0,0]
    v_cvt_pk_bf16_f32 v68, v58, -v59
    ds_write_addtid_b32 v67 offset:1360
    v_pk_mul_f32 v[64:65], v[56:57], v[30:31] op_sel:[0,0] op_sel_hi:[1,0]
    v_pk_fma_f32 v[62:63], v[54:55], v[30:31], v[62:63] op_sel:[1,1,0] op_sel_hi:[0,1,1] neg_lo:[1,0,0]
    v_cvt_pk_bf16_f32 v69, v60, -v61
    ds_write_addtid_b32 v68 offset:1632
    v_pk_mul_f32 v[44:45], v[58:59], v[30:31] op_sel:[0,0] op_sel_hi:[1,0]
    v_pk_fma_f32 v[64:65], v[56:57], v[30:31], v[64:65] op_sel:[1,1,0] op_sel_hi:[0,1,1] neg_lo:[1,0,0]
    v_cvt_pk_bf16_f32 v70, v62, -v63
    ds_write_addtid_b32 v69 offset:1904
    v_pk_mul_f32 v[46:47], v[60:61], v[30:31] op_sel:[0,0] op_sel_hi:[1,0]
L_wa_0:
    s_cbranch_execz L_wa_1
    s_nop 0
    v_pk_fma_f32 v[44:45], v[58:59], v[30:31], v[44:45] op_sel:[1,1,0] op_sel_hi:[0,1,1] neg_lo:[1,0,0]
    v_cvt_pk_bf16_f32 v71, v64, -v65
    ds_write_addtid_b32 v70 offset:2176
    v_pk_mul_f32 v[48:49], v[62:63], v[30:31] op_sel:[0,0] op_sel_hi:[1,0]
    v_pk_fma_f32 v[46:47], v[60:61], v[30:31], v[46:47] op_sel:[1,1,0] op_sel_hi:[0,1,1] neg_lo:[1,0,0]
    v_cvt_pk_bf16_f32 v72, v44, -v45
    ds_write_addtid_b32 v71 offset:2448
    v_pk_mul_f32 v[50:51], v[64:65], v[30:31] op_sel:[0,0] op_sel_hi:[1,0]
    v_pk_fma_f32 v[48:49], v[62:63], v[30:31], v[48:49] op_sel:[1,1,0] op_sel_hi:[0,1,1] neg_lo:[1,0,0]
    v_cvt_pk_bf16_f32 v73, v46, -v47
    ds_write_addtid_b32 v72 offset:2720
    v_pk_mul_f32 v[52:53], v[44:45], v[30:31] op_sel:[0,0] op_sel_hi:[1,0]
    v_pk_fma_f32 v[50:51], v[64:65], v[30:31], v[50:51] op_sel:[1,1,0] op_sel_hi:[0,1,1] neg_lo:[1,0,0]
    v_cvt_pk_bf16_f32 v66, v48, -v49
    ds_write_addtid_b32 v73 offset:2992
    v_pk_mul_f32 v[54:55], v[46:47], v[30:31] op_sel:[0,0] op_sel_hi:[1,0]
    v_pk_fma_f32 v[52:53], v[44:45], v[30:31], v[52:53] op_sel:[1,1,0] op_sel_hi:[0,1,1] neg_lo:[1,0,0]
    v_cvt_pk_bf16_f32 v67, v50, -v51
    ds_write_addtid_b32 v66 offset:3264
    v_pk_mul_f32 v[56:57], v[48:49], v[30:31] op_sel:[0,0] op_sel_hi:[1,0]
    v_pk_fma_f32 v[54:55], v[46:47], v[30:31], v[54:55] op_sel:[1,1,0] op_sel_hi:[0,1,1] neg_lo:[1,0,0]
    v_cvt_pk_bf16_f32 v68, v52, -v53
    ds_write_addtid_b32 v67 offset:3536
    v_pk_mul_f32 v[58:59], v[50:51], v[30:31] op_sel:[0,0] op_sel_hi:[1,0]
    v_pk_fma_f32 v[56:57], v[48:49], v[30:31], v[56:57] op_sel:[1,1,0] op_sel_hi:[0,1,1] neg_lo:[1,0,0]
    v_cvt_pk_bf16_f32 v69, v54, -v55
    ds_write_addtid_b32 v68 offset:3808
    v_pk_mul_f32 v[60:61], v[52:53], v[30:31] op_sel:[0,0] op_sel_hi:[1,0]
    v_pk_fma_f32 v[58:59], v[50:51], v[30:31], v[58:59] op_sel:[1,1,0] op_sel_hi:[0,1,1] neg_lo:[1,0,0]
    v_cvt_pk_bf16_f32 v70, v56, -v57
    ds_write_addtid_b32 v69 offset:4080
    v_pk_mul_f32 v[62:63], v[54:55], v[30:31] op_sel:[0,0] op_sel_hi:[1,0]
    v_pk_fma_f32 v[60:61], v[52:53], v[30:31], v[60:61] op_sel:[1,1,0] op_sel_hi:[0,1,1] neg_lo:[1,0,0]
    v_cvt_pk_bf16_f32 v71, v58, -v59
    ds_write_addtid_b32 v70 offset:4352
    v_pk_mul_f32 v[64:65], v[56:57], v[30:31] op_sel:[0,0] op_sel_hi:[1,0]
    v_pk_fma_f32 v[62:63], v[54:55], v[30:31], v[62:63] op_sel:[1,1,0] op_sel_hi:[0,1,1] neg_lo:[1,0,0]
    v_cvt_pk_bf16_f32 v72, v60, -v61
    ds_write_addtid_b32 v71 offset:4624
    v_pk_mul_f32 v[44:45], v[58:59], v[30:31] op_sel:[0,0] op_sel_hi:[1,0]
    v_pk_fma_f32 v[64:65], v[56:57], v[30:31], v[64:65] op_sel:[1,1,0] op_sel_hi:[0,1,1] neg_lo:[1,0,0]
    v_cvt_pk_bf16_f32 v73, v62, -v63
    ds_write_addtid_b32 v72 offset:4896
    v_pk_mul_f32 v[46:47], v[60:61], v[30:31] op_sel:[0,0] op_sel_hi:[1,0]
    v_pk_fma_f32 v[44:45], v[58:59], v[30:31], v[44:45] op_sel:[1,1,0] op_sel_hi:[0,1,1] neg_lo:[1,0,0]
    v_cvt_pk_bf16_f32 v66, v64, -v65
    ds_write_addtid_b32 v73 offset:5168
    v_pk_mul_f32 v[48:49], v[62:63], v[30:31] op_sel:[0,0] op_sel_hi:[1,0]
    v_pk_fma_f32 v[46:47], v[60:61], v[30:31], v[46:47] op_sel:[1,1,0] op_sel_hi:[0,1,1] neg_lo:[1,0,0]
    v_cvt_pk_bf16_f32 v67, v44, -v45
    ds_write_addtid_b32 v66 offset:5440
    v_pk_mul_f32 v[50:51], v[64:65], v[30:31] op_sel:[0,0] op_sel_hi:[1,0]
    v_pk_fma_f32 v[48:49], v[62:63], v[30:31], v[48:49] op_sel:[1,1,0] op_sel_hi:[0,1,1] neg_lo:[1,0,0]
    v_cvt_pk_bf16_f32 v68, v46, -v47
    ds_write_addtid_b32 v67 offset:5712
    v_pk_mul_f32 v[52:53], v[44:45], v[30:31] op_sel:[0,0] op_sel_hi:[1,0]
    v_pk_fma_f32 v[50:51], v[64:65], v[30:31], v[50:51] op_sel:[1,1,0] op_sel_hi:[0,1,1] neg_lo:[1,0,0]
    v_cvt_pk_bf16_f32 v69, v48, -v49
    ds_write_addtid_b32 v68 offset:5984
    v_pk_mul_f32 v[54:55], v[46:47], v[30:31] op_sel:[0,0] op_sel_hi:[1,0]
    v_pk_fma_f32 v[52:53], v[44:45], v[30:31], v[52:53] op_sel:[1,1,0] op_sel_hi:[0,1,1] neg_lo:[1,0,0]
    v_cvt_pk_bf16_f32 v70, v50, -v51
    ds_write_addtid_b32 v69 offset:6256
    v_pk_mul_f32 v[56:57], v[48:49], v[30:31] op_sel:[0,0] op_sel_hi:[1,0]
    v_pk_fma_f32 v[54:55], v[46:47], v[30:31], v[54:55] op_sel:[1,1,0] op_sel_hi:[0,1,1] neg_lo:[1,0,0]
    v_cvt_pk_bf16_f32 v71, v52, -v53
    ds_write_addtid_b32 v70 offset:6528
    v_pk_mul_f32 v[58:59], v[50:51], v[30:31] op_sel:[0,0] op_sel_hi:[1,0]
    v_pk_fma_f32 v[56:57], v[48:49], v[30:31], v[56:57] op_sel:[1,1,0] op_sel_hi:[0,1,1] neg_lo:[1,0,0]
    v_cvt_pk_bf16_f32 v72, v54, -v55
    ds_write_addtid_b32 v71 offset:6800
    v_pk_mul_f32 v[60:61], v[52:53], v[30:31] op_sel:[0,0] op_sel_hi:[1,0]
    v_pk_fma_f32 v[58:59], v[50:51], v[30:31], v[58:59] op_sel:[1,1,0] op_sel_hi:[0,1,1] neg_lo:[1,0,0]
    v_cvt_pk_bf16_f32 v73, v56, -v57
    ds_write_addtid_b32 v72 offset:7072
    v_pk_mul_f32 v[62:63], v[54:55], v[30:31] op_sel:[0,0] op_sel_hi:[1,0]
    v_pk_fma_f32 v[60:61], v[52:53], v[30:31], v[60:61] op_sel:[1,1,0] op_sel_hi:[0,1,1] neg_lo:[1,0,0]
    v_cvt_pk_bf16_f32 v66, v58, -v59
    ds_write_addtid_b32 v73 offset:7344
    v_pk_fma_f32 v[62:63], v[54:55], v[30:31], v[62:63] op_sel:[1,1,0] op_sel_hi:[0,1,1] neg_lo:[1,0,0]
    v_cvt_pk_bf16_f32 v67, v60, -v61
    ds_write_addtid_b32 v66 offset:7616
    v_cvt_pk_bf16_f32 v68, v62, -v63
    ds_write_addtid_b32 v67 offset:7888
    ds_write_addtid_b32 v68 offset:8160
    s_add_u32 m0, s49, 0
    s_add_u32 s39, s50, 0
    buffer_load_dwordx4 v86, s[40:43], s39 offen lds
    s_mov_b32 m0, s48
    s_add_u32 m0, s49, 8192
    s_add_u32 s39, s50, 655360
    buffer_load_dwordx4 v86, s[40:43], s39 offen lds
    s_mov_b32 m0, s48
    ds_read_b128 v[96:99], v79 offset:0
    v_pk_mul_f32 v[50:51], v[36:37], v[32:33] op_sel:[0,0] op_sel_hi:[1,0]
    v_pk_mul_f32 v[52:53], v[36:37], v[22:23] op_sel:[0,0] op_sel_hi:[1,0]
    ds_read_b128 v[100:103], v79 offset:32
    v_pk_fma_f32 v[50:51], v[36:37], v[32:33], v[50:51] op_sel:[1,1,0] op_sel_hi:[0,1,1] neg_lo:[1,0,0]
    v_pk_mul_f32 v[54:55], v[50:51], v[32:33] op_sel:[0,0] op_sel_hi:[1,0]
    ds_read_b128 v[104:107], v79 offset:64
    v_pk_fma_f32 v[52:53], v[36:37], v[22:23], v[52:53] op_sel:[1,1,0] op_sel_hi:[0,1,1] neg_lo:[1,0,0]
    v_cvt_pk_bf16_f32 v69, v50, v51
    ds_read_b128 v[108:111], v79 offset:96
    v_pk_mul_f32 v[56:57], v[36:37], v[24:25] op_sel:[0,0] op_sel_hi:[1,0]
    v_pk_fma_f32 v[54:55], v[50:51], v[32:33], v[54:55] op_sel:[1,1,0] op_sel_hi:[0,1,1] neg_lo:[1,0,0]
    v_cvt_pk_bf16_f32 v70, v52, v53
    ds_read_b128 v[112:115], v79 offset:128
    v_pk_mul_f32 v[58:59], v[54:55], v[32:33] op_sel:[0,0] op_sel_hi:[1,0]
    v_pk_fma_f32 v[56:57], v[36:37], v[24:25], v[56:57] op_sel:[1,1,0] op_sel_hi:[0,1,1] neg_lo:[1,0,0]
    ds_read_b128 v[116:119], v79 offset:160
    v_cvt_pk_bf16_f32 v71, v54, v55
    v_pk_mul_f32 v[60:61], v[52:53], v[24:25] op_sel:[0,0] op_sel_hi:[1,0]
    ds_read_b128 v[120:123], v79 offset:192
    v_pk_fma_f32 v[58:59], v[54:55], v[32:33], v[58:59] op_sel:[1,1,0] op_sel_hi:[0,1,1] neg_lo:[1,0,0]
    v_cvt_pk_bf16_f32 v72, v56, v57
    ds_read_b128 v[124:127], v79 offset:224
    v_pk_mul_f32 v[62:63], v[58:59], v[32:33] op_sel:[0,0] op_sel_hi:[1,0]
    v_pk_fma_f32 v[60:61], v[52:53], v[24:25], v[60:61] op_sel:[1,1,0] op_sel_hi:[0,1,1] neg_lo:[1,0,0]
    v_cvt_pk_bf16_f32 v73, v58, v59
    ds_write_addtid_b32 v69 offset:2176
    ds_write_addtid_b32 v69 offset:4080
    ds_write_addtid_b32 v70 offset:272
    ds_write_addtid_b32 v71 offset:4352
    ds_write_addtid_b32 v72 offset:544
    v_pk_mul_f32 v[64:65], v[36:37], v[26:27] op_sel:[0,0] op_sel_hi:[1,0]
    v_pk_fma_f32 v[62:63], v[58:59], v[32:33], v[62:63] op_sel:[1,1,0] op_sel_hi:[0,1,1] neg_lo:[1,0,0]
    v_cvt_pk_bf16_f32 v66, v60, v61
    ds_write_addtid_b32 v73 offset:5440
    v_pk_mul_f32 v[44:45], v[62:63], v[32:33] op_sel:[0,0] op_sel_hi:[1,0]
    v_pk_fma_f32 v[64:65], v[36:37], v[26:27], v[64:65] op_sel:[1,1,0] op_sel_hi:[0,1,1] neg_lo:[1,0,0]
    v_cvt_pk_bf16_f32 v67, v62, v63
    ds_write_addtid_b32 v66 offset:816
    v_pk_mul_f32 v[46:47], v[52:53], v[26:27] op_sel:[0,0] op_sel_hi:[1,0]
    v_pk_fma_f32 v[44:45], v[62:63], v[32:33], v[44:45] op_sel:[1,1,0] op_sel_hi:[0,1,1] neg_lo:[1,0,0]
    v_cvt_pk_bf16_f32 v68, v64, v65
    ds_write_addtid_b32 v67 offset:4896
    v_pk_mul_f32 v[48:49], v[44:45], v[32:33] op_sel:[0,0] op_sel_hi:[1,0]
    v_pk_fma_f32 v[46:47], v[52:53], v[26:27], v[46:47] op_sel:[1,1,0] op_sel_hi:[0,1,1] neg_lo:[1,0,0]
    v_cvt_pk_bf16_f32 v69, v44, v45
    ds_write_addtid_b32 v68 offset:1088
    v_pk_mul_f32 v[38:39], v[56:57], v[26:27] op_sel:[0,0] op_sel_hi:[1,0]
    v_pk_fma_f32 v[48:49], v[44:45], v[32:33], v[48:49] op_sel:[1,1,0] op_sel_hi:[0,1,1] neg_lo:[1,0,0]
    v_cvt_pk_bf16_f32 v70, v46, v47
    ds_write_addtid_b32 v69 offset:5984
    v_pk_mul_f32 v[40:41], v[48:49], v[32:33] op_sel:[0,0] op_sel_hi:[1,0]
    v_pk_fma_f32 v[38:39], v[56:57], v[26:27], v[38:39] op_sel:[1,1,0] op_sel_hi:[0,1,1] neg_lo:[1,0,0]
    v_cvt_pk_bf16_f32 v71, v48, v49
    ds_write_addtid_b32 v70 offset:1360
    v_pk_mul_f32 v[42:43], v[60:61], v[26:27] op_sel:[0,0] op_sel_hi:[1,0]
    v_pk_fma_f32 v[40:41], v[48:49], v[32:33], v[40:41] op_sel:[1,1,0] op_sel_hi:[0,1,1] neg_lo:[1,0,0]
    v_cvt_pk_bf16_f32 v72, v38, v39
    ds_write_addtid_b32 v71 offset:5168
    v_pk_mul_f32 v[62:63], v[40:41], v[32:33] op_sel:[0,0] op_sel_hi:[1,0]
    v_pk_fma_f32 v[42:43], v[60:61], v[26:27], v[42:43] op_sel:[1,1,0] op_sel_hi:[0,1,1] neg_lo:[1,0,0]
    v_cvt_pk_bf16_f32 v73, v40, v41
    ds_write_addtid_b32 v72 offset:1632
    v_pk_mul_f32 v[64:65], v[50:51], v[24:25] op_sel:[0,0] op_sel_hi:[1,0]
    v_pk_fma_f32 v[62:63], v[40:41], v[32:33], v[62:63] op_sel:[1,1,0] op_sel_hi:[0,1,1] neg_lo:[1,0,0]
    v_cvt_pk_bf16_f32 v66, v42, v43
    ds_write_addtid_b32 v73 offset:6256
    v_pk_mul_f32 v[52:53], v[50:51], v[26:27] op_sel:[0,0] op_sel_hi:[1,0]
    v_pk_fma_f32 v[64:65], v[50:51], v[24:25], v[64:65] op_sel:[1,1,0] op_sel_hi:[0,1,1] neg_lo:[1,0,0]
    v_cvt_pk_bf16_f32 v67, v62, v63
    ds_write_addtid_b32 v66 offset:1904
    v_pk_mul_f32 v[44:45], v[54:55], v[26:27] op_sel:[0,0] op_sel_hi:[1,0]
    v_pk_fma_f32 v[52:53], v[50:51], v[26:27], v[52:53] op_sel:[1,1,0] op_sel_hi:[0,1,1] neg_lo:[1,0,0]
    v_cvt_pk_bf16_f32 v68, v64, v65
    ds_write_addtid_b32 v67 offset:2992
    v_pk_mul_f32 v[46:47], v[64:65], v[26:27] op_sel:[0,0] op_sel_hi:[1,0]
    v_pk_fma_f32 v[44:45], v[54:55], v[26:27], v[44:45] op_sel:[1,1,0] op_sel_hi:[0,1,1] neg_lo:[1,0,0]
    v_cvt_pk_bf16_f32 v69, v52, v53
    ds_write_addtid_b32 v68 offset:2448
    v_pk_mul_f32 v[56:57], v[58:59], v[26:27] op_sel:[0,0] op_sel_hi:[1,0]
    v_pk_fma_f32 v[46:47], v[64:65], v[26:27], v[46:47] op_sel:[1,1,0] op_sel_hi:[0,1,1] neg_lo:[1,0,0]
    v_cvt_pk_bf16_f32 v70, v44, v45
    ds_write_addtid_b32 v69 offset:2720
    ds_write_addtid_b32 v69 offset:3264
    v_pk_fma_f32 v[56:57], v[58:59], v[26:27], v[56:57] op_sel:[1,1,0] op_sel_hi:[0,1,1] neg_lo:[1,0,0]
    v_cvt_pk_bf16_f32 v71, v46, v47
    ds_write_addtid_b32 v70 offset:4624
    v_cvt_pk_bf16_f32 v72, v56, v57
    ds_write_addtid_b32 v71 offset:3536
    v_cvt_pk_bf16_f32 v73, v36, v37
    ds_write_addtid_b32 v72 offset:5712
    ds_write_addtid_b32 v73 offset:0
    s_add_u32 m0, s49, 33280
    s_add_u32 s39, s50, 1310720
    buffer_load_dwordx4 v86, s[40:43], s39 offen lds
    s_mov_b32 m0, s48
    s_nop 0
    ds_read_b128 v[128:131], v76 offset:0
    ds_read_b128 v[132:135], v76 offset:32
    ds_read_b128 v[136:139], v76 offset:64
    ds_read_b128 v[140:143], v76 offset:96
    ds_read_b128 v[144:147], v76 offset:128
    ds_read_b128 v[148:151], v76 offset:160
    ds_read_b128 v[152:155], v76 offset:192
    ds_read_b128 v[156:159], v76 offset:224
    s_setprio 0
    v_mul_f32 v34, v14, v20
    v_mul_f32 v35, v15, v20
    v_mul_f32 v34, s52, v34
    v_mul_f32_e64 v35, s53, v35
    v_mul_f32 v39, 0x41000000, v35
    v_fract_f32 v41, v35
    s_waitcnt lgkmcnt(7)
    v_mfma_f32_32x32x16_bf16 v[160:175], v[128:131], v[96:99], v[160:175]
    v_mul_f32 v43, 0x43800000, v35
    v_mul_f32_e64 v16, v16, v20
    v_mul_f32 v38, 0x41000000, v34
    s_waitcnt lgkmcnt(6)
    v_mfma_f32_32x32x16_bf16 v[160:175], v[132:135], v[100:103], v[160:175]
    v_exp_f32 v40, v34
    v_mul_f32 v42, 0x43800000, v34
    v_mul_f32 v17, v17, v20
    s_waitcnt lgkmcnt(5)
    v_mfma_f32_32x32x16_bf16 v[160:175], v[136:139], v[104:107], v[160:175]
    v_fract_f32 v39, v39
    v_cos_f32 v22, v41
    v_fract_f32 v43, v43
    s_waitcnt lgkmcnt(4)
    v_mfma_f32_32x32x16_bf16 v[160:175], v[140:143], v[108:111], v[160:175]
    v_mul_f32 v36, v18, v16
    v_exp_f32 v38, v38
    v_sin_f32 v23, v41
    v_exp_f32_e64 v42, v42
    s_waitcnt lgkmcnt(3)
    v_mfma_f32_32x32x16_bf16 v[160:175], v[144:147], v[112:115], v[160:175]
    v_mul_f32 v37, v18, v17
    v_cos_f32 v28, v39
    v_mul_f32 v22, v22, v40
    s_waitcnt lgkmcnt(2)
    v_mfma_f32_32x32x16_bf16 v[160:175], v[148:151], v[116:119], v[160:175]
    v_cos_f32_e64 v32, v43
    v_fma_f32 v36, -v19, v17, v36
    v_sin_f32 v29, v39
    s_waitcnt lgkmcnt(1)
    v_mfma_f32_32x32x16_bf16 v[160:175], v[152:155], v[120:123], v[160:175]
    v_mul_f32 v23, v23, v40
    v_sin_f32 v33, v43
    v_fmac_f32 v37, v19, v16
    s_waitcnt lgkmcnt(0)
    v_mfma_f32_32x32x16_bf16 v[160:175], v[156:159], v[124:127], v[160:175]
    v_mul_f32 v28, v28, v38
    v_mul_f32 v32, v32, v42
    v_mul_f32 v29, v29, v38
    v_mul_f32 v33, v33, v42
    v_pk_mul_f32 v[50:51], v[28:29], v[28:29] op_sel:[0,0] op_sel_hi:[1,0]
    v_pk_mul_f32 v[24:25], v[22:23], v[22:23] op_sel:[0,0] op_sel_hi:[1,0]
    v_pk_fma_f32 v[50:51], v[28:29], v[28:29], v[50:51] op_sel:[1,1,0] op_sel_hi:[0,1,1] neg_lo:[1,0,0]
    v_pk_mul_f32 v[30:31], v[50:51], v[50:51] op_sel:[0,0] op_sel_hi:[1,0]
    v_pk_fma_f32 v[24:25], v[22:23], v[22:23], v[24:25] op_sel:[1,1,0] op_sel_hi:[0,1,1] neg_lo:[1,0,0]
    v_cvt_pk_bf16_f32 v66, v50, -v51
    v_pk_mul_f32 v[52:53], v[50:51], v[28:29] op_sel:[0,0] op_sel_hi:[1,0]
    v_pk_fma_f32 v[30:31], v[50:51], v[50:51], v[30:31] op_sel:[1,1,0] op_sel_hi:[0,1,1] neg_lo:[1,0,0]
    ds_write_addtid_b32 v66 offset:272
    v_pk_mul_f32 v[26:27], v[24:25], v[24:25] op_sel:[0,0] op_sel_hi:[1,0]
    v_pk_fma_f32 v[52:53], v[50:51], v[28:29], v[52:53] op_sel:[1,1,0] op_sel_hi:[0,1,1] neg_lo:[1,0,0]
    v_cvt_pk_bf16_f32 v67, v30, -v31
    v_pk_fma_f32 v[26:27], v[24:25], v[24:25], v[26:27] op_sel:[1,1,0] op_sel_hi:[0,1,1] neg_lo:[1,0,0]
    v_cvt_pk_bf16_f32 v68, v52, -v53
    ds_write_addtid_b32 v67 offset:816
    v_pk_mul_f32 v[54:55], v[28:29], v[30:31] op_sel:[0,0] op_sel_hi:[1,0]
    ds_write_addtid_b32 v68 offset:544
    v_pk_mul_f32 v[56:57], v[50:51], v[30:31] op_sel:[0,0] op_sel_hi:[1,0]
    v_pk_fma_f32 v[54:55], v[28:29], v[30:31], v[54:55] op_sel:[1,1,0] op_sel_hi:[0,1,1] neg_lo:[1,0,0]
    v_cvt_pk_bf16_f32 v69, v28, -v29
    v_pk_mul_f32 v[58:59], v[52:53], v[30:31] op_sel:[0,0] op_sel_hi:[1,0]
    v_pk_fma_f32 v[56:57], v[50:51], v[30:31], v[56:57] op_sel:[1,1,0] op_sel_hi:[0,1,1] neg_lo:[1,0,0]
    v_cvt_pk_bf16_f32 v70, v54, -v55
    ds_write_addtid_b32 v69 offset:0
    v_pk_mul_f32 v[60:61], v[30:31], v[30:31] op_sel:[0,0] op_sel_hi:[1,0]
    v_pk_fma_f32 v[58:59], v[52:53], v[30:31], v[58:59] op_sel:[1,1,0] op_sel_hi:[0,1,1] neg_lo:[1,0,0]
    v_cvt_pk_bf16_f32 v71, v56, -v57
    ds_write_addtid_b32 v70 offset:1088
    v_pk_mul_f32 v[62:63], v[54:55], v[30:31] op_sel:[0,0] op_sel_hi:[1,0]
    v_pk_fma_f32 v[60:61], v[30:31], v[30:31], v[60:61] op_sel:[1,1,0] op_sel_hi:[0,1,1] neg_lo:[1,0,0]
    v_cvt_pk_bf16_f32 v72, v58, -v59
    ds_write_addtid_b32 v71 offset:1360
    v_pk_mul_f32 v[64:65], v[56:57], v[30:31] op_sel:[0,0] op_sel_hi:[1,0]
    v_pk_fma_f32 v[62:63], v[54:55], v[30:31], v[62:63] op_sel:[1,1,0] op_sel_hi:[0,1,1] neg_lo:[1,0,0]
    v_cvt_pk_bf16_f32 v73, v60, -v61
    ds_write_addtid_b32 v72 offset:1632
    v_pk_mul_f32 v[44:45], v[58:59], v[30:31] op_sel:[0,0] op_sel_hi:[1,0]
    v_pk_fma_f32 v[64:65], v[56:57], v[30:31], v[64:65] op_sel:[1,1,0] op_sel_hi:[0,1,1] neg_lo:[1,0,0]
    v_cvt_pk_bf16_f32 v66, v62, -v63
    ds_write_addtid_b32 v73 offset:1904
    v_pk_mul_f32 v[46:47], v[60:61], v[30:31] op_sel:[0,0] op_sel_hi:[1,0]
    v_pk_fma_f32 v[44:45], v[58:59], v[30:31], v[44:45] op_sel:[1,1,0] op_sel_hi:[0,1,1] neg_lo:[1,0,0]
    v_cvt_pk_bf16_f32 v67, v64, -v65
    ds_write_addtid_b32 v66 offset:2176
    v_pk_mul_f32 v[48:49], v[62:63], v[30:31] op_sel:[0,0] op_sel_hi:[1,0]
    v_pk_fma_f32 v[46:47], v[60:61], v[30:31], v[46:47] op_sel:[1,1,0] op_sel_hi:[0,1,1] neg_lo:[1,0,0]
    v_cvt_pk_bf16_f32 v68, v44, -v45
    ds_write_addtid_b32 v67 offset:2448
    v_pk_mul_f32 v[50:51], v[64:65], v[30:31] op_sel:[0,0] op_sel_hi:[1,0]
    v_pk_fma_f32 v[48:49], v[62:63], v[30:31], v[48:49] op_sel:[1,1,0] op_sel_hi:[0,1,1] neg_lo:[1,0,0]
    v_cvt_pk_bf16_f32 v69, v46, -v47
    ds_write_addtid_b32 v68 offset:2720
    v_pk_mul_f32 v[52:53], v[44:45], v[30:31] op_sel:[0,0] op_sel_hi:[1,0]
    v_pk_fma_f32 v[50:51], v[64:65], v[30:31], v[50:51] op_sel:[1,1,0] op_sel_hi:[0,1,1] neg_lo:[1,0,0]
    v_cvt_pk_bf16_f32 v70, v48, -v49
    ds_write_addtid_b32 v69 offset:2992
    v_pk_mul_f32 v[54:55], v[46:47], v[30:31] op_sel:[0,0] op_sel_hi:[1,0]
    v_pk_fma_f32 v[52:53], v[44:45], v[30:31], v[52:53] op_sel:[1,1,0] op_sel_hi:[0,1,1] neg_lo:[1,0,0]
    v_cvt_pk_bf16_f32 v71, v50, -v51
    ds_write_addtid_b32 v70 offset:3264
    v_pk_mul_f32 v[56:57], v[48:49], v[30:31] op_sel:[0,0] op_sel_hi:[1,0]
    v_pk_fma_f32 v[54:55], v[46:47], v[30:31], v[54:55] op_sel:[1,1,0] op_sel_hi:[0,1,1] neg_lo:[1,0,0]
    v_cvt_pk_bf16_f32 v72, v52, -v53
    ds_write_addtid_b32 v71 offset:3536
    v_pk_mul_f32 v[58:59], v[50:51], v[30:31] op_sel:[0,0] op_sel_hi:[1,0]
    v_pk_fma_f32 v[56:57], v[48:49], v[30:31], v[56:57] op_sel:[1,1,0] op_sel_hi:[0,1,1] neg_lo:[1,0,0]
    v_cvt_pk_bf16_f32 v73, v54, -v55
    ds_write_addtid_b32 v72 offset:3808
    v_pk_mul_f32 v[60:61], v[52:53], v[30:31] op_sel:[0,0] op_sel_hi:[1,0]
    v_pk_fma_f32 v[58:59], v[50:51], v[30:31], v[58:59] op_sel:[1,1,0] op_sel_hi:[0,1,1] neg_lo:[1,0,0]
    v_cvt_pk_bf16_f32 v66, v56, -v57
    ds_write_addtid_b32 v73 offset:4080
    v_pk_mul_f32 v[62:63], v[54:55], v[30:31] op_sel:[0,0] op_sel_hi:[1,0]
    v_pk_fma_f32 v[60:61], v[52:53], v[30:31], v[60:61] op_sel:[1,1,0] op_sel_hi:[0,1,1] neg_lo:[1,0,0]
    v_cvt_pk_bf16_f32 v67, v58, -v59
    ds_write_addtid_b32 v66 offset:4352
    v_pk_mul_f32 v[64:65], v[56:57], v[30:31] op_sel:[0,0] op_sel_hi:[1,0]
    v_pk_fma_f32 v[62:63], v[54:55], v[30:31], v[62:63] op_sel:[1,1,0] op_sel_hi:[0,1,1] neg_lo:[1,0,0]
    v_cvt_pk_bf16_f32 v68, v60, -v61
    ds_write_addtid_b32 v67 offset:4624
    v_pk_mul_f32 v[44:45], v[58:59], v[30:31] op_sel:[0,0] op_sel_hi:[1,0]
    v_pk_fma_f32 v[64:65], v[56:57], v[30:31], v[64:65] op_sel:[1,1,0] op_sel_hi:[0,1,1] neg_lo:[1,0,0]
    v_cvt_pk_bf16_f32 v69, v62, -v63
    ds_write_addtid_b32 v68 offset:4896
    v_pk_mul_f32 v[46:47], v[60:61], v[30:31] op_sel:[0,0] op_sel_hi:[1,0]
    v_pk_fma_f32 v[44:45], v[58:59], v[30:31], v[44:45] op_sel:[1,1,0] op_sel_hi:[0,1,1] neg_lo:[1,0,0]
    v_cvt_pk_bf16_f32 v70, v64, -v65
    ds_write_addtid_b32 v69 offset:5168
    v_pk_mul_f32 v[48:49], v[62:63], v[30:31] op_sel:[0,0] op_sel_hi:[1,0]
    v_pk_fma_f32 v[46:47], v[60:61], v[30:31], v[46:47] op_sel:[1,1,0] op_sel_hi:[0,1,1] neg_lo:[1,0,0]
    v_cvt_pk_bf16_f32 v71, v44, -v45
    ds_write_addtid_b32 v70 offset:5440
    v_pk_mul_f32 v[50:51], v[64:65], v[30:31] op_sel:[0,0] op_sel_hi:[1,0]
    v_pk_fma_f32 v[48:49], v[62:63], v[30:31], v[48:49] op_sel:[1,1,0] op_sel_hi:[0,1,1] neg_lo:[1,0,0]
    v_cvt_pk_bf16_f32 v72, v46, -v47
    ds_write_addtid_b32 v71 offset:5712
    v_pk_mul_f32 v[52:53], v[44:45], v[30:31] op_sel:[0,0] op_sel_hi:[1,0]
    v_pk_fma_f32 v[50:51], v[64:65], v[30:31], v[50:51] op_sel:[1,1,0] op_sel_hi:[0,1,1] neg_lo:[1,0,0]
    v_cvt_pk_bf16_f32 v73, v48, -v49
    ds_write_addtid_b32 v72 offset:5984
    v_pk_mul_f32 v[54:55], v[46:47], v[30:31] op_sel:[0,0] op_sel_hi:[1,0]
    v_pk_fma_f32 v[52:53], v[44:45], v[30:31], v[52:53] op_sel:[1,1,0] op_sel_hi:[0,1,1] neg_lo:[1,0,0]
    v_cvt_pk_bf16_f32 v66, v50, -v51
    ds_write_addtid_b32 v73 offset:6256
    v_pk_mul_f32 v[56:57], v[48:49], v[30:31] op_sel:[0,0] op_sel_hi:[1,0]
    v_pk_fma_f32 v[54:55], v[46:47], v[30:31], v[54:55] op_sel:[1,1,0] op_sel_hi:[0,1,1] neg_lo:[1,0,0]
    v_cvt_pk_bf16_f32 v67, v52, -v53
    ds_write_addtid_b32 v66 offset:6528
    v_pk_mul_f32 v[58:59], v[50:51], v[30:31] op_sel:[0,0] op_sel_hi:[1,0]
    v_pk_fma_f32 v[56:57], v[48:49], v[30:31], v[56:57] op_sel:[1,1,0] op_sel_hi:[0,1,1] neg_lo:[1,0,0]
    v_cvt_pk_bf16_f32 v68, v54, -v55
    ds_write_addtid_b32 v67 offset:6800
    v_pk_mul_f32 v[60:61], v[52:53], v[30:31] op_sel:[0,0] op_sel_hi:[1,0]
    v_pk_fma_f32 v[58:59], v[50:51], v[30:31], v[58:59] op_sel:[1,1,0] op_sel_hi:[0,1,1] neg_lo:[1,0,0]
    v_cvt_pk_bf16_f32 v69, v56, -v57
    ds_write_addtid_b32 v68 offset:7072
    v_pk_mul_f32 v[62:63], v[54:55], v[30:31] op_sel:[0,0] op_sel_hi:[1,0]
    v_pk_fma_f32 v[60:61], v[52:53], v[30:31], v[60:61] op_sel:[1,1,0] op_sel_hi:[0,1,1] neg_lo:[1,0,0]
    v_cvt_pk_bf16_f32 v70, v58, -v59
    ds_write_addtid_b32 v69 offset:7344
    v_pk_fma_f32 v[62:63], v[54:55], v[30:31], v[62:63] op_sel:[1,1,0] op_sel_hi:[0,1,1] neg_lo:[1,0,0]
    v_cvt_pk_bf16_f32 v71, v60, -v61
    ds_write_addtid_b32 v70 offset:7616
    v_cvt_pk_bf16_f32 v72, v62, -v63
    ds_write_addtid_b32 v71 offset:7888
    ds_write_addtid_b32 v72 offset:8160
    s_add_u32 m0, s49, 41472
    s_add_u32 s39, s50, 1966080
    buffer_load_dwordx4 v86, s[40:43], s39 offen lds
    s_mov_b32 m0, s48
    s_nop 0
    ds_read_b128 v[96:99], v79 offset:0
    v_pk_mul_f32 v[50:51], v[36:37], v[32:33] op_sel:[0,0] op_sel_hi:[1,0]
    v_pk_mul_f32 v[52:53], v[36:37], v[22:23] op_sel:[0,0] op_sel_hi:[1,0]
    ds_read_b128 v[100:103], v79 offset:32
    v_pk_fma_f32 v[50:51], v[36:37], v[32:33], v[50:51] op_sel:[1,1,0] op_sel_hi:[0,1,1] neg_lo:[1,0,0]
    v_pk_mul_f32 v[54:55], v[50:51], v[32:33] op_sel:[0,0] op_sel_hi:[1,0]
    ds_read_b128 v[104:107], v79 offset:64
    v_pk_fma_f32 v[52:53], v[36:37], v[22:23], v[52:53] op_sel:[1,1,0] op_sel_hi:[0,1,1] neg_lo:[1,0,0]
    v_cvt_pk_bf16_f32 v73, v50, v51
    ds_read_b128 v[108:111], v79 offset:96
    v_pk_mul_f32 v[56:57], v[36:37], v[24:25] op_sel:[0,0] op_sel_hi:[1,0]
    s_waitcnt vmcnt(2)
    s_nop 0
    v_pk_fma_f32 v[54:55], v[50:51], v[32:33], v[54:55] op_sel:[1,1,0] op_sel_hi:[0,1,1] neg_lo:[1,0,0]
    v_cvt_pk_bf16_f32 v66, v52, v53
    ds_read_b128 v[112:115], v79 offset:128
    v_pk_mul_f32 v[58:59], v[54:55], v[32:33] op_sel:[0,0] op_sel_hi:[1,0]
    v_pk_fma_f32 v[56:57], v[36:37], v[24:25], v[56:57] op_sel:[1,1,0] op_sel_hi:[0,1,1] neg_lo:[1,0,0]
    ds_read_b128 v[116:119], v79 offset:160
    v_cvt_pk_bf16_f32 v67, v54, v55
    v_pk_mul_f32 v[60:61], v[52:53], v[24:25] op_sel:[0,0] op_sel_hi:[1,0]
    ds_read_b128 v[120:123], v79 offset:192
    v_pk_fma_f32 v[58:59], v[54:55], v[32:33], v[58:59] op_sel:[1,1,0] op_sel_hi:[0,1,1] neg_lo:[1,0,0]
    ds_read_b64_tr_b16 v[176:177], v84 offset:0
    v_cvt_pk_bf16_f32 v68, v56, v57
    ds_read_b128 v[124:127], v79 offset:224
    v_pk_mul_f32 v[62:63], v[58:59], v[32:33] op_sel:[0,0] op_sel_hi:[1,0]
    v_pk_fma_f32 v[60:61], v[52:53], v[24:25], v[60:61] op_sel:[1,1,0] op_sel_hi:[0,1,1] neg_lo:[1,0,0]
    v_cvt_pk_bf16_f32 v69, v58, v59
    ds_write_addtid_b32 v73 offset:2176
    ds_write_addtid_b32 v73 offset:4080
    ds_write_addtid_b32 v66 offset:272
    ds_write_addtid_b32 v67 offset:4352
    ds_write_addtid_b32 v68 offset:544
    ds_read_b64_tr_b16 v[178:179], v84 offset:512
    v_pk_mul_f32 v[64:65], v[36:37], v[26:27] op_sel:[0,0] op_sel_hi:[1,0]
    v_pk_fma_f32 v[62:63], v[58:59], v[32:33], v[62:63] op_sel:[1,1,0] op_sel_hi:[0,1,1] neg_lo:[1,0,0]
    v_cvt_pk_bf16_f32 v70, v60, v61
    ds_write_addtid_b32 v69 offset:5440
    v_pk_mul_f32 v[44:45], v[62:63], v[32:33] op_sel:[0,0] op_sel_hi:[1,0]
    v_pk_fma_f32 v[64:65], v[36:37], v[26:27], v[64:65] op_sel:[1,1,0] op_sel_hi:[0,1,1] neg_lo:[1,0,0]
    v_cvt_pk_bf16_f32 v71, v62, v63
    ds_write_addtid_b32 v70 offset:816
    v_pk_mul_f32 v[46:47], v[52:53], v[26:27] op_sel:[0,0] op_sel_hi:[1,0]
    v_pk_fma_f32 v[44:45], v[62:63], v[32:33], v[44:45] op_sel:[1,1,0] op_sel_hi:[0,1,1] neg_lo:[1,0,0]
    ds_read_b64_tr_b16 v[180:181], v84 offset:8192
    v_cvt_pk_bf16_f32 v72, v64, v65
    ds_write_addtid_b32 v71 offset:4896
    v_pk_mul_f32 v[48:49], v[44:45], v[32:33] op_sel:[0,0] op_sel_hi:[1,0]
    v_pk_fma_f32 v[46:47], v[52:53], v[26:27], v[46:47] op_sel:[1,1,0] op_sel_hi:[0,1,1] neg_lo:[1,0,0]
    v_cvt_pk_bf16_f32 v73, v44, v45
    ds_write_addtid_b32 v72 offset:1088
    v_pk_mul_f32 v[38:39], v[56:57], v[26:27] op_sel:[0,0] op_sel_hi:[1,0]
    v_pk_fma_f32 v[48:49], v[44:45], v[32:33], v[48:49] op_sel:[1,1,0] op_sel_hi:[0,1,1] neg_lo:[1,0,0]
    v_cvt_pk_bf16_f32 v66, v46, v47
    ds_write_addtid_b32 v73 offset:5984
    v_pk_mul_f32 v[40:41], v[48:49], v[32:33] op_sel:[0,0] op_sel_hi:[1,0]
    ds_read_b64_tr_b16 v[182:183], v84 offset:8704
    v_pk_fma_f32 v[38:39], v[56:57], v[26:27], v[38:39] op_sel:[1,1,0] op_sel_hi:[0,1,1] neg_lo:[1,0,0]
    v_cvt_pk_bf16_f32 v67, v48, v49
    ds_write_addtid_b32 v66 offset:1360
    v_pk_mul_f32 v[42:43], v[60:61], v[26:27] op_sel:[0,0] op_sel_hi:[1,0]
    v_pk_fma_f32 v[40:41], v[48:49], v[32:33], v[40:41] op_sel:[1,1,0] op_sel_hi:[0,1,1] neg_lo:[1,0,0]
    v_cvt_pk_bf16_f32 v68, v38, v39
    ds_write_addtid_b32 v67 offset:5168
    v_pk_mul_f32 v[62:63], v[40:41], v[32:33] op_sel:[0,0] op_sel_hi:[1,0]
    v_pk_fma_f32 v[42:43], v[60:61], v[26:27], v[42:43] op_sel:[1,1,0] op_sel_hi:[0,1,1] neg_lo:[1,0,0]
    v_cvt_pk_bf16_f32 v69, v40, v41
    s_waitcnt lgkmcnt(15)
    s_nop 0
    ds_write_b64 v85, v[176:177] offset:0
    ds_write_addtid_b32 v68 offset:1632
    v_pk_mul_f32 v[64:65], v[50:51], v[24:25] op_sel:[0,0] op_sel_hi:[1,0]
    v_pk_fma_f32 v[62:63], v[40:41], v[32:33], v[62:63] op_sel:[1,1,0] op_sel_hi:[0,1,1] neg_lo:[1,0,0]
    v_cvt_pk_bf16_f32 v70, v42, v43
    ds_write_addtid_b32 v69 offset:6256
    v_pk_mul_f32 v[52:53], v[50:51], v[26:27] op_sel:[0,0] op_sel_hi:[1,0]
    v_pk_fma_f32 v[64:65], v[50:51], v[24:25], v[64:65] op_sel:[1,1,0] op_sel_hi:[0,1,1] neg_lo:[1,0,0]
    v_cvt_pk_bf16_f32 v71, v62, v63
    ds_write_addtid_b32 v70 offset:1904
    v_pk_mul_f32 v[44:45], v[54:55], v[26:27] op_sel:[0,0] op_sel_hi:[1,0]
    s_waitcnt lgkmcnt(13)
    s_nop 0
    ds_write_b64 v85, v[178:179] offset:64
    v_pk_fma_f32 v[52:53], v[50:51], v[26:27], v[52:53] op_sel:[1,1,0] op_sel_hi:[0,1,1] neg_lo:[1,0,0]
    v_cvt_pk_bf16_f32 v72, v64, v65
    ds_write_addtid_b32 v71 offset:2992
    v_pk_mul_f32 v[46:47], v[64:65], v[26:27] op_sel:[0,0] op_sel_hi:[1,0]
    v_pk_fma_f32 v[44:45], v[54:55], v[26:27], v[44:45] op_sel:[1,1,0] op_sel_hi:[0,1,1] neg_lo:[1,0,0]
    v_cvt_pk_bf16_f32 v73, v52, v53
    ds_write_addtid_b32 v72 offset:2448
    v_pk_mul_f32 v[56:57], v[58:59], v[26:27] op_sel:[0,0] op_sel_hi:[1,0]
    v_pk_fma_f32 v[46:47], v[64:65], v[26:27], v[46:47] op_sel:[1,1,0] op_sel_hi:[0,1,1] neg_lo:[1,0,0]
    v_cvt_pk_bf16_f32 v66, v44, v45
    s_waitcnt lgkmcnt(13)
    s_nop 0
    ds_write_b64 v85, v[180:181] offset:1024
    ds_write_addtid_b32 v73 offset:2720
    ds_write_addtid_b32 v73 offset:3264
    v_pk_fma_f32 v[56:57], v[58:59], v[26:27], v[56:57] op_sel:[1,1,0] op_sel_hi:[0,1,1] neg_lo:[1,0,0]
    v_cvt_pk_bf16_f32 v67, v46, v47
    ds_write_addtid_b32 v66 offset:4624
    v_cvt_pk_bf16_f32 v68, v56, v57
    ds_write_addtid_b32 v67 offset:3536
    v_cvt_pk_bf16_f32 v69, v36, v37
    ds_write_addtid_b32 v68 offset:5712
    ds_write_addtid_b32 v69 offset:0
    s_waitcnt lgkmcnt(15)
    s_nop 0
    ds_write_b64 v85, v[182:183] offset:1088
    ds_read_b128 v[128:131], v76 offset:0
    ds_read_b128 v[132:135], v76 offset:32
    ds_read_b128 v[136:139], v76 offset:64
    ds_read_b128 v[140:143], v76 offset:96
    ds_read_b128 v[144:147], v76 offset:128
    ds_read_b128 v[148:151], v76 offset:160
    ds_read_b128 v[152:155], v76 offset:192
    ds_read_b128 v[156:159], v76 offset:224
    s_waitcnt lgkmcnt(7)
    v_mfma_f32_32x32x16_bf16 v[160:175], v[128:131], v[96:99], v[160:175]
    s_waitcnt lgkmcnt(0)
    s_barrier
    ds_read_b64_tr_b16 v[176:177], v80 offset:0
    v_mfma_f32_32x32x16_bf16 v[160:175], v[132:135], v[100:103], v[160:175]
    ds_read_b64_tr_b16 v[178:179], v80 offset:128
    ds_read_b64_tr_b16 v[180:181], v80 offset:256
    v_mfma_f32_32x32x16_bf16 v[160:175], v[136:139], v[104:107], v[160:175]
    ds_read_b64_tr_b16 v[182:183], v80 offset:384
    ds_read_b64_tr_b16 v[184:185], v80 offset:512
    v_mfma_f32_32x32x16_bf16 v[160:175], v[140:143], v[108:111], v[160:175]
    ds_read_b64_tr_b16 v[186:187], v80 offset:640
    ds_read_b64_tr_b16 v[188:189], v80 offset:768
    ds_read_b64_tr_b16 v[190:191], v80 offset:896
    v_mfma_f32_32x32x16_bf16 v[160:175], v[144:147], v[112:115], v[160:175]
    ds_read_b64_tr_b16 v[192:193], v80 offset:1024
    ds_read_b64_tr_b16 v[194:195], v80 offset:1152
    v_mfma_f32_32x32x16_bf16 v[160:175], v[148:151], v[116:119], v[160:175]
    ds_read_b64_tr_b16 v[196:197], v80 offset:1280
    ds_read_b64_tr_b16 v[198:199], v80 offset:1408
    v_mfma_f32_32x32x16_bf16 v[160:175], v[152:155], v[120:123], v[160:175]
    ds_read_b64_tr_b16 v[200:201], v80 offset:1536
    ds_read_b64_tr_b16 v[202:203], v80 offset:1664
    v_mfma_f32_32x32x16_bf16 v[160:175], v[156:159], v[124:127], v[160:175]
    ds_read_b64_tr_b16 v[204:205], v80 offset:1792
    ds_read_b64_tr_b16 v[206:207], v80 offset:1920
    ds_read_b64_tr_b16 v[208:209], v80 offset:2048
    v_and_b32 v2, 7, v0
    v_lshl_add_u32 v2, v2, 2, s48
    v_mov_b32_e64 v3, 0
    ds_write_b32 v2, v3
    v_and_b32 v4, 1, v0
    v_cmp_eq_u32 vcc, 0, v4
    s_mov_b64 s[58:59], 1
    v_mov_b32 v60, 0
    v_mov_b32 v61, 0
    v_mov_b32 v62, 0
    v_mov_b32_e64 v63, 0
    v_cvt_pk_bf16_f32 v6, v160, v161
    v_cvt_pk_bf16_f32 v7, v162, v163
    ds_write_b64 v77, v[6:7] offset:32
    v_cndmask_b32 v172, v167, v168, s[58:59]
    v_cndmask_b32 v173, v168, v170, s[58:59]
    v_cndmask_b32 v174, v170, v171, s[58:59]
L_wa_1:
    s_cbranch_execz L_wa_2
    s_nop 0
    v_cndmask_b32 v175, v171, v167, s[58:59]
    v_mov_b32_dpp v166, v172 wave_rol:1 row_mask:0xc bank_mask:0xf
    v_mov_b32_dpp v161, v173 wave_rol:1 row_mask:0xf bank_mask:0xf
    v_mov_b32_dpp v162, v174 wave_rol:1 row_mask:0xf bank_mask:0xf
    v_mov_b32_dpp v163, v175 wave_rol:1 row_mask:0xf bank_mask:0xf
    v_cvt_pk_bf16_f32 v8, v164, v164
    v_cvt_pk_bf16_f32 v9, v165, v166
    ds_write_b64 v77, v[8:9] offset:544
    ds_read_b64_tr_b16 v[96:97], v81 offset:128
    ds_read_b64_tr_b16 v[98:99], v81 offset:0
    ds_read_b64_tr_b16 v[100:101], v81 offset:384
    ds_read_b64_tr_b16 v[102:103], v81 offset:256
    v_cvt_pk_bf16_f32 v10, v168, v168
    v_cvt_pk_bf16_f32 v11, v168, v169
    v_cvt_pk_bf16_f32 v12, v169, v169
    v_cvt_pk_bf16_f32 v13, v161, v161
    ds_write_b128 v78, v[10:13] offset:1056
    v_cndmask_b32_e64 v5, v162, v170, vcc
    v_cvt_pk_bf16_f32 v14, v170, v170
    v_cvt_pk_bf16_f32 v15, v170, v170
    v_cvt_pk_bf16_f32 v16, v5, v162
    v_cvt_pk_bf16_f32 v17, v162, v162
    ds_write_b128 v78, v[14:17] offset:2080
    v_cndmask_b32_e64 v5, v163, v171, vcc
    v_cvt_pk_bf16_f32 v18, v171, v171
    v_cvt_pk_bf16_f32 v19, v171, v171
    v_cvt_pk_bf16_f32 v20, v5, v163
    v_cvt_pk_bf16_f32 v21, v163, v163
    ds_write_b128 v78, v[18:21] offset:3104
    ds_read_b64_tr_b16 v[156:157], v81 offset:3968
    ds_read_b64_tr_b16 v[158:159], v81 offset:3840
    ds_read_b64_tr_b16 v[152:153], v81 offset:3712
    ds_read_b64_tr_b16 v[154:155], v81 offset:3584
    ds_read_b64_tr_b16 v[148:149], v81 offset:3456
    ds_read_b64_tr_b16 v[150:151], v81 offset:3328
    ds_read_b64_tr_b16 v[144:145], v81 offset:3200
    ds_read_b64_tr_b16 v[146:147], v81 offset:3072
    ds_read_b64_tr_b16 v[140:141], v81 offset:2944
    ds_read_b64_tr_b16 v[142:143], v81 offset:2816
    ds_read_b64_tr_b16 v[136:137], v81 offset:2688
    ds_read_b64_tr_b16 v[138:139], v81 offset:2560
    s_and_b32 s54, s3, 1
    s_waitcnt lgkmcnt(15)
    v_mfma_f32_16x16x32_bf16 v[40:43], v[176:179], v[96:99], 0
    v_mfma_f32_16x16x32_bf16 v[44:47], v[178:181], v[96:99], 0
    s_waitcnt lgkmcnt(10)
    v_mfma_f32_16x16x32_bf16 v[168:171], v[176:179], v[156:159], 0
    v_mfma_f32_16x16x32_bf16 v[172:175], v[178:181], v[156:159], 0
    s_waitcnt lgkmcnt(8)
    v_mfma_f32_16x16x32_bf16 v[168:171], v[180:183], v[152:155], v[168:171]
    v_mfma_f32_16x16x32_bf16 v[172:175], v[182:185], v[152:155], v[172:175]
    s_waitcnt lgkmcnt(6)
    v_mfma_f32_16x16x32_bf16 v[168:171], v[184:187], v[148:151], v[168:171]
    ds_read_b64_tr_b16 v[132:133], v81 offset:2432
    v_mfma_f32_16x16x32_bf16 v[172:175], v[186:189], v[148:151], v[172:175]
    s_waitcnt lgkmcnt(5)
    v_mfma_f32_16x16x32_bf16 v[168:171], v[188:191], v[144:147], v[168:171]
    ds_read_b64_tr_b16 v[134:135], v81 offset:2304
    v_mfma_f32_16x16x32_bf16 v[172:175], v[190:193], v[144:147], v[172:175]
    s_waitcnt lgkmcnt(4)
    v_mfma_f32_16x16x32_bf16 v[168:171], v[192:195], v[140:143], v[168:171]
    v_mfma_f32_16x16x32_bf16 v[172:175], v[194:197], v[140:143], v[172:175]
    ds_read_b64_tr_b16 v[128:129], v81 offset:2176
    s_waitcnt lgkmcnt(3)
    v_mfma_f32_16x16x32_bf16 v[168:171], v[196:199], v[136:139], v[168:171]
    v_mfma_f32_16x16x32_bf16 v[172:175], v[198:201], v[136:139], v[172:175]
    ds_read_b64_tr_b16 v[130:131], v81 offset:2048
    v_mfma_f32_16x16x32_bf16 v[48:51], v[176:179], v[100:103], 0
    v_mfma_f32_16x16x32_bf16 v[52:55], v[178:181], v[100:103], 0
    v_mfma_f32_16x16x32_bf16 v[48:51], v[180:183], v[96:99], v[48:51]
    v_mfma_f32_16x16x32_bf16 v[52:55], v[182:185], v[96:99], v[52:55]
    s_waitcnt lgkmcnt(2)
    v_mfma_f32_16x16x32_bf16 v[168:171], v[200:203], v[132:135], v[168:171]
    ds_read_b64_tr_b16 v[104:105], v81 offset:640
    v_mfma_f32_16x16x32_bf16 v[172:175], v[202:205], v[132:135], v[172:175]
    ds_read_b64_tr_b16 v[106:107], v81 offset:512
    v_cndmask_b32 v24, v43, v63, s[56:57]
    s_waitcnt lgkmcnt(2)
    v_mfma_f32_16x16x32_bf16 v[168:171], v[204:207], v[128:131], v[168:171]
    v_cndmask_b32 v25, v47, v43, s[56:57]
    v_add_f32_dpp v42, v24, v42 wave_ror:1 row_mask:0xf bank_mask:0xf
    v_mfma_f32_16x16x32_bf16 v[172:175], v[206:209], v[128:131], v[172:175]
    v_add_f32_dpp v46, v25, v46 wave_ror:1 row_mask:0xf bank_mask:0xf
    v_mfma_f32_16x16x32_bf16 v[160:163], v[176:179], v[152:155], 0
    v_cndmask_b32 v22, v42, v62, s[56:57]
    v_cndmask_b32 v23, v46, v42, s[56:57]
    v_mfma_f32_16x16x32_bf16 v[164:167], v[178:181], v[152:155], 0
    v_add_f32_dpp v41, v22, v41 wave_ror:1 row_mask:0xf bank_mask:0xf
    v_add_f32_dpp v45, v23, v45 wave_ror:1 row_mask:0xf bank_mask:0xf
    v_mfma_f32_16x16x32_bf16 v[160:163], v[180:183], v[148:151], v[160:163]
    v_cndmask_b32 v24, v41, v61, s[56:57]
    v_mfma_f32_16x16x32_bf16 v[164:167], v[182:185], v[148:151], v[164:167]
    v_cndmask_b32 v25, v45, v41, s[56:57]
    v_add_f32_dpp v40, v24, v40 wave_ror:1 row_mask:0xf bank_mask:0xf
    v_mfma_f32_16x16x32_bf16 v[160:163], v[184:187], v[144:147], v[160:163]
    v_add_f32_dpp v44, v25, v44 wave_ror:1 row_mask:0xf bank_mask:0xf
    v_cvt_pk_bf16_f32 v26, v40, v44
    v_mfma_f32_16x16x32_bf16 v[164:167], v[186:189], v[144:147], v[164:167]
    ds_write_b16 v82, v26 offset:0
    ds_write_b16_d16_hi v82, v26 offset:128
    s_waitcnt lgkmcnt(2)
    v_mfma_f32_16x16x32_bf16 v[56:59], v[176:179], v[104:107], 0
    v_mfma_f32_16x16x32_bf16 v[60:63], v[178:181], v[104:107], 0
    v_mfma_f32_16x16x32_bf16 v[56:59], v[180:183], v[100:103], v[56:59]
    v_mfma_f32_16x16x32_bf16 v[60:63], v[182:185], v[100:103], v[60:63]
    v_mfma_f32_16x16x32_bf16 v[56:59], v[184:187], v[96:99], v[56:59]
    ds_read_b64_tr_b16 v[108:109], v81 offset:896
    v_mfma_f32_16x16x32_bf16 v[60:63], v[186:189], v[96:99], v[60:63]
    ds_read_b64_tr_b16 v[110:111], v81 offset:768
    ds_read_b64_tr_b16 v[124:125], v81 offset:1920
    v_mfma_f32_16x16x32_bf16 v[160:163], v[188:191], v[140:143], v[160:163]
    ds_read_b64_tr_b16 v[126:127], v81 offset:1792
    v_cndmask_b32 v24, v51, v47, s[56:57]
    v_mfma_f32_16x16x32_bf16 v[164:167], v[190:193], v[140:143], v[164:167]
    v_cndmask_b32 v25, v55, v51, s[56:57]
    v_add_f32_dpp v50, v24, v50 wave_ror:1 row_mask:0xf bank_mask:0xf
    v_mfma_f32_16x16x32_bf16 v[160:163], v[192:195], v[136:139], v[160:163]
    v_add_f32_dpp v54, v25, v54 wave_ror:1 row_mask:0xf bank_mask:0xf
    v_cndmask_b32 v22, v50, v46, s[56:57]
    v_mfma_f32_16x16x32_bf16 v[164:167], v[194:197], v[136:139], v[164:167]
    v_cndmask_b32 v23, v54, v50, s[56:57]
    v_add_f32_dpp v49, v22, v49 wave_ror:1 row_mask:0xf bank_mask:0xf
    v_mfma_f32_16x16x32_bf16 v[160:163], v[196:199], v[132:135], v[160:163]
    v_add_f32_dpp v53, v23, v53 wave_ror:1 row_mask:0xf bank_mask:0xf
    v_cndmask_b32 v24, v49, v45, s[56:57]
    v_mfma_f32_16x16x32_bf16 v[164:167], v[198:201], v[132:135], v[164:167]
    v_cndmask_b32 v25, v53, v49, s[56:57]
    v_add_f32_dpp v48, v24, v48 wave_ror:1 row_mask:0xf bank_mask:0xf
    v_mfma_f32_16x16x32_bf16 v[160:163], v[200:203], v[128:131], v[160:163]
    v_add_f32_dpp v52, v25, v52 wave_ror:1 row_mask:0xf bank_mask:0xf
    v_cvt_pk_bf16_f32 v27, v48, v52
    v_mfma_f32_16x16x32_bf16 v[164:167], v[202:205], v[128:131], v[164:167]
    ds_write_b16 v82, v27 offset:256
    ds_write_b16_d16_hi v82, v27 offset:384
    s_waitcnt lgkmcnt(4)
    v_mfma_f32_16x16x32_bf16 v[40:43], v[176:179], v[108:111], 0
    v_mfma_f32_16x16x32_bf16 v[44:47], v[178:181], v[108:111], 0
    v_mfma_f32_16x16x32_bf16 v[40:43], v[180:183], v[104:107], v[40:43]
    v_mfma_f32_16x16x32_bf16 v[44:47], v[182:185], v[104:107], v[44:47]
    v_mfma_f32_16x16x32_bf16 v[40:43], v[184:187], v[100:103], v[40:43]
    ds_read_b64_tr_b16 v[112:113], v81 offset:1152
    ds_read_b64_tr_b16 v[114:115], v81 offset:1024
    v_mfma_f32_16x16x32_bf16 v[44:47], v[186:189], v[100:103], v[44:47]
    v_cndmask_b32 v24, v59, v55, s[56:57]
    v_cndmask_b32 v25, v63, v59, s[56:57]
    s_nop 0
    v_add_f32_dpp v58, v24, v58 wave_ror:1 row_mask:0xf bank_mask:0xf
    v_mfma_f32_16x16x32_bf16 v[40:43], v[188:191], v[96:99], v[40:43]
    v_add_f32_dpp v62, v25, v62 wave_ror:1 row_mask:0xf bank_mask:0xf
    v_cndmask_b32 v22, v58, v54, s[56:57]
    v_cndmask_b32 v23, v62, v58, s[56:57]
    v_mfma_f32_16x16x32_bf16 v[44:47], v[190:193], v[96:99], v[44:47]
    v_add_f32_dpp v57, v22, v57 wave_ror:1 row_mask:0xf bank_mask:0xf
    v_add_f32_dpp v61, v23, v61 wave_ror:1 row_mask:0xf bank_mask:0xf
    v_cndmask_b32 v24, v57, v53, s[56:57]
    s_waitcnt lgkmcnt(4)
    v_mfma_f32_16x16x32_bf16 v[160:163], v[204:207], v[124:127], v[160:163]
    v_cndmask_b32 v25, v61, v57, s[56:57]
    v_add_f32_dpp v56, v24, v56 wave_ror:1 row_mask:0xf bank_mask:0xf
    s_nop 0
    v_add_f32_dpp v60, v25, v60 wave_ror:1 row_mask:0xf bank_mask:0xf
    v_mfma_f32_16x16x32_bf16 v[164:167], v[206:209], v[124:127], v[164:167]
    v_cvt_pk_bf16_f32 v26, v56, v60
    ds_write_b16 v82, v26 offset:512
    ds_write_b16_d16_hi v82, v26 offset:640
    s_waitcnt lgkmcnt(2)
    v_mfma_f32_16x16x32_bf16 v[48:51], v[176:179], v[112:115], 0
    v_mfma_f32_16x16x32_bf16 v[52:55], v[178:181], v[112:115], 0
    ds_read_b64_tr_b16 v[116:117], v81 offset:1408
    ds_read_b64_tr_b16 v[118:119], v81 offset:1280
    v_cndmask_b32 v24, v43, v63, s[56:57]
    v_cndmask_b32 v25, v47, v43, s[56:57]
    s_nop 0
    s_nop 0
    v_add_f32_dpp v42, v24, v42 wave_ror:1 row_mask:0xf bank_mask:0xf
    v_add_f32_dpp v46, v25, v46 wave_ror:1 row_mask:0xf bank_mask:0xf
    v_cndmask_b32 v22, v42, v62, s[56:57]
    v_cndmask_b32 v23, v46, v42, s[56:57]
    s_nop 0
    s_nop 0
    v_add_f32_dpp v41, v22, v41 wave_ror:1 row_mask:0xf bank_mask:0xf
    v_add_f32_dpp v45, v23, v45 wave_ror:1 row_mask:0xf bank_mask:0xf
    v_cndmask_b32 v24, v41, v61, s[56:57]
    v_cndmask_b32 v25, v45, v41, s[56:57]
    s_nop 0
    s_nop 0
    v_add_f32_dpp v40, v24, v40 wave_ror:1 row_mask:0xf bank_mask:0xf
    v_add_f32_dpp v44, v25, v44 wave_ror:1 row_mask:0xf bank_mask:0xf
    v_cvt_pk_bf16_f32 v27, v40, v44
    ds_write_b16 v82, v27 offset:768
    ds_write_b16_d16_hi v82, v27 offset:896
    v_mfma_f32_16x16x32_bf16 v[48:51], v[180:183], v[108:111], v[48:51]
    v_mfma_f32_16x16x32_bf16 v[52:55], v[182:185], v[108:111], v[52:55]
    v_mfma_f32_16x16x32_bf16 v[48:51], v[184:187], v[104:107], v[48:51]
    s_waitcnt lgkmcnt(0)
    s_barrier
    v_mfma_f32_16x16x32_bf16 v[52:55], v[186:189], v[104:107], v[52:55]
    ds_read_b64_tr_b16 v[28:29], v83 offset:0
    v_mfma_f32_16x16x32_bf16 v[48:51], v[188:191], v[100:103], v[48:51]
    ds_read_b64_tr_b16 v[30:31], v83 offset:16640
    v_mfma_f32_16x16x32_bf16 v[52:55], v[190:193], v[100:103], v[52:55]
    s_add_u32 s62, s51, 0
    v_mfma_f32_16x16x32_bf16 v[48:51], v[192:195], v[96:99], v[48:51]
    v_mfma_f32_16x16x32_bf16 v[52:55], v[194:197], v[96:99], v[52:55]
    v_mfma_f32_16x16x32_bf16 v[56:59], v[176:179], v[116:119], 0
    v_mfma_f32_16x16x32_bf16 v[60:63], v[178:181], v[116:119], 0
    v_mfma_f32_16x16x32_bf16 v[56:59], v[180:183], v[112:115], v[56:59]
    v_mfma_f32_16x16x32_bf16 v[60:63], v[182:185], v[112:115], v[60:63]
    v_mfma_f32_16x16x32_bf16 v[56:59], v[184:187], v[108:111], v[56:59]
    s_waitcnt lgkmcnt(0)
    s_cmp_lg_u32 s54, 0
    s_cbranch_scc1 L_st0_0
    buffer_store_dwordx4 v[28:31], v87, s[44:47], s62 offen nt
L_st0_0:
    ds_read_b64_tr_b16 v[120:121], v81 offset:1664
    v_mfma_f32_16x16x32_bf16 v[60:63], v[186:189], v[108:111], v[60:63]
    ds_read_b64_tr_b16 v[122:123], v81 offset:1536
    v_cndmask_b32 v24, v51, v47, s[56:57]
    v_mfma_f32_16x16x32_bf16 v[56:59], v[188:191], v[104:107], v[56:59]
    v_cndmask_b32 v25, v55, v51, s[56:57]
    v_add_f32_dpp v50, v24, v50 wave_ror:1 row_mask:0xf bank_mask:0xf
    v_mfma_f32_16x16x32_bf16 v[60:63], v[190:193], v[104:107], v[60:63]
    v_add_f32_dpp v54, v25, v54 wave_ror:1 row_mask:0xf bank_mask:0xf
    v_cndmask_b32 v22, v50, v46, s[56:57]
    v_cndmask_b32 v23, v54, v50, s[56:57]
    v_mfma_f32_16x16x32_bf16 v[56:59], v[192:195], v[100:103], v[56:59]
    v_add_f32_dpp v49, v22, v49 wave_ror:1 row_mask:0xf bank_mask:0xf
    v_add_f32_dpp v53, v23, v53 wave_ror:1 row_mask:0xf bank_mask:0xf
    v_mfma_f32_16x16x32_bf16 v[60:63], v[194:197], v[100:103], v[60:63]
    v_cndmask_b32 v24, v49, v45, s[56:57]
    v_cndmask_b32 v25, v53, v49, s[56:57]
    v_mfma_f32_16x16x32_bf16 v[56:59], v[196:199], v[96:99], v[56:59]
    v_add_f32_dpp v48, v24, v48 wave_ror:1 row_mask:0xf bank_mask:0xf
    v_add_f32_dpp v52, v25, v52 wave_ror:1 row_mask:0xf bank_mask:0xf
    v_mfma_f32_16x16x32_bf16 v[60:63], v[198:201], v[96:99], v[60:63]
    v_cvt_pk_bf16_f32 v26, v48, v52
    ds_write_b16 v82, v26 offset:1024
    ds_write_b16_d16_hi v82, v26 offset:1152
    s_waitcnt lgkmcnt(2)
    v_mfma_f32_16x16x32_bf16 v[40:43], v[176:179], v[120:123], 0
    v_mfma_f32_16x16x32_bf16 v[44:47], v[178:181], v[120:123], 0
    v_mfma_f32_16x16x32_bf16 v[40:43], v[180:183], v[116:119], v[40:43]
    v_mfma_f32_16x16x32_bf16 v[44:47], v[182:185], v[116:119], v[44:47]
    v_mfma_f32_16x16x32_bf16 v[40:43], v[184:187], v[112:115], v[40:43]
    s_cmp_lg_u32 s54, 1
    s_cbranch_scc1 L_st0_1
    buffer_store_dwordx4 v[28:31], v87, s[44:47], s62 offen nt
L_st0_1:
    v_mfma_f32_16x16x32_bf16 v[44:47], v[186:189], v[112:115], v[44:47]
    v_cndmask_b32 v24, v59, v55, s[56:57]
    v_cndmask_b32 v25, v63, v59, s[56:57]
    v_mfma_f32_16x16x32_bf16 v[40:43], v[188:191], v[108:111], v[40:43]
    v_add_f32_dpp v58, v24, v58 wave_ror:1 row_mask:0xf bank_mask:0xf
    v_mfma_f32_16x16x32_bf16 v[44:47], v[190:193], v[108:111], v[44:47]
    v_add_f32_dpp v62, v25, v62 wave_ror:1 row_mask:0xf bank_mask:0xf
    v_cndmask_b32 v22, v58, v54, s[56:57]
    v_mfma_f32_16x16x32_bf16 v[40:43], v[192:195], v[104:107], v[40:43]
    v_cndmask_b32 v23, v62, v58, s[56:57]
    v_add_f32_dpp v57, v22, v57 wave_ror:1 row_mask:0xf bank_mask:0xf
    v_mfma_f32_16x16x32_bf16 v[44:47], v[194:197], v[104:107], v[44:47]
    v_add_f32_dpp v61, v23, v61 wave_ror:1 row_mask:0xf bank_mask:0xf
    v_mfma_f32_16x16x32_bf16 v[40:43], v[196:199], v[100:103], v[40:43]
    v_cndmask_b32 v24, v57, v53, s[56:57]
    v_cndmask_b32 v25, v61, v57, s[56:57]
    v_mfma_f32_16x16x32_bf16 v[44:47], v[198:201], v[100:103], v[44:47]
    v_add_f32_dpp v56, v24, v56 wave_ror:1 row_mask:0xf bank_mask:0xf
    v_mfma_f32_16x16x32_bf16 v[40:43], v[200:203], v[96:99], v[40:43]
    v_add_f32_dpp v60, v25, v60 wave_ror:1 row_mask:0xf bank_mask:0xf
    v_cvt_pk_bf16_f32 v27, v56, v60
    v_mfma_f32_16x16x32_bf16 v[44:47], v[202:205], v[96:99], v[44:47]
    ds_write_b16 v82, v27 offset:1280
    ds_write_b16_d16_hi v82, v27 offset:1408
    v_mfma_f32_16x16x32_bf16 v[48:51], v[176:179], v[124:127], 0
    v_mfma_f32_16x16x32_bf16 v[52:55], v[178:181], v[124:127], 0
    v_mfma_f32_16x16x32_bf16 v[48:51], v[180:183], v[120:123], v[48:51]
    v_mfma_f32_16x16x32_bf16 v[52:55], v[182:185], v[120:123], v[52:55]
    v_mfma_f32_16x16x32_bf16 v[48:51], v[184:187], v[116:119], v[48:51]
    v_cndmask_b32 v24, v43, v63, s[56:57]
    v_mfma_f32_16x16x32_bf16 v[52:55], v[186:189], v[116:119], v[52:55]
    v_cndmask_b32 v25, v47, v43, s[56:57]
    v_add_f32_dpp v42, v24, v42 wave_ror:1 row_mask:0xf bank_mask:0xf
    v_mfma_f32_16x16x32_bf16 v[48:51], v[188:191], v[112:115], v[48:51]
    v_add_f32_dpp v46, v25, v46 wave_ror:1 row_mask:0xf bank_mask:0xf
    v_cndmask_b32 v22, v42, v62, s[56:57]
    v_mfma_f32_16x16x32_bf16 v[52:55], v[190:193], v[112:115], v[52:55]
    v_cndmask_b32 v23, v46, v42, s[56:57]
    v_mfma_f32_16x16x32_bf16 v[48:51], v[192:195], v[108:111], v[48:51]
    v_add_f32_dpp v41, v22, v41 wave_ror:1 row_mask:0xf bank_mask:0xf
    v_add_f32_dpp v45, v23, v45 wave_ror:1 row_mask:0xf bank_mask:0xf
    v_mfma_f32_16x16x32_bf16 v[52:55], v[194:197], v[108:111], v[52:55]
    v_cndmask_b32 v24, v41, v61, s[56:57]
    v_cndmask_b32 v25, v45, v41, s[56:57]
    v_mfma_f32_16x16x32_bf16 v[48:51], v[196:199], v[104:107], v[48:51]
    v_add_f32_dpp v40, v24, v40 wave_ror:1 row_mask:0xf bank_mask:0xf
    v_mfma_f32_16x16x32_bf16 v[52:55], v[198:201], v[104:107], v[52:55]
    v_add_f32_dpp v44, v25, v44 wave_ror:1 row_mask:0xf bank_mask:0xf
    v_cvt_pk_bf16_f32 v26, v40, v44
    v_mfma_f32_16x16x32_bf16 v[48:51], v[200:203], v[100:103], v[48:51]
    ds_write_b16 v82, v26 offset:1536
    ds_write_b16_d16_hi v82, v26 offset:1664
    v_mfma_f32_16x16x32_bf16 v[52:55], v[202:205], v[100:103], v[52:55]
    s_waitcnt vmcnt(1)
    v_mfma_f32_16x16x32_bf16 v[48:51], v[204:207], v[96:99], v[48:51]
    ds_read_b64_tr_b16 v[32:33], v84 offset:33280
    ds_read_b64_tr_b16 v[34:35], v84 offset:33792
    v_mfma_f32_16x16x32_bf16 v[52:55], v[206:209], v[96:99], v[52:55]
    s_waitcnt lgkmcnt(1)
    ds_write_b64 v85, v[32:33] offset:2048
    s_waitcnt lgkmcnt(1)
    ds_write_b64 v85, v[34:35] offset:2112
    v_mfma_f32_16x16x32_bf16 v[56:59], v[176:179], v[128:131], 0
    v_mfma_f32_16x16x32_bf16 v[60:63], v[178:181], v[128:131], 0
    v_mfma_f32_16x16x32_bf16 v[56:59], v[180:183], v[124:127], v[56:59]
    v_mfma_f32_16x16x32_bf16 v[60:63], v[182:185], v[124:127], v[60:63]
    v_cndmask_b32 v24, v51, v47, s[56:57]
    v_cndmask_b32 v25, v55, v51, s[56:57]
    v_mfma_f32_16x16x32_bf16 v[56:59], v[184:187], v[120:123], v[56:59]
    v_add_f32_dpp v50, v24, v50 wave_ror:1 row_mask:0xf bank_mask:0xf
    v_add_f32_dpp v54, v25, v54 wave_ror:1 row_mask:0xf bank_mask:0xf
    v_mfma_f32_16x16x32_bf16 v[60:63], v[186:189], v[120:123], v[60:63]
    v_cndmask_b32 v22, v50, v46, s[56:57]
    v_cndmask_b32 v23, v54, v50, s[56:57]
    v_mfma_f32_16x16x32_bf16 v[56:59], v[188:191], v[116:119], v[56:59]
    v_add_f32_dpp v49, v22, v49 wave_ror:1 row_mask:0xf bank_mask:0xf
    v_add_f32_dpp v53, v23, v53 wave_ror:1 row_mask:0xf bank_mask:0xf
    v_mfma_f32_16x16x32_bf16 v[60:63], v[190:193], v[116:119], v[60:63]
    v_cndmask_b32 v24, v49, v45, s[56:57]
    v_cndmask_b32 v25, v53, v49, s[56:57]
    v_mfma_f32_16x16x32_bf16 v[56:59], v[192:195], v[112:115], v[56:59]
    v_add_f32_dpp v48, v24, v48 wave_ror:1 row_mask:0xf bank_mask:0xf
    v_add_f32_dpp v52, v25, v52 wave_ror:1 row_mask:0xf bank_mask:0xf
    v_mfma_f32_16x16x32_bf16 v[60:63], v[194:197], v[112:115], v[60:63]
    v_cvt_pk_bf16_f32 v27, v48, v52
    ds_write_b16 v82, v27 offset:1792
    ds_write_b16_d16_hi v82, v27 offset:1920
    v_mfma_f32_16x16x32_bf16 v[56:59], v[196:199], v[108:111], v[56:59]
    v_mfma_f32_16x16x32_bf16 v[60:63], v[198:201], v[108:111], v[60:63]
    v_mfma_f32_16x16x32_bf16 v[56:59], v[200:203], v[104:107], v[56:59]
    s_waitcnt lgkmcnt(0)
    s_barrier
    v_mfma_f32_16x16x32_bf16 v[60:63], v[202:205], v[104:107], v[60:63]
    ds_read_b64_tr_b16 v[210:211], v80 offset:2176
    v_mfma_f32_16x16x32_bf16 v[56:59], v[204:207], v[100:103], v[56:59]
    ds_read_b64_tr_b16 v[212:213], v80 offset:2304
    ds_read_b64_tr_b16 v[28:29], v83 offset:1024
    v_mfma_f32_16x16x32_bf16 v[60:63], v[206:209], v[100:103], v[60:63]
    ds_read_b64_tr_b16 v[30:31], v83 offset:17664
    s_add_u32 s62, s51, 1310720
    s_waitcnt lgkmcnt(3)
    v_mfma_f32_16x16x32_bf16 v[56:59], v[208:211], v[96:99], v[56:59]
    s_waitcnt lgkmcnt(2)
    v_mfma_f32_16x16x32_bf16 v[60:63], v[210:213], v[96:99], v[60:63]
    v_mfma_f32_16x16x32_bf16 v[40:43], v[176:179], v[132:135], 0
    v_mfma_f32_16x16x32_bf16 v[44:47], v[178:181], v[132:135], 0
    v_mfma_f32_16x16x32_bf16 v[40:43], v[180:183], v[128:131], v[40:43]
    v_mfma_f32_16x16x32_bf16 v[44:47], v[182:185], v[128:131], v[44:47]
    v_mfma_f32_16x16x32_bf16 v[40:43], v[184:187], v[124:127], v[40:43]
    s_waitcnt lgkmcnt(0)
    s_cmp_lg_u32 s54, 0
    s_cbranch_scc1 L_st1_0
    buffer_store_dwordx4 v[28:31], v87, s[44:47], s62 offen nt
L_st1_0:
    v_mfma_f32_16x16x32_bf16 v[44:47], v[186:189], v[124:127], v[44:47]
    ds_read_b64_tr_b16 v[214:215], v80 offset:2432
    v_mfma_f32_16x16x32_bf16 v[40:43], v[188:191], v[120:123], v[40:43]
    ds_read_b64_tr_b16 v[216:217], v80 offset:2560
    ds_read_b64_tr_b16 v[218:219], v80 offset:2688
    v_mfma_f32_16x16x32_bf16 v[44:47], v[190:193], v[120:123], v[44:47]
    ds_read_b64_tr_b16 v[220:221], v80 offset:2816
    v_mfma_f32_16x16x32_bf16 v[40:43], v[192:195], v[116:119], v[40:43]
    ds_read_b64_tr_b16 v[222:223], v80 offset:2944
    v_mfma_f32_16x16x32_bf16 v[44:47], v[194:197], v[116:119], v[44:47]
    ds_read_b64_tr_b16 v[224:225], v80 offset:3072
    v_cndmask_b32 v24, v59, v55, s[56:57]
    v_mfma_f32_16x16x32_bf16 v[40:43], v[196:199], v[112:115], v[40:43]
    v_cndmask_b32 v25, v63, v59, s[56:57]
    v_mfma_f32_16x16x32_bf16 v[44:47], v[198:201], v[112:115], v[44:47]
    v_add_f32_dpp v58, v24, v58 wave_ror:1 row_mask:0xf bank_mask:0xf
    v_add_f32_dpp v62, v25, v62 wave_ror:1 row_mask:0xf bank_mask:0xf
    v_mfma_f32_16x16x32_bf16 v[40:43], v[200:203], v[108:111], v[40:43]
    v_cndmask_b32 v22, v58, v54, s[56:57]
    v_mfma_f32_16x16x32_bf16 v[44:47], v[202:205], v[108:111], v[44:47]
    v_cndmask_b32 v23, v62, v58, s[56:57]
    v_mfma_f32_16x16x32_bf16 v[40:43], v[204:207], v[104:107], v[40:43]
    v_add_f32_dpp v57, v22, v57 wave_ror:1 row_mask:0xf bank_mask:0xf
    v_add_f32_dpp v61, v23, v61 wave_ror:1 row_mask:0xf bank_mask:0xf
    v_mfma_f32_16x16x32_bf16 v[44:47], v[206:209], v[104:107], v[44:47]
    v_cndmask_b32 v24, v57, v53, s[56:57]
    v_mfma_f32_16x16x32_bf16 v[40:43], v[208:211], v[100:103], v[40:43]
    v_cndmask_b32 v25, v61, v57, s[56:57]
    v_mfma_f32_16x16x32_bf16 v[44:47], v[210:213], v[100:103], v[44:47]
    v_add_f32_dpp v56, v24, v56 wave_ror:1 row_mask:0xf bank_mask:0xf
    v_add_f32_dpp v60, v25, v60 wave_ror:1 row_mask:0xf bank_mask:0xf
    s_waitcnt lgkmcnt(5)
    v_mfma_f32_16x16x32_bf16 v[40:43], v[212:215], v[96:99], v[40:43]
    v_cvt_pk_bf16_f32 v26, v56, v60
    s_waitcnt lgkmcnt(4)
    v_mfma_f32_16x16x32_bf16 v[44:47], v[214:217], v[96:99], v[44:47]
    ds_write_b16 v82, v26 offset:2048
    ds_write_b16_d16_hi v82, v26 offset:2176
    v_mfma_f32_16x16x32_bf16 v[48:51], v[176:179], v[136:139], 0
    v_mfma_f32_16x16x32_bf16 v[52:55], v[178:181], v[136:139], 0
    v_mfma_f32_16x16x32_bf16 v[48:51], v[180:183], v[132:135], v[48:51]
    v_mfma_f32_16x16x32_bf16 v[52:55], v[182:185], v[132:135], v[52:55]
    v_mfma_f32_16x16x32_bf16 v[48:51], v[184:187], v[128:131], v[48:51]
    s_cmp_lg_u32 s54, 1
    s_cbranch_scc1 L_st1_1
    buffer_store_dwordx4 v[28:31], v87, s[44:47], s62 offen nt
L_st1_1:
    v_mfma_f32_16x16x32_bf16 v[52:55], v[186:189], v[128:131], v[52:55]
    v_cndmask_b32 v24, v43, v63, s[56:57]
    v_mfma_f32_16x16x32_bf16 v[48:51], v[188:191], v[124:127], v[48:51]
    v_cndmask_b32 v25, v47, v43, s[56:57]
    v_add_f32_dpp v42, v24, v42 wave_ror:1 row_mask:0xf bank_mask:0xf
    v_mfma_f32_16x16x32_bf16 v[52:55], v[190:193], v[124:127], v[52:55]
    v_add_f32_dpp v46, v25, v46 wave_ror:1 row_mask:0xf bank_mask:0xf
    v_mfma_f32_16x16x32_bf16 v[48:51], v[192:195], v[120:123], v[48:51]
    v_cndmask_b32 v22, v42, v62, s[56:57]
    v_mfma_f32_16x16x32_bf16 v[52:55], v[194:197], v[120:123], v[52:55]
    v_cndmask_b32 v23, v46, v42, s[56:57]
    v_add_f32_dpp v41, v22, v41 wave_ror:1 row_mask:0xf bank_mask:0xf
    v_mfma_f32_16x16x32_bf16 v[48:51], v[196:199], v[116:119], v[48:51]
    v_add_f32_dpp v45, v23, v45 wave_ror:1 row_mask:0xf bank_mask:0xf
    v_mfma_f32_16x16x32_bf16 v[52:55], v[198:201], v[116:119], v[52:55]
    v_cndmask_b32 v24, v41, v61, s[56:57]
    v_cndmask_b32 v25, v45, v41, s[56:57]
    v_mfma_f32_16x16x32_bf16 v[48:51], v[200:203], v[112:115], v[48:51]
    v_add_f32_dpp v40, v24, v40 wave_ror:1 row_mask:0xf bank_mask:0xf
    v_mfma_f32_16x16x32_bf16 v[52:55], v[202:205], v[112:115], v[52:55]
    v_add_f32_dpp v44, v25, v44 wave_ror:1 row_mask:0xf bank_mask:0xf
    v_mfma_f32_16x16x32_bf16 v[48:51], v[204:207], v[108:111], v[48:51]
    v_cvt_pk_bf16_f32 v27, v40, v44
    ds_write_b16 v82, v27 offset:2304
    v_mfma_f32_16x16x32_bf16 v[52:55], v[206:209], v[108:111], v[52:55]
    ds_write_b16_d16_hi v82, v27 offset:2432
    v_mfma_f32_16x16x32_bf16 v[48:51], v[208:211], v[104:107], v[48:51]
    s_lshl_b32 s39, s3, 6
    v_and_b32_e64 v79, 32, v0
    v_mfma_f32_16x16x32_bf16 v[52:55], v[210:213], v[104:107], v[52:55]
    v_lshl_add_u32 v79, v79, 1, s39
    v_mfma_f32_16x16x32_bf16 v[48:51], v[212:215], v[100:103], v[48:51]
    v_sub_u32_e64 v76, v83, v79
    v_mfma_f32_16x16x32_bf16 v[52:55], v[214:217], v[100:103], v[52:55]
    v_cmp_gt_u32 vcc, 32, v0
    v_mov_b32_e64 v79, 0x40000000
    s_waitcnt lgkmcnt(7)
    v_mfma_f32_16x16x32_bf16 v[48:51], v[216:219], v[96:99], v[48:51]
    s_mul_i32 s39, s3, 81920
    s_waitcnt lgkmcnt(6)
    v_mfma_f32_16x16x32_bf16 v[52:55], v[218:221], v[96:99], v[52:55]
    s_sub_u32 s50, s51, s39
    v_cndmask_b32_e64 v79, v79, v87, vcc
    v_mfma_f32_16x16x32_bf16 v[56:59], v[176:179], v[140:143], 0
    v_mfma_f32_16x16x32_bf16 v[60:63], v[178:181], v[140:143], 0
    v_mfma_f32_16x16x32_bf16 v[56:59], v[180:183], v[136:139], v[56:59]
    v_mfma_f32_16x16x32_bf16 v[60:63], v[182:185], v[136:139], v[60:63]
    v_mfma_f32_16x16x32_bf16 v[56:59], v[184:187], v[132:135], v[56:59]
    v_cndmask_b32 v24, v51, v47, s[56:57]
    v_mfma_f32_16x16x32_bf16 v[60:63], v[186:189], v[132:135], v[60:63]
    v_cndmask_b32 v25, v55, v51, s[56:57]
    v_mfma_f32_16x16x32_bf16 v[56:59], v[188:191], v[128:131], v[56:59]
    v_add_f32_dpp v50, v24, v50 wave_ror:1 row_mask:0xf bank_mask:0xf
    v_mfma_f32_16x16x32_bf16 v[60:63], v[190:193], v[128:131], v[60:63]
    v_add_f32_dpp v54, v25, v54 wave_ror:1 row_mask:0xf bank_mask:0xf
    v_mfma_f32_16x16x32_bf16 v[56:59], v[192:195], v[124:127], v[56:59]
    v_cndmask_b32 v22, v50, v46, s[56:57]
    v_mfma_f32_16x16x32_bf16 v[60:63], v[194:197], v[124:127], v[60:63]
    v_cndmask_b32 v23, v54, v50, s[56:57]
    v_mfma_f32_16x16x32_bf16 v[56:59], v[196:199], v[120:123], v[56:59]
    v_add_f32_dpp v49, v22, v49 wave_ror:1 row_mask:0xf bank_mask:0xf
    v_mfma_f32_16x16x32_bf16 v[60:63], v[198:201], v[120:123], v[60:63]
    v_add_f32_dpp v53, v23, v53 wave_ror:1 row_mask:0xf bank_mask:0xf
    v_mfma_f32_16x16x32_bf16 v[56:59], v[200:203], v[116:119], v[56:59]
    v_cndmask_b32 v24, v49, v45, s[56:57]
    v_mfma_f32_16x16x32_bf16 v[60:63], v[202:205], v[116:119], v[60:63]
    v_cndmask_b32 v25, v53, v49, s[56:57]
    v_mfma_f32_16x16x32_bf16 v[56:59], v[204:207], v[112:115], v[56:59]
    v_add_f32_dpp v48, v24, v48 wave_ror:1 row_mask:0xf bank_mask:0xf
    v_mfma_f32_16x16x32_bf16 v[60:63], v[206:209], v[112:115], v[60:63]
    v_add_f32_dpp v52, v25, v52 wave_ror:1 row_mask:0xf bank_mask:0xf
    v_mfma_f32_16x16x32_bf16 v[56:59], v[208:211], v[108:111], v[56:59]
    v_cvt_pk_bf16_f32 v26, v48, v52
    v_mfma_f32_16x16x32_bf16 v[60:63], v[210:213], v[108:111], v[60:63]
    ds_write_b16 v82, v26 offset:2560
    v_mfma_f32_16x16x32_bf16 v[56:59], v[212:215], v[104:107], v[56:59]
    ds_write_b16_d16_hi v82, v26 offset:2688
    v_mfma_f32_16x16x32_bf16 v[60:63], v[214:217], v[104:107], v[60:63]
    s_waitcnt vmcnt(0)
    v_mfma_f32_16x16x32_bf16 v[56:59], v[216:219], v[100:103], v[56:59]
    ds_read_b64_tr_b16 v[32:33], v84 offset:41472
    v_mfma_f32_16x16x32_bf16 v[60:63], v[218:221], v[100:103], v[60:63]
    ds_read_b64_tr_b16 v[34:35], v84 offset:41984
    s_waitcnt lgkmcnt(9)
    v_mfma_f32_16x16x32_bf16 v[56:59], v[220:223], v[96:99], v[56:59]
    s_waitcnt lgkmcnt(1)
    ds_write_b64 v85, v[32:33] offset:3072
    v_mfma_f32_16x16x32_bf16 v[60:63], v[222:225], v[96:99], v[60:63]
    s_waitcnt lgkmcnt(1)
    ds_write_b64 v85, v[34:35] offset:3136
    v_mfma_f32_16x16x32_bf16 v[40:43], v[176:179], v[144:147], 0
    v_mfma_f32_16x16x32_bf16 v[44:47], v[178:181], v[144:147], 0
    v_mfma_f32_16x16x32_bf16 v[40:43], v[180:183], v[140:143], v[40:43]
    v_mfma_f32_16x16x32_bf16 v[44:47], v[182:185], v[140:143], v[44:47]
    v_cndmask_b32 v24, v59, v55, s[56:57]
    v_mfma_f32_16x16x32_bf16 v[40:43], v[184:187], v[136:139], v[40:43]
    v_cndmask_b32 v25, v63, v59, s[56:57]
    v_mfma_f32_16x16x32_bf16 v[44:47], v[186:189], v[136:139], v[44:47]
    v_add_f32_dpp v58, v24, v58 wave_ror:1 row_mask:0xf bank_mask:0xf
    v_mfma_f32_16x16x32_bf16 v[40:43], v[188:191], v[132:135], v[40:43]
    v_add_f32_dpp v62, v25, v62 wave_ror:1 row_mask:0xf bank_mask:0xf
    v_mfma_f32_16x16x32_bf16 v[44:47], v[190:193], v[132:135], v[44:47]
    v_cndmask_b32 v22, v58, v54, s[56:57]
    v_mfma_f32_16x16x32_bf16 v[40:43], v[192:195], v[128:131], v[40:43]
    v_cndmask_b32 v23, v62, v58, s[56:57]
    v_mfma_f32_16x16x32_bf16 v[44:47], v[194:197], v[128:131], v[44:47]
    v_add_f32_dpp v57, v22, v57 wave_ror:1 row_mask:0xf bank_mask:0xf
    v_mfma_f32_16x16x32_bf16 v[40:43], v[196:199], v[124:127], v[40:43]
    v_add_f32_dpp v61, v23, v61 wave_ror:1 row_mask:0xf bank_mask:0xf
    v_mfma_f32_16x16x32_bf16 v[44:47], v[198:201], v[124:127], v[44:47]
    v_cndmask_b32 v24, v57, v53, s[56:57]
    v_mfma_f32_16x16x32_bf16 v[40:43], v[200:203], v[120:123], v[40:43]
    v_cndmask_b32 v25, v61, v57, s[56:57]
    v_mfma_f32_16x16x32_bf16 v[44:47], v[202:205], v[120:123], v[44:47]
    v_add_f32_dpp v56, v24, v56 wave_ror:1 row_mask:0xf bank_mask:0xf
    v_mfma_f32_16x16x32_bf16 v[40:43], v[204:207], v[116:119], v[40:43]
    v_add_f32_dpp v60, v25, v60 wave_ror:1 row_mask:0xf bank_mask:0xf
    v_mfma_f32_16x16x32_bf16 v[44:47], v[206:209], v[116:119], v[44:47]
    v_cvt_pk_bf16_f32 v27, v56, v60
    v_mfma_f32_16x16x32_bf16 v[40:43], v[208:211], v[112:115], v[40:43]
    ds_write_b16 v82, v27 offset:2816
    v_mfma_f32_16x16x32_bf16 v[44:47], v[210:213], v[112:115], v[44:47]
    ds_write_b16_d16_hi v82, v27 offset:2944
    v_mfma_f32_16x16x32_bf16 v[40:43], v[212:215], v[108:111], v[40:43]
    v_mfma_f32_16x16x32_bf16 v[44:47], v[214:217], v[108:111], v[44:47]
    v_mfma_f32_16x16x32_bf16 v[40:43], v[216:219], v[104:107], v[40:43]
    s_waitcnt lgkmcnt(0)
    s_barrier
    v_mfma_f32_16x16x32_bf16 v[44:47], v[218:221], v[104:107], v[44:47]
    ds_read_b64_tr_b16 v[226:227], v80 offset:3200
    v_mfma_f32_16x16x32_bf16 v[40:43], v[220:223], v[100:103], v[40:43]
    ds_read_b64_tr_b16 v[228:229], v80 offset:3328
    ds_read_b64_tr_b16 v[28:29], v83 offset:2048
    v_mfma_f32_16x16x32_bf16 v[44:47], v[222:225], v[100:103], v[44:47]
L_wa_2:
    s_cbranch_execz L_wa_x
    ds_read_b64_tr_b16 v[30:31], v83 offset:18688
    s_add_u32 s62, s51, 2621440
    s_waitcnt lgkmcnt(3)
    v_mfma_f32_16x16x32_bf16 v[40:43], v[224:227], v[96:99], v[40:43]
    s_waitcnt lgkmcnt(2)
    v_mfma_f32_16x16x32_bf16 v[44:47], v[226:229], v[96:99], v[44:47]
    v_mfma_f32_16x16x32_bf16 v[48:51], v[176:179], v[148:151], 0
    v_mfma_f32_16x16x32_bf16 v[52:55], v[178:181], v[148:151], 0
    v_mfma_f32_16x16x32_bf16 v[48:51], v[180:183], v[144:147], v[48:51]
    v_mfma_f32_16x16x32_bf16 v[52:55], v[182:185], v[144:147], v[52:55]
    v_mfma_f32_16x16x32_bf16 v[48:51], v[184:187], v[140:143], v[48:51]
    v_mfma_f32_16x16x32_bf16 v[52:55], v[186:189], v[140:143], v[52:55]
    s_waitcnt lgkmcnt(0)
    s_cmp_lg_u32 s54, 0
    s_cbranch_scc1 L_st2_0
    buffer_store_dwordx4 v[28:31], v87, s[44:47], s62 offen nt
L_st2_0:
    v_mfma_f32_16x16x32_bf16 v[48:51], v[188:191], v[136:139], v[48:51]
    ds_read_b64_tr_b16 v[230:231], v80 offset:3456
    v_mfma_f32_16x16x32_bf16 v[52:55], v[190:193], v[136:139], v[52:55]
    ds_read_b64_tr_b16 v[232:233], v80 offset:3584
    v_mfma_f32_16x16x32_bf16 v[48:51], v[192:195], v[132:135], v[48:51]
    ds_read_b64_tr_b16 v[234:235], v80 offset:3712
    v_mfma_f32_16x16x32_bf16 v[52:55], v[194:197], v[132:135], v[52:55]
    ds_read_b64_tr_b16 v[236:237], v80 offset:3840
    v_mfma_f32_16x16x32_bf16 v[48:51], v[196:199], v[128:131], v[48:51]
    ds_read_b64_tr_b16 v[238:239], v80 offset:3968
    v_mfma_f32_16x16x32_bf16 v[52:55], v[198:201], v[128:131], v[52:55]
    ds_read_b64_tr_b16 v[240:241], v80 offset:4096
    v_mfma_f32_16x16x32_bf16 v[48:51], v[200:203], v[124:127], v[48:51]
    v_cndmask_b32 v24, v43, v63, s[56:57]
    v_mfma_f32_16x16x32_bf16 v[52:55], v[202:205], v[124:127], v[52:55]
    v_cndmask_b32 v25, v47, v43, s[56:57]
    v_mfma_f32_16x16x32_bf16 v[48:51], v[204:207], v[120:123], v[48:51]
    v_add_f32_dpp v42, v24, v42 wave_ror:1 row_mask:0xf bank_mask:0xf
    v_mfma_f32_16x16x32_bf16 v[52:55], v[206:209], v[120:123], v[52:55]
    v_add_f32_dpp v46, v25, v46 wave_ror:1 row_mask:0xf bank_mask:0xf
    v_mfma_f32_16x16x32_bf16 v[48:51], v[208:211], v[116:119], v[48:51]
    s_cmp_lg_u32 s54, 1
    s_cbranch_scc1 L_st2_1
    buffer_store_dwordx4 v[28:31], v87, s[44:47], s62 offen nt
L_st2_1:
    v_mfma_f32_16x16x32_bf16 v[52:55], v[210:213], v[116:119], v[52:55]
    v_cndmask_b32 v22, v42, v62, s[56:57]
    v_mfma_f32_16x16x32_bf16 v[48:51], v[212:215], v[112:115], v[48:51]
    v_cndmask_b32 v23, v46, v42, s[56:57]
    v_mfma_f32_16x16x32_bf16 v[52:55], v[214:217], v[112:115], v[52:55]
    v_add_f32_dpp v41, v22, v41 wave_ror:1 row_mask:0xf bank_mask:0xf
    v_mfma_f32_16x16x32_bf16 v[48:51], v[216:219], v[108:111], v[48:51]
    v_add_f32_dpp v45, v23, v45 wave_ror:1 row_mask:0xf bank_mask:0xf
    v_mfma_f32_16x16x32_bf16 v[52:55], v[218:221], v[108:111], v[52:55]
    v_cndmask_b32 v24, v41, v61, s[56:57]
    v_mfma_f32_16x16x32_bf16 v[48:51], v[220:223], v[104:107], v[48:51]
    v_cndmask_b32 v25, v45, v41, s[56:57]
    v_mfma_f32_16x16x32_bf16 v[52:55], v[222:225], v[104:107], v[52:55]
    v_add_f32_dpp v40, v24, v40 wave_ror:1 row_mask:0xf bank_mask:0xf
    v_mfma_f32_16x16x32_bf16 v[48:51], v[224:227], v[100:103], v[48:51]
    v_add_f32_dpp v44, v25, v44 wave_ror:1 row_mask:0xf bank_mask:0xf
    v_mfma_f32_16x16x32_bf16 v[52:55], v[226:229], v[100:103], v[52:55]
    v_cvt_pk_bf16_f32 v26, v40, v44
    s_waitcnt lgkmcnt(5)
    v_mfma_f32_16x16x32_bf16 v[48:51], v[228:231], v[96:99], v[48:51]
    ds_write_b16 v82, v26 offset:3072
    s_waitcnt lgkmcnt(5)
    v_mfma_f32_16x16x32_bf16 v[52:55], v[230:233], v[96:99], v[52:55]
    ds_write_b16_d16_hi v82, v26 offset:3200
    v_mfma_f32_16x16x32_bf16 v[160:163], v[208:211], v[120:123], v[160:163]
    v_mfma_f32_16x16x32_bf16 v[164:167], v[210:213], v[120:123], v[164:167]
    v_mfma_f32_16x16x32_bf16 v[160:163], v[212:215], v[116:119], v[160:163]
    v_mfma_f32_16x16x32_bf16 v[164:167], v[214:217], v[116:119], v[164:167]
    v_cndmask_b32 v24, v51, v47, s[56:57]
    s_nop 1
    v_cndmask_b32 v25, v55, v51, s[56:57]
    v_add_f32_dpp v50, v24, v50 wave_ror:1 row_mask:0xf bank_mask:0xf
    s_nop 0
    v_add_f32_dpp v54, v25, v54 wave_ror:1 row_mask:0xf bank_mask:0xf
    v_cndmask_b32 v22, v50, v46, s[56:57]
    v_mfma_f32_16x16x32_bf16 v[160:163], v[216:219], v[112:115], v[160:163]
    v_cndmask_b32 v23, v54, v50, s[56:57]
    v_add_f32_dpp v49, v22, v49 wave_ror:1 row_mask:0xf bank_mask:0xf
    s_nop 0
    v_add_f32_dpp v53, v23, v53 wave_ror:1 row_mask:0xf bank_mask:0xf
    v_cndmask_b32 v24, v49, v45, s[56:57]
    v_cndmask_b32 v25, v53, v49, s[56:57]
    v_mfma_f32_16x16x32_bf16 v[164:167], v[218:221], v[112:115], v[164:167]
    s_nop 0
    v_add_f32_dpp v48, v24, v48 wave_ror:1 row_mask:0xf bank_mask:0xf
    v_add_f32_dpp v52, v25, v52 wave_ror:1 row_mask:0xf bank_mask:0xf
    v_cvt_pk_bf16_f32 v27, v48, v52
    ds_write_b16 v82, v27 offset:3328
    ds_write_b16_d16_hi v82, v27 offset:3456
    v_mfma_f32_16x16x32_bf16 v[160:163], v[220:223], v[108:111], v[160:163]
    v_mfma_f32_16x16x32_bf16 v[164:167], v[222:225], v[108:111], v[164:167]
    v_mfma_f32_16x16x32_bf16 v[160:163], v[224:227], v[104:107], v[160:163]
    s_waitcnt lgkmcnt(0)
    s_barrier
    v_mfma_f32_16x16x32_bf16 v[164:167], v[226:229], v[104:107], v[164:167]
    ds_read_b64_tr_b16 v[28:29], v76 offset:3072
    v_mfma_f32_16x16x32_bf16 v[160:163], v[228:231], v[100:103], v[160:163]
    ds_read_b64_tr_b16 v[30:31], v76 offset:19712
    v_mfma_f32_16x16x32_bf16 v[164:167], v[230:233], v[100:103], v[164:167]
    s_add_u32 s62, s50, 3932160
    v_mfma_f32_16x16x32_bf16 v[160:163], v[232:235], v[96:99], v[160:163]
    v_mfma_f32_16x16x32_bf16 v[164:167], v[234:237], v[96:99], v[164:167]
    v_mfma_f32_16x16x32_bf16 v[168:171], v[208:211], v[124:127], v[168:171]
    v_mfma_f32_16x16x32_bf16 v[172:175], v[210:213], v[124:127], v[172:175]
    v_mfma_f32_16x16x32_bf16 v[168:171], v[212:215], v[120:123], v[168:171]
    v_mfma_f32_16x16x32_bf16 v[172:175], v[214:217], v[120:123], v[172:175]
    v_mfma_f32_16x16x32_bf16 v[168:171], v[216:219], v[116:119], v[168:171]
    s_waitcnt lgkmcnt(0)
    buffer_store_dwordx4 v[28:31], v79, s[44:47], s62 offen
    v_mfma_f32_16x16x32_bf16 v[172:175], v[218:221], v[116:119], v[172:175]
    v_cndmask_b32 v24, v163, v55, s[56:57]
    v_mfma_f32_16x16x32_bf16 v[168:171], v[220:223], v[112:115], v[168:171]
    v_cndmask_b32 v25, v167, v163, s[56:57]
    v_add_f32_dpp v162, v24, v162 wave_ror:1 row_mask:0xf bank_mask:0xf
    v_mfma_f32_16x16x32_bf16 v[172:175], v[222:225], v[112:115], v[172:175]
    v_add_f32_dpp v166, v25, v166 wave_ror:1 row_mask:0xf bank_mask:0xf
    v_mfma_f32_16x16x32_bf16 v[168:171], v[224:227], v[108:111], v[168:171]
    v_cndmask_b32 v22, v162, v54, s[56:57]
    v_mfma_f32_16x16x32_bf16 v[172:175], v[226:229], v[108:111], v[172:175]
    v_cndmask_b32 v23, v166, v162, s[56:57]
    v_add_f32_dpp v161, v22, v161 wave_ror:1 row_mask:0xf bank_mask:0xf
    v_mfma_f32_16x16x32_bf16 v[168:171], v[228:231], v[104:107], v[168:171]
    v_add_f32_dpp v165, v23, v165 wave_ror:1 row_mask:0xf bank_mask:0xf
    v_mfma_f32_16x16x32_bf16 v[172:175], v[230:233], v[104:107], v[172:175]
    v_cndmask_b32 v24, v161, v53, s[56:57]
    v_mfma_f32_16x16x32_bf16 v[168:171], v[232:235], v[100:103], v[168:171]
    v_cndmask_b32 v25, v165, v161, s[56:57]
    v_add_f32_dpp v160, v24, v160 wave_ror:1 row_mask:0xf bank_mask:0xf
    v_mfma_f32_16x16x32_bf16 v[172:175], v[234:237], v[100:103], v[172:175]
    v_add_f32_dpp v164, v25, v164 wave_ror:1 row_mask:0xf bank_mask:0xf
    v_mfma_f32_16x16x32_bf16 v[168:171], v[236:239], v[96:99], v[168:171]
    v_cvt_pk_bf16_f32 v26, v160, v164
    v_mfma_f32_16x16x32_bf16 v[172:175], v[238:241], v[96:99], v[172:175]
    ds_write_b16 v82, v26 offset:3584
    ds_write_b16_d16_hi v82, v26 offset:3712
    s_nop 3
    v_cndmask_b32 v24, v171, v167, s[56:57]
    s_nop 0
    v_cndmask_b32 v25, v175, v171, s[56:57]
    v_add_f32_dpp v170, v24, v170 wave_ror:1 row_mask:0xf bank_mask:0xf
    s_nop 0
    v_add_f32_dpp v174, v25, v174 wave_ror:1 row_mask:0xf bank_mask:0xf
    v_cndmask_b32 v22, v170, v166, s[56:57]
    v_cndmask_b32 v23, v174, v170, s[56:57]
    s_nop 0
    s_nop 0
    v_add_f32_dpp v169, v22, v169 wave_ror:1 row_mask:0xf bank_mask:0xf
    v_add_f32_dpp v173, v23, v173 wave_ror:1 row_mask:0xf bank_mask:0xf
    v_cndmask_b32 v24, v169, v165, s[56:57]
    v_cndmask_b32 v25, v173, v169, s[56:57]
    s_nop 0
    s_nop 0
    v_add_f32_dpp v168, v24, v168 wave_ror:1 row_mask:0xf bank_mask:0xf
    v_add_f32_dpp v172, v25, v172 wave_ror:1 row_mask:0xf bank_mask:0xf
    v_cvt_pk_bf16_f32 v27, v168, v172
    ds_write_b16 v82, v27 offset:3840
    ds_write_b16_d16_hi v82, v27 offset:3968
    s_waitcnt lgkmcnt(0)
    s_barrier
    ds_read_b64_tr_b16 v[28:29], v76 offset:3584
    ds_read_b64_tr_b16 v[30:31], v76 offset:20224
    s_add_u32 s62, s50, 4587520
    s_waitcnt lgkmcnt(0)
    buffer_store_dwordx4 v[28:31], v79, s[44:47], s62 offen
    s_endpgm
L_END:
.section .rodata,"a"
.p2align 6
.amdhsa_kernel concat_heads__ssm_conv_s4__linear_kernel_hedgehog__prompt_kernel
  .amdhsa_next_free_vgpr 256
  .amdhsa_next_free_sgpr 102
  .amdhsa_accum_offset 256
  .amdhsa_group_segment_fixed_size 0
  .amdhsa_kernarg_size 128
  .amdhsa_user_sgpr_count 2
  .amdhsa_user_sgpr_kernarg_segment_ptr 1
  .amdhsa_system_sgpr_workgroup_id_x 1
.end_amdhsa_kernel
```
